```python
import torch

def _softmax(x, axis=-1):
    return torch.softmax(x, dim=axis)
def _gelu(x):
    return torch.nn.functional.gelu(x, approximate="tanh")
def _silu(x):
    return torch.nn.functional.silu(x)
def _sigmoid(x):
    return torch.sigmoid(x)
def _layernorm(x, axis=-1, eps=1e-5):
    m = x.mean(dim=axis, keepdim=True)
    v = x.var(dim=axis, keepdim=True, unbiased=False)
    return (x - m) / torch.sqrt(v + eps)
def _scatter_add(tgt, idx, src, axis=0):
    return tgt.clone().index_add_(axis, idx, src)
def _segment_sum(src, seg, n):
    out = torch.zeros((n,) + src.shape[1:], dtype=src.dtype)
    return out.index_add_(0, seg, src)
def _pad(x, pw):
    flat = tuple(v for pair in reversed(pw) for v in pair)
    return torch.nn.functional.pad(x, flat)

kernel_name = 'interleave_layers__sliding_local_dilated__grouped_kv_mqa__prompt'

def setup_inputs():

    _w = (lambda a: (lambda t: t.to(torch.bfloat16) if t.is_floating_point() else t)(torch.as_tensor(a)))
    def _A_setup():
        B, S, D = 1, 2048, 576
        return {
            "x": _w((lambda *s: torch.randn(*s, dtype=torch.bfloat16) * 0.05)(B, S, D)),
            "wqkv": _w((lambda *s: torch.randn(*s, dtype=torch.bfloat16) * 0.05)(D, 3 * D)),
            "wo": _w((lambda *s: torch.randn(*s, dtype=torch.bfloat16) * 0.05)(D, D)),
        }
    _A_in = _A_setup()

    def _B_setup():
        B, S, D, H = 1, 2048, 576, 32
        Dh = D // H
        return {
            "x": _w((lambda *s: torch.randn(*s, dtype=torch.bfloat16) * 0.05)(B, S, D)),
            "wq": _w((lambda *s: torch.randn(*s, dtype=torch.bfloat16) * 0.05)(D, H * Dh)),
            "wk": _w((lambda *s: torch.randn(*s, dtype=torch.bfloat16) * 0.05)(D, Dh)),
            "wv": _w((lambda *s: torch.randn(*s, dtype=torch.bfloat16) * 0.05)(D, Dh)),
            "wo": _w((lambda *s: torch.randn(*s, dtype=torch.bfloat16) * 0.05)(H * Dh, D)),
        }
    _B_in = _B_setup()

    return {
        "A_x": _A_in["x"],
        "A_wqkv": _A_in["wqkv"],
        "A_wo": _A_in["wo"],
        "B_x": _B_in["x"],
        "B_wq": _B_in["wq"],
        "B_wk": _B_in["wk"],
        "B_wv": _B_in["wv"],
        "B_wo": _B_in["wo"],
    }

def reference(A_x, A_wqkv, A_wo, B_x, B_wq, B_wk, B_wv, B_wo):
    def _A_ref(x, wqkv, wo):
        B, S, D = x.shape
        H = 32; Dh = D // H
        W, dil = 8, 2
        qkv = (lambda x, *d: x.permute(*d))((x @ wqkv).reshape(B, S, 3, H, Dh), 2, 0, 3, 1, 4)
        q, k, v = qkv[0], qkv[1], qkv[2]
        scale = Dh ** -0.5
        pos = torch.arange(S)
        off = torch.arange(W) * dil
        idx = pos[:, None] - off[None, :]
        mask = idx >= 0
        idx_c = torch.where(mask, idx, 0).reshape(-1)
        kg = k[:, :, idx_c, :].reshape(B, H, S, W, Dh)
        vg = v[:, :, idx_c, :].reshape(B, H, S, W, Dh)
        logits = torch.einsum("bhsd,bhswd->bhsw", q, kg) * scale
        logits = torch.where(mask[None, None, :, :], logits, -1e9)
        attn = _softmax(logits, axis=-1)
        o = torch.einsum("bhsw,bhswd->bhsd", attn, vg)
        return (lambda x, *d: x.permute(*d))(o, 0, 2, 1, 3).reshape(B, S, D) @ wo

    def _B_ref(x, wq, wk, wv, wo):
        B, S, D = x.shape
        H = 32
        Dh = D // H
        q = (lambda x, *d: x.permute(*d))((x @ wq).reshape(B, S, H, Dh), 0, 2, 1, 3)
        k = x @ wk
        v = x @ wv
        scores = torch.einsum("bhqd,bkd->bhqk", q, k) * (Dh ** -0.5)
        p = _softmax(scores, axis=-1)
        o = torch.einsum("bhqk,bkd->bhqd", p, v)
        return (lambda x, *d: x.permute(*d))(o, 0, 2, 1, 3).reshape(B, S, H * Dh) @ wo

    x = A_x
    x = x + _A_ref(_layernorm(x, axis=-1), A_wqkv, A_wo)
    x = x + _B_ref(_layernorm(x, axis=-1), B_wq, B_wk, B_wv, B_wo)
    x = x + _A_ref(_layernorm(x, axis=-1), A_wqkv, A_wo)
    x = x + _B_ref(_layernorm(x, axis=-1), B_wq, B_wk, B_wv, B_wo)
    return x
```

```asm
; @launch kernel=k0_kernel grid=(256,1,1) block=(768,1,1) lds=4608
; @launch kernel=main_kernel grid=(256,1,1) block=(512,1,1) lds=163840
.amdgcn_target "amdgcn-amd-amdhsa--gfx950"
.text
.globl k0_kernel
.p2align 8
.type k0_kernel,@function
k0_kernel:
    s_load_dwordx16 s[48:63], s[0:1], 0
    s_load_dwordx2 s[8:9], s[0:1], 80
    s_cmp_ge_u32 s2, 16
    s_cbranch_scc1 K0_GO
    s_getpc_b64 s[12:13]
K0_PC0:
    s_mov_b32 s14, CODE_END-K0_PC0
    s_mov_b32 s15, 0x20000
    s_and_b32 s13, s13, 0xffff
    v_lshlrev_b32 v4, 7, v0
    buffer_load_dword v79, v4, s[12:15], 0 offen
K0_GO:
    s_cmp_ge_u32 s2, 256
    s_cbranch_scc1 K0_END
    s_mov_b32 s10, 21237760
    s_mov_b32 s11, 0x20000
    v_lshrrev_b32 v4, 6, v0
    v_and_b32 v1, 63, v0
    v_readfirstlane_b32 s3, v4
    v_and_b32 v2, 15, v0
    v_lshrrev_b32 v3, 4, v1
    s_mov_b32 s30, 0x05040100
    s_mov_b32 s31, 0x07060302
    s_movk_i32 s29, 288
    s_cmp_ge_u32 s3, 11
    s_cbranch_scc1 K0_T6
    s_cmp_ge_u32 s3, 9
    s_cbranch_scc1 K0_T5
    s_cmp_lt_u32 s2, 36
    s_cbranch_scc1 K0_T3
    s_cmp_lt_u32 s2, 40
    s_cbranch_scc1 K0_T3B
    s_cmp_lt_u32 s2, 76
    s_cbranch_scc1 K0_T4
    s_cmp_ge_u32 s2, 220
    s_cbranch_scc1 K0_T7
    s_cmp_ge_u32 s2, 184
    s_cbranch_scc1 K0_T2
    s_mov_b32 s14, 1990656
    s_mov_b32 s15, 0x20000
    s_mov_b32 s32, 0
    s_mov_b32 s33, 3456
    s_mov_b32 s34, 6912
    s_mov_b32 s35, 10368
    s_mov_b32 s36, 13824
    s_mov_b32 s37, 17280
    s_mov_b32 s38, 20736
    s_mov_b32 s39, 24192
    s_sub_u32 s16, s2, 76
    s_mul_i32 s16, s16, 576
    v_add_u32 v4, s16, v0
    v_lshrrev_b32 v5, 5, v4
    v_mul_u32_u24 v5, 2428, v5
    v_lshrrev_b32 v12, 16, v5
    v_mul_u32_u24 v5, 864, v12
    v_sub_u32 v6, v4, v5
    v_mul_u32_u24 v5, 27648, v12
    v_lshl_add_u32 v5, v6, 2, v5
    s_waitcnt lgkmcnt(0)
    s_mov_b64 s[12:13], s[50:51]
    buffer_load_dword v16, v5, s[12:15], s32 offen
    buffer_load_dword v17, v5, s[12:15], s33 offen
    buffer_load_dword v18, v5, s[12:15], s34 offen
    buffer_load_dword v19, v5, s[12:15], s35 offen
    buffer_load_dword v20, v5, s[12:15], s36 offen
    buffer_load_dword v21, v5, s[12:15], s37 offen
    buffer_load_dword v22, v5, s[12:15], s38 offen
    buffer_load_dword v23, v5, s[12:15], s39 offen
    v_mul_u32_u24 v7, 7282, v6
    v_lshrrev_b32 v7, 16, v7
    v_mul_u32_u24 v8, 9, v7
    v_sub_u32 v8, v6, v8
    v_lshrrev_b32 v13, 5, v7
    v_and_b32 v9, 1, v7
    v_bfe_u32 v7, v7, 1, 4
    v_lshl_add_u32 v10, v13, 1, v9
    v_lshlrev_b32 v10, 10, v10
    v_lshl_add_u32 v10, v8, 5, v10
    v_lshlrev_b32 v11, 6, v9
    v_lshl_add_u32 v11, v13, 5, v11
    v_lshlrev_b32 v14, 5, v9
    v_add_u32 v14, 128, v14
    v_cmp_eq_u32 s[26:27], 2, v13
    s_nop 1
    v_cndmask_b32 v11, v11, v14, s[26:27]
    v_add_u32 v11, 6144, v11
    v_cmp_gt_u32 s[26:27], 8, v8
    s_nop 1
    v_cndmask_b32 v10, v11, v10, s[26:27]
    v_mul_u32_u24 v7, 129024, v7
    v_lshrrev_b32 v11, 2, v12
    v_mul_u32_u24 v11, 7168, v11
    v_and_b32 v12, 3, v12
    v_lshl_add_u32 v10, v12, 8, v10
    v_add3_u32 v10, v10, v7, v11
    v_add_u32 v10, 17031168, v10
    s_branch K0_UNIT
K0_T2:
    s_mov_b32 s14, 663552
    s_mov_b32 s15, 0x20000
    s_sub_u32 s16, s2, 184
    s_lshl_b32 s16, s16, 1
    v_cmp_le_u32 s[26:27], s29, v0
    v_subrev_u32 v6, 288, v0
    s_nop 0
    v_cndmask_b32 v6, v0, v6, s[26:27]
    v_cndmask_b32 v12, 0, 1, s[26:27]
    v_add_u32 v12, s16, v12
    v_lshlrev_b32 v6, 1, v6
    s_cmp_ge_u32 s16, 64
    s_cbranch_scc1 K0_T2R
    s_mov_b32 s32, 0
    s_mov_b32 s33, 1152
    s_mov_b32 s34, 2304
    s_mov_b32 s35, 3456
    s_mov_b32 s36, 4608
    s_mov_b32 s37, 5760
    s_mov_b32 s38, 6912
    s_mov_b32 s39, 8064
    v_lshrrev_b32 v7, 1, v12
    v_mul_u32_u24 v7, 18, v7
    v_and_b32 v8, 1, v12
    v_lshl_add_u32 v7, v8, 3, v7
    s_branch K0_T2J
K0_T2R:
    s_mov_b32 s32, 0
    s_mov_b32 s33, 1152
    s_mov_b32 s34, 20736
    s_mov_b32 s35, 21888
    s_mov_b32 s36, 41472
    s_mov_b32 s37, 42624
    s_mov_b32 s38, 62208
    s_mov_b32 s39, 63360
    v_subrev_u32 v7, 64, v12
    v_mul_u32_u24 v7, 72, v7
    v_add_u32 v7, 16, v7
K0_T2J:
    v_mul_u32_u24 v5, 1152, v7
    v_lshl_add_u32 v5, v6, 1, v5
    s_waitcnt lgkmcnt(0)
    s_mov_b64 s[12:13], s[52:53]
    buffer_load_dword v16, v5, s[12:15], s32 offen
    buffer_load_dword v17, v5, s[12:15], s33 offen
    buffer_load_dword v18, v5, s[12:15], s34 offen
    buffer_load_dword v19, v5, s[12:15], s35 offen
    buffer_load_dword v20, v5, s[12:15], s36 offen
    buffer_load_dword v21, v5, s[12:15], s37 offen
    buffer_load_dword v22, v5, s[12:15], s38 offen
    buffer_load_dword v23, v5, s[12:15], s39 offen
    v_mul_u32_u24 v7, 911, v6
    v_lshrrev_b32 v7, 16, v7
    v_mul_u32_u24 v8, 72, v7
    v_sub_u32 v8, v6, v8
    v_lshrrev_b32 v9, 4, v8
    v_and_b32 v8, 15, v8
    v_lshlrev_b32 v10, 10, v9
    v_lshl_add_u32 v10, v8, 4, v10
    v_and_b32 v9, 3, v12
    v_lshl_add_u32 v10, v9, 8, v10
    v_mul_u32_u24 v7, 92160, v7
    v_lshrrev_b32 v9, 2, v12
    v_mul_u32_u24 v9, 5120, v9
    v_add3_u32 v10, v10, v7, v9
    v_add_u32 v10, 19095552, v10
K0_UNIT:
    s_waitcnt vmcnt(0)
    v_perm_b32 v24, v17, v16, s30
    v_perm_b32 v28, v17, v16, s31
    v_perm_b32 v25, v19, v18, s30
    v_perm_b32 v29, v19, v18, s31
    v_perm_b32 v26, v21, v20, s30
    v_perm_b32 v30, v21, v20, s31
    v_perm_b32 v27, v23, v22, s30
    v_perm_b32 v31, v23, v22, s31
    buffer_store_dwordx4 v[24:27], v10, s[8:11], 0 offen
    buffer_store_dwordx4 v[28:31], v10, s[8:11], 0 offen offset:16
    s_endpgm
K0_T3:
    s_mov_b32 s14, 663552
    s_mov_b32 s15, 0x20000
    s_mov_b32 s32, 0
    s_mov_b32 s33, 1152
    s_mov_b32 s34, 2304
    s_mov_b32 s35, 3456
    s_mov_b32 s36, 4608
    s_mov_b32 s37, 5760
    s_mov_b32 s38, 6912
    s_mov_b32 s39, 8064
    s_sub_u32 s16, s2, 0
    s_and_b32 s18, s16, 1
    s_lshr_b32 s16, s16, 1
    s_mul_i32 s17, s18, 9
    s_add_u32 s17, s17, s3
    s_lshl_b32 s19, s16, 5
    v_lshl_add_u32 v6, v2, 1, s19
    s_mul_i32 s20, s17, 36864
    v_mul_u32_u24 v5, 9216, v3
    v_lshl_add_u32 v5, v6, 1, v5
    v_add_u32 v5, s20, v5
    s_waitcnt lgkmcnt(0)
    s_mov_b64 s[12:13], s[56:57]
    buffer_load_dword v16, v5, s[12:15], s32 offen
    buffer_load_dword v17, v5, s[12:15], s33 offen
    buffer_load_dword v18, v5, s[12:15], s34 offen
    buffer_load_dword v19, v5, s[12:15], s35 offen
    buffer_load_dword v20, v5, s[12:15], s36 offen
    buffer_load_dword v21, v5, s[12:15], s37 offen
    buffer_load_dword v22, v5, s[12:15], s38 offen
    buffer_load_dword v23, v5, s[12:15], s39 offen
    v_mul_u32_u24 v7, 3641, v6
    v_lshrrev_b32 v7, 16, v7
    v_mul_u32_u24 v8, 18, v7
    v_sub_u32 v8, v6, v8
    v_and_b32 v9, 3, v7
    v_lshrrev_b32 v7, 2, v7
    v_lshl_add_u32 v10, v9, 4, v8
    v_lshl_add_u32 v11, v9, 2, 64
    v_cmp_gt_u32 s[26:27], 16, v8
    s_nop 1
    v_cndmask_b32 v11, v11, v10, s[26:27]
    v_lshrrev_b32 v9, 4, v11
    v_and_b32 v8, 15, v11
    v_lshlrev_b32 v10, 10, v9
    v_lshl_add_u32 v10, v8, 4, v10
    v_lshl_add_u32 v10, v3, 8, v10
    v_mul_u32_u24 v13, 92160, v7
    s_mul_i32 s28, s17, 5120
    s_add_u32 s28, s28, 19834880
    v_add3_u32 v10, v10, v13, s28
    v_mul_u32_u24 v13, 80, v7
    v_add_lshl_u32 v13, v13, v11, 2
    s_mov_b32 s29, 0x3f803f80
    v_mov_b32 v40, 0
    v_mov_b32 v41, 0
    s_waitcnt vmcnt(0)
    v_perm_b32 v24, v17, v16, s30
    v_perm_b32 v28, v17, v16, s31
    v_perm_b32 v25, v19, v18, s30
    v_perm_b32 v29, v19, v18, s31
    v_perm_b32 v26, v21, v20, s30
    v_perm_b32 v30, v21, v20, s31
    v_perm_b32 v27, v23, v22, s30
    v_perm_b32 v31, v23, v22, s31
    buffer_store_dwordx4 v[24:27], v10, s[8:11], 0 offen
    buffer_store_dwordx4 v[28:31], v10, s[8:11], 0 offen offset:16
    v_dot2_f32_bf16 v40, v24, s29, v40
    v_dot2_f32_bf16 v41, v28, s29, v41
    v_dot2_f32_bf16 v40, v25, s29, v40
    v_dot2_f32_bf16 v41, v29, s29, v41
    v_dot2_f32_bf16 v40, v26, s29, v40
    v_dot2_f32_bf16 v41, v30, s29, v41
    v_dot2_f32_bf16 v40, v27, s29, v40
    v_dot2_f32_bf16 v41, v31, s29, v41
    s_lshl_b32 s20, s3, 9
    v_lshlrev_b32 v42, 3, v1
    v_add_u32 v43, s20, v42
    ds_write_b64 v43, v[40:41]
    s_waitcnt lgkmcnt(0)
    s_barrier
    s_cmp_lg_u32 s3, 0
    s_cbranch_scc1 K0_END
    ds_read_b64 v[46:47], v42 offset:512
    ds_read_b64 v[48:49], v42 offset:1024
    ds_read_b64 v[50:51], v42 offset:1536
    ds_read_b64 v[52:53], v42 offset:2048
    ds_read_b64 v[54:55], v42 offset:2560
    ds_read_b64 v[56:57], v42 offset:3072
    ds_read_b64 v[58:59], v42 offset:3584
    ds_read_b64 v[60:61], v42 offset:4096
    s_waitcnt lgkmcnt(0)
    v_add_f32 v40, v40, v46
    v_add_f32 v41, v41, v47
    v_add_f32 v40, v40, v48
    v_add_f32 v41, v41, v49
    v_add_f32 v40, v40, v50
    v_add_f32 v41, v41, v51
    v_add_f32 v40, v40, v52
    v_add_f32 v41, v41, v53
    v_add_f32 v40, v40, v54
    v_add_f32 v41, v41, v55
    v_add_f32 v40, v40, v56
    v_add_f32 v41, v41, v57
    v_add_f32 v40, v40, v58
    v_add_f32 v41, v41, v59
    v_add_f32 v40, v40, v60
    v_add_f32 v41, v41, v61
    v_mov_b32 v42, v40
    v_mov_b32 v43, v41
    s_nop 0
    v_permlane32_swap_b32 v40, v42
    v_permlane32_swap_b32 v41, v43
    v_add_f32 v40, v40, v42
    v_add_f32 v41, v41, v43
    v_mov_b32 v42, v40
    v_mov_b32 v43, v41
    s_nop 0
    v_permlane16_swap_b32 v40, v42
    v_permlane16_swap_b32 v41, v43
    v_add_f32 v40, v40, v42
    v_add_f32 v41, v41, v43
    s_mul_i32 s21, s18, 2560
    s_add_u32 s21, s21, 17022976
    s_mov_b64 exec, 0xffff
    buffer_store_dwordx2 v[40:41], v13, s[8:11], s21 offen
    s_endpgm
K0_T3B:
    s_sub_u32 s16, s2, 36
    s_and_b32 s18, s16, 1
    s_lshr_b32 s16, s16, 1
    s_mul_i32 s17, s18, 9
    s_add_u32 s17, s17, s3
    s_mov_b32 s14, 20736
    s_mov_b32 s15, 0x20000
    s_mov_b32 s32, 0
    s_mov_b32 s33, 36
    s_mov_b32 s34, 72
    s_mov_b32 s35, 108
    s_mov_b32 s36, 144
    s_mov_b32 s37, 180
    s_mov_b32 s38, 216
    s_mov_b32 s39, 252
    s_mul_i32 s20, s17, 1152
    v_mul_u32_u24 v5, 288, v3
    v_lshl_add_u32 v5, v2, 2, v5
    v_add_u32 v5, s20, v5
    s_waitcnt lgkmcnt(0)
    s_cmp_eq_u32 s16, 0
    s_cselect_b64 s[12:13], s[58:59], s[60:61]
    buffer_load_dword v16, v5, s[12:15], s32 offen
    buffer_load_dword v17, v5, s[12:15], s33 offen
    buffer_load_dword v18, v5, s[12:15], s34 offen
    buffer_load_dword v19, v5, s[12:15], s35 offen
    buffer_load_dword v20, v5, s[12:15], s36 offen
    buffer_load_dword v21, v5, s[12:15], s37 offen
    buffer_load_dword v22, v5, s[12:15], s38 offen
    buffer_load_dword v23, v5, s[12:15], s39 offen
    v_mul_u32_u24 v7, 86, v2
    v_lshrrev_b32 v7, 8, v7
    v_mul_u32_u24 v8, 3, v7
    v_sub_u32 v8, v2, v8
    s_mul_i32 s22, s16, 3
    v_add_u32 v7, s22, v7
    v_lshl_add_u32 v11, v8, 2, 6
    v_mul_u32_u24 v10, 92160, v7
    v_lshl_add_u32 v10, v11, 4, v10
    v_lshl_add_u32 v10, v3, 8, v10
    s_mul_i32 s28, s17, 5120
    s_add_u32 s28, s28, 19838976
    v_add_u32 v10, s28, v10
    v_mul_u32_u24 v13, 80, v7
    v_add3_u32 v13, v13, v11, 64
    v_lshlrev_b32 v13, 2, v13
    v_mov_b32 v11, 2147483392
    v_cmp_gt_u32 s[26:27], 9, v2
    s_nop 1
    v_cndmask_b32 v10, v11, v10, s[26:27]
    s_mov_b32 s29, 0x3f803f80
    v_mov_b32 v40, 0
    v_mov_b32 v41, 0
    s_waitcnt vmcnt(0)
    v_perm_b32 v24, v17, v16, s30
    v_perm_b32 v28, v17, v16, s31
    v_perm_b32 v25, v19, v18, s30
    v_perm_b32 v29, v19, v18, s31
    v_perm_b32 v26, v21, v20, s30
    v_perm_b32 v30, v21, v20, s31
    v_perm_b32 v27, v23, v22, s30
    v_perm_b32 v31, v23, v22, s31
    buffer_store_dwordx4 v[24:27], v10, s[8:11], 0 offen
    buffer_store_dwordx4 v[28:31], v10, s[8:11], 0 offen offset:16
    v_dot2_f32_bf16 v40, v24, s29, v40
    v_dot2_f32_bf16 v41, v28, s29, v41
    v_dot2_f32_bf16 v40, v25, s29, v40
    v_dot2_f32_bf16 v41, v29, s29, v41
    v_dot2_f32_bf16 v40, v26, s29, v40
    v_dot2_f32_bf16 v41, v30, s29, v41
    v_dot2_f32_bf16 v40, v27, s29, v40
    v_dot2_f32_bf16 v41, v31, s29, v41
    s_lshl_b32 s20, s3, 9
    v_lshlrev_b32 v42, 3, v1
    v_add_u32 v43, s20, v42
    ds_write_b64 v43, v[40:41]
    s_waitcnt lgkmcnt(0)
    s_barrier
    s_cmp_lg_u32 s3, 0
    s_cbranch_scc1 K0_END
    ds_read_b64 v[46:47], v42 offset:512
    ds_read_b64 v[48:49], v42 offset:1024
    ds_read_b64 v[50:51], v42 offset:1536
    ds_read_b64 v[52:53], v42 offset:2048
    ds_read_b64 v[54:55], v42 offset:2560
    ds_read_b64 v[56:57], v42 offset:3072
    ds_read_b64 v[58:59], v42 offset:3584
    ds_read_b64 v[60:61], v42 offset:4096
    s_waitcnt lgkmcnt(0)
    v_add_f32 v40, v40, v46
    v_add_f32 v41, v41, v47
    v_add_f32 v40, v40, v48
    v_add_f32 v41, v41, v49
    v_add_f32 v40, v40, v50
    v_add_f32 v41, v41, v51
    v_add_f32 v40, v40, v52
    v_add_f32 v41, v41, v53
    v_add_f32 v40, v40, v54
    v_add_f32 v41, v41, v55
    v_add_f32 v40, v40, v56
    v_add_f32 v41, v41, v57
    v_add_f32 v40, v40, v58
    v_add_f32 v41, v41, v59
    v_add_f32 v40, v40, v60
    v_add_f32 v41, v41, v61
    v_mov_b32 v42, v40
    v_mov_b32 v43, v41
    s_nop 0
    v_permlane32_swap_b32 v40, v42
    v_permlane32_swap_b32 v41, v43
    v_add_f32 v40, v40, v42
    v_add_f32 v41, v41, v43
    v_mov_b32 v42, v40
    v_mov_b32 v43, v41
    s_nop 0
    v_permlane16_swap_b32 v40, v42
    v_permlane16_swap_b32 v41, v43
    v_add_f32 v40, v40, v42
    v_add_f32 v41, v41, v43
    s_mul_i32 s21, s18, 2560
    s_add_u32 s21, s21, 17022976
    s_mov_b64 exec, 0x1ff
    buffer_store_dwordx2 v[40:41], v13, s[8:11], s21 offen
    s_endpgm
K0_T4:
    s_mov_b32 s14, 663552
    s_mov_b32 s15, 0x20000
    s_sub_u32 s16, s2, 40
    s_lshl_b32 s16, s16, 1
    v_cmp_le_u32 s[26:27], s29, v0
    v_subrev_u32 v6, 288, v0
    s_nop 0
    v_cndmask_b32 v6, v0, v6, s[26:27]
    v_cndmask_b32 v12, 0, 1, s[26:27]
    v_add_u32 v12, s16, v12
    v_lshrrev_b32 v9, 3, v6
    v_and_b32 v10, 7, v6
    v_lshlrev_b32 v10, 5, v10
    s_cmp_ge_u32 s16, 64
    s_cbranch_scc1 K0_T4R
    s_mov_b32 s32, 0
    s_mov_b32 s33, 1152
    s_mov_b32 s34, 2304
    s_mov_b32 s35, 3456
    s_mov_b32 s36, 4608
    s_mov_b32 s37, 5760
    s_mov_b32 s38, 6912
    s_mov_b32 s39, 8064
    v_lshrrev_b32 v13, 1, v12
    v_mul_u32_u24 v7, 18, v13
    v_and_b32 v8, 1, v12
    v_lshl_add_u32 v7, v8, 3, v7
    v_lshl_add_u32 v10, v8, 10, v10
    v_lshl_add_u32 v10, v9, 11, v10
    v_and_b32 v8, 3, v13
    v_lshl_add_u32 v10, v8, 8, v10
    v_lshrrev_b32 v8, 2, v13
    v_mul_u32_u24 v8, 73728, v8
    v_add_u32 v10, v10, v8
    v_add_u32 v10, 20574208, v10
    s_branch K0_T4J
K0_T4R:
    s_mov_b32 s32, 0
    s_mov_b32 s33, 1152
    s_mov_b32 s34, 82944
    s_mov_b32 s35, 84096
    s_mov_b32 s36, 165888
    s_mov_b32 s37, 167040
    s_mov_b32 s38, 248832
    s_mov_b32 s39, 249984
    v_and_b32 v8, 3, v12
    v_bfe_u32 v13, v12, 2, 1
    v_mul_u32_u24 v7, 18, v8
    v_mul_u32_u24 v11, 288, v13
    v_add3_u32 v7, v7, v11, 16
    v_lshl_add_u32 v10, v9, 10, v10
    v_lshl_add_u32 v10, v8, 8, v10
    v_mul_u32_u24 v8, 36864, v13
    v_add_u32 v10, v10, v8
    v_add_u32 v10, 21164032, v10
K0_T4J:
    v_mul_u32_u24 v5, 1152, v7
    v_lshl_add_u32 v5, v6, 2, v5
    s_waitcnt lgkmcnt(0)
    s_mov_b64 s[12:13], s[62:63]
    buffer_load_dword v16, v5, s[12:15], s32 offen
    buffer_load_dword v17, v5, s[12:15], s33 offen
    buffer_load_dword v18, v5, s[12:15], s34 offen
    buffer_load_dword v19, v5, s[12:15], s35 offen
    buffer_load_dword v20, v5, s[12:15], s36 offen
    buffer_load_dword v21, v5, s[12:15], s37 offen
    buffer_load_dword v22, v5, s[12:15], s38 offen
    buffer_load_dword v23, v5, s[12:15], s39 offen
    s_branch K0_UNIT
K0_T5:
    s_cmp_lt_u32 s2, 40
    s_cbranch_scc1 K0_END
    s_lshl_b32 s16, s2, 1
    s_add_u32 s16, s16, s3
    s_sub_u32 s16, s16, 9
K0_T5B:
    s_mov_b32 s14, 2359296
    s_mov_b32 s15, 0x20000
    s_lshl_b32 s16, s16, 2
    s_mul_i32 s20, s16, 1152
    v_mul_u32_u24 v5, 1152, v3
    v_lshl_add_u32 v5, v2, 4, v5
    v_mov_b32 v6, 2147483392
    v_cmp_gt_u32 s[26:27], 8, v2
    s_nop 1
    v_cndmask_b32 v6, v6, v5, s[26:27]
    s_waitcnt lgkmcnt(0)
    s_mov_b64 s[12:13], s[48:49]
    buffer_load_dwordx4 v[16:19], v5, s[12:15], s20 offen offset:0
    buffer_load_dwordx4 v[20:23], v5, s[12:15], s20 offen offset:256
    buffer_load_dwordx4 v[24:27], v5, s[12:15], s20 offen offset:512
    buffer_load_dwordx4 v[28:31], v5, s[12:15], s20 offen offset:768
    buffer_load_dwordx4 v[32:35], v6, s[12:15], s20 offen offset:1024
    v_and_b32 v7, 3, v1
    v_lshrrev_b32 v8, 2, v1
    v_lshl_add_u32 v9, v7, 4, v8
    v_lshlrev_b32 v9, 2, v9
    s_lshr_b32 s21, s16, 4
    s_mul_i32 s21, s21, 18432
    s_and_b32 s22, s16, 15
    s_lshl_b32 s22, s22, 4
    s_add_u32 s21, s21, s22
    s_add_u32 s21, s21, 0
    v_lshlrev_b32 v10, 8, v8
    v_lshl_add_u32 v10, v7, 4, v10
    s_mov_b32 s29, 0x3f803f80
    v_mov_b32 v40, 0
    v_mov_b32 v41, 0
    s_waitcnt vmcnt(0)
    ds_bpermute_b32 v44, v9, v16
    ds_bpermute_b32 v45, v9, v17
    ds_bpermute_b32 v46, v9, v18
    ds_bpermute_b32 v47, v9, v19
    ds_bpermute_b32 v48, v9, v20
    ds_bpermute_b32 v49, v9, v21
    ds_bpermute_b32 v50, v9, v22
    ds_bpermute_b32 v51, v9, v23
    ds_bpermute_b32 v52, v9, v24
    ds_bpermute_b32 v53, v9, v25
    ds_bpermute_b32 v54, v9, v26
    ds_bpermute_b32 v55, v9, v27
    ds_bpermute_b32 v56, v9, v28
    ds_bpermute_b32 v57, v9, v29
    ds_bpermute_b32 v58, v9, v30
    ds_bpermute_b32 v59, v9, v31
    ds_bpermute_b32 v60, v9, v32
    ds_bpermute_b32 v61, v9, v33
    ds_bpermute_b32 v62, v9, v34
    ds_bpermute_b32 v63, v9, v35
    v_dot2_f32_bf16 v40, v16, s29, v40
    v_dot2_f32_bf16 v41, v16, v16, v41
    v_dot2_f32_bf16 v40, v17, s29, v40
    v_dot2_f32_bf16 v41, v17, v17, v41
    v_dot2_f32_bf16 v40, v18, s29, v40
    v_dot2_f32_bf16 v41, v18, v18, v41
    v_dot2_f32_bf16 v40, v19, s29, v40
    v_dot2_f32_bf16 v41, v19, v19, v41
    v_dot2_f32_bf16 v40, v20, s29, v40
    v_dot2_f32_bf16 v41, v20, v20, v41
    v_dot2_f32_bf16 v40, v21, s29, v40
    v_dot2_f32_bf16 v41, v21, v21, v41
    v_dot2_f32_bf16 v40, v22, s29, v40
    v_dot2_f32_bf16 v41, v22, v22, v41
    v_dot2_f32_bf16 v40, v23, s29, v40
    v_dot2_f32_bf16 v41, v23, v23, v41
    v_dot2_f32_bf16 v40, v24, s29, v40
    v_dot2_f32_bf16 v41, v24, v24, v41
    v_dot2_f32_bf16 v40, v25, s29, v40
    v_dot2_f32_bf16 v41, v25, v25, v41
    v_dot2_f32_bf16 v40, v26, s29, v40
    v_dot2_f32_bf16 v41, v26, v26, v41
    v_dot2_f32_bf16 v40, v27, s29, v40
    v_dot2_f32_bf16 v41, v27, v27, v41
    v_dot2_f32_bf16 v40, v28, s29, v40
    v_dot2_f32_bf16 v41, v28, v28, v41
    v_dot2_f32_bf16 v40, v29, s29, v40
    v_dot2_f32_bf16 v41, v29, v29, v41
    v_dot2_f32_bf16 v40, v30, s29, v40
    v_dot2_f32_bf16 v41, v30, v30, v41
    v_dot2_f32_bf16 v40, v31, s29, v40
    v_dot2_f32_bf16 v41, v31, v31, v41
    v_dot2_f32_bf16 v40, v32, s29, v40
    v_dot2_f32_bf16 v41, v32, v32, v41
    v_dot2_f32_bf16 v40, v33, s29, v40
    v_dot2_f32_bf16 v41, v33, v33, v41
    v_dot2_f32_bf16 v40, v34, s29, v40
    v_dot2_f32_bf16 v41, v34, v34, v41
    v_dot2_f32_bf16 v40, v35, s29, v40
    v_dot2_f32_bf16 v41, v35, v35, v41
    s_nop 1
    v_add_f32_dpp v40, v40, v40 row_ror:8 row_mask:0xf bank_mask:0xf
    v_add_f32_dpp v41, v41, v41 row_ror:8 row_mask:0xf bank_mask:0xf
    s_nop 0
    v_add_f32_dpp v40, v40, v40 row_ror:4 row_mask:0xf bank_mask:0xf
    v_add_f32_dpp v41, v41, v41 row_ror:4 row_mask:0xf bank_mask:0xf
    s_nop 0
    v_add_f32_dpp v40, v40, v40 row_ror:2 row_mask:0xf bank_mask:0xf
    v_add_f32_dpp v41, v41, v41 row_ror:2 row_mask:0xf bank_mask:0xf
    s_nop 0
    v_add_f32_dpp v40, v40, v40 row_ror:1 row_mask:0xf bank_mask:0xf
    v_add_f32_dpp v41, v41, v41 row_ror:1 row_mask:0xf bank_mask:0xf
    v_mul_f32 v40, 987991609, v40
    v_mul_f32 v41, 987991609, v41
    v_fma_f32 v41, -v40, v40, v41
    v_max_f32 v41, 0, v41
    v_add_f32 v41, 925353388, v41
    v_rsq_f32 v41, v41
    v_mul_f32 v40, -1.0, v40
    v_mul_f32 v40, v40, v41
    ds_bpermute_b32 v42, v9, v40
    ds_bpermute_b32 v43, v9, v41
    s_mov_b32 s29, 0xffff0000
    s_waitcnt lgkmcnt(0)
    v_lshlrev_b32 v11, 16, v44
    v_and_b32 v12, s29, v44
    v_fma_f32 v11, v11, v43, v42
    v_fma_f32 v12, v12, v43, v42
    v_cvt_pk_bf16_f32 v16, v11, v12
    v_lshlrev_b32 v11, 16, v45
    v_and_b32 v12, s29, v45
    v_fma_f32 v11, v11, v43, v42
    v_fma_f32 v12, v12, v43, v42
    v_cvt_pk_bf16_f32 v17, v11, v12
    v_lshlrev_b32 v11, 16, v46
    v_and_b32 v12, s29, v46
    v_fma_f32 v11, v11, v43, v42
    v_fma_f32 v12, v12, v43, v42
    v_cvt_pk_bf16_f32 v18, v11, v12
    v_lshlrev_b32 v11, 16, v47
    v_and_b32 v12, s29, v47
    v_fma_f32 v11, v11, v43, v42
    v_fma_f32 v12, v12, v43, v42
    v_cvt_pk_bf16_f32 v19, v11, v12
    v_min_u32 v16, -2, v16
    s_add_u32 s23, s21, 0
    buffer_store_dwordx4 v[16:19], v10, s[8:11], s23 offen
    v_lshlrev_b32 v11, 16, v48
    v_and_b32 v12, s29, v48
    v_fma_f32 v11, v11, v43, v42
    v_fma_f32 v12, v12, v43, v42
    v_cvt_pk_bf16_f32 v20, v11, v12
    v_lshlrev_b32 v11, 16, v49
    v_and_b32 v12, s29, v49
    v_fma_f32 v11, v11, v43, v42
    v_fma_f32 v12, v12, v43, v42
    v_cvt_pk_bf16_f32 v21, v11, v12
    v_lshlrev_b32 v11, 16, v50
    v_and_b32 v12, s29, v50
    v_fma_f32 v11, v11, v43, v42
    v_fma_f32 v12, v12, v43, v42
    v_cvt_pk_bf16_f32 v22, v11, v12
    v_lshlrev_b32 v11, 16, v51
    v_and_b32 v12, s29, v51
    v_fma_f32 v11, v11, v43, v42
    v_fma_f32 v12, v12, v43, v42
    v_cvt_pk_bf16_f32 v23, v11, v12
    v_min_u32 v20, -2, v20
    s_add_u32 s23, s21, 4096
    buffer_store_dwordx4 v[20:23], v10, s[8:11], s23 offen
    v_lshlrev_b32 v11, 16, v52
    v_and_b32 v12, s29, v52
    v_fma_f32 v11, v11, v43, v42
    v_fma_f32 v12, v12, v43, v42
    v_cvt_pk_bf16_f32 v24, v11, v12
    v_lshlrev_b32 v11, 16, v53
    v_and_b32 v12, s29, v53
    v_fma_f32 v11, v11, v43, v42
    v_fma_f32 v12, v12, v43, v42
    v_cvt_pk_bf16_f32 v25, v11, v12
    v_lshlrev_b32 v11, 16, v54
    v_and_b32 v12, s29, v54
    v_fma_f32 v11, v11, v43, v42
    v_fma_f32 v12, v12, v43, v42
    v_cvt_pk_bf16_f32 v26, v11, v12
    v_lshlrev_b32 v11, 16, v55
    v_and_b32 v12, s29, v55
    v_fma_f32 v11, v11, v43, v42
    v_fma_f32 v12, v12, v43, v42
    v_cvt_pk_bf16_f32 v27, v11, v12
    v_min_u32 v24, -2, v24
    s_add_u32 s23, s21, 8192
    buffer_store_dwordx4 v[24:27], v10, s[8:11], s23 offen
    v_lshlrev_b32 v11, 16, v56
    v_and_b32 v12, s29, v56
    v_fma_f32 v11, v11, v43, v42
    v_fma_f32 v12, v12, v43, v42
    v_cvt_pk_bf16_f32 v28, v11, v12
    v_lshlrev_b32 v11, 16, v57
    v_and_b32 v12, s29, v57
    v_fma_f32 v11, v11, v43, v42
    v_fma_f32 v12, v12, v43, v42
    v_cvt_pk_bf16_f32 v29, v11, v12
    v_lshlrev_b32 v11, 16, v58
    v_and_b32 v12, s29, v58
    v_fma_f32 v11, v11, v43, v42
    v_fma_f32 v12, v12, v43, v42
    v_cvt_pk_bf16_f32 v30, v11, v12
    v_lshlrev_b32 v11, 16, v59
    v_and_b32 v12, s29, v59
    v_fma_f32 v11, v11, v43, v42
    v_fma_f32 v12, v12, v43, v42
    v_cvt_pk_bf16_f32 v31, v11, v12
    v_min_u32 v28, -2, v28
    s_add_u32 s23, s21, 12288
    buffer_store_dwordx4 v[28:31], v10, s[8:11], s23 offen
    s_mov_b32 exec_hi, 0
    v_lshlrev_b32 v11, 16, v60
    v_and_b32 v12, s29, v60
    v_fma_f32 v11, v11, v43, v42
    v_fma_f32 v12, v12, v43, v42
    v_cvt_pk_bf16_f32 v32, v11, v12
    v_lshlrev_b32 v11, 16, v61
    v_and_b32 v12, s29, v61
    v_fma_f32 v11, v11, v43, v42
    v_fma_f32 v12, v12, v43, v42
    v_cvt_pk_bf16_f32 v33, v11, v12
    v_lshlrev_b32 v11, 16, v62
    v_and_b32 v12, s29, v62
    v_fma_f32 v11, v11, v43, v42
    v_fma_f32 v12, v12, v43, v42
    v_cvt_pk_bf16_f32 v34, v11, v12
    v_lshlrev_b32 v11, 16, v63
    v_and_b32 v12, s29, v63
    v_fma_f32 v11, v11, v43, v42
    v_fma_f32 v12, v12, v43, v42
    v_cvt_pk_bf16_f32 v35, v11, v12
    v_min_u32 v32, -2, v32
    s_add_u32 s23, s21, 16384
    buffer_store_dwordx4 v[32:35], v10, s[8:11], s23 offen
    s_endpgm
K0_T6:
    v_lshlrev_b32 v4, 4, v1
    v_mov_b32 v16, -1
    v_mov_b32 v17, -1
    v_mov_b32 v18, -1
    v_mov_b32 v19, -1
    v_mov_b32 v24, 0x3f803f80
    v_mov_b32 v25, v24
    v_mov_b32 v26, v24
    v_mov_b32 v27, v24
    s_sub_u32 s20, s2, 72
    s_lshl_b32 s19, s20, 2
    s_and_b32 s19, s19, 0x1ff
    v_add_u32 v5, s19, v1
    v_mul_u32_u24 v6, 3277, v5
    v_lshrrev_b32 v6, 16, v6
    v_mul_u32_u24 v6, 20, v6
    v_sub_u32 v5, v5, v6
    s_cmp_lt_u32 s20, 80
    s_cselect_b32 s20, 18, 32
    v_cmp_eq_u32 s[26:27], 18, v5
    s_nop 1
    v_cndmask_b32 v20, 0, v24, s[26:27]
    v_cmp_gt_u32 s[26:27], s20, v5
    s_nop 1
    v_cndmask_b32 v20, v20, -1, s[26:27]
    v_mov_b32 v21, v20
    v_mov_b32 v22, v20
    v_mov_b32 v23, v20
    s_lshl_b32 s21, s2, 10
    s_add_u32 s21, s21, 16515072
    s_add_u32 s22, s21, 253952
    s_mul_i32 s23, s2, 9216
    s_add_u32 s23, s23, 7077888
    s_add_u32 s24, s23, 4096
    s_add_u32 s25, s23, 8192
    s_waitcnt lgkmcnt(0)
    s_cmp_ge_u32 s2, 248
    s_cbranch_scc1 K0_T6A
    buffer_store_dwordx4 v[20:23], v4, s[8:11], s21 offen
    buffer_store_dwordx4 v[20:23], v4, s[8:11], s22 offen
K0_T6A:
    buffer_store_dwordx4 v[16:19], v4, s[8:11], s23 offen offset:0
    buffer_store_dwordx4 v[16:19], v4, s[8:11], s23 offen offset:1024
    buffer_store_dwordx4 v[16:19], v4, s[8:11], s23 offen offset:2048
    buffer_store_dwordx4 v[16:19], v4, s[8:11], s23 offen offset:3072
    buffer_store_dwordx4 v[16:19], v4, s[8:11], s24 offen offset:0
    buffer_store_dwordx4 v[16:19], v4, s[8:11], s24 offen offset:1024
    buffer_store_dwordx4 v[16:19], v4, s[8:11], s24 offen offset:2048
    buffer_store_dwordx4 v[16:19], v4, s[8:11], s24 offen offset:3072
    buffer_store_dwordx4 v[16:19], v4, s[8:11], s25 offen offset:0
    s_cmp_ge_u32 s2, 144
    s_cbranch_scc1 K0_END
    v_mov_b32 v28, 0
    v_mov_b32 v29, 0
    v_mov_b32 v30, 0
    v_mov_b32 v31, 0
    v_and_b32 v5, 3, v1
    v_bfe_u32 v6, v1, 2, 2
    v_lshlrev_b32 v5, 4, v5
    v_lshl_add_u32 v5, v6, 8, v5
    v_mul_u32_u24 v6, 7168, v3
    v_add_u32 v5, v5, v6
    s_mul_i32 s20, s2, 14336
    s_add_u32 s20, s20, 17037504
    v_and_b32 v6, 7, v1
    v_lshrrev_b32 v7, 3, v1
    v_lshlrev_b32 v8, 4, v6
    v_lshl_add_u32 v8, v7, 8, v8
    s_mul_i32 s21, s2, 5120
    s_add_u32 s22, s21, 19839008
    s_add_u32 s21, s21, 19099776
    v_lshrrev_b32 v9, 1, v6
    v_lshlrev_b32 v9, 6, v9
    v_and_b32 v10, 1, v6
    v_lshl_add_u32 v9, v10, 4, v9
    v_lshl_add_u32 v9, v7, 8, v9
    v_cmp_eq_u32 s[26:27], 0, v6
    s_nop 1
    v_cndmask_b32 v24, 0, v24, s[26:27]
    v_mov_b32 v25, v24
    v_mov_b32 v26, v24
    v_mov_b32 v27, v24
    s_mov_b32 exec_hi, 0
    buffer_store_dwordx4 v[28:31], v5, s[8:11], s20 offen
    buffer_store_dwordx4 v[28:31], v8, s[8:11], s21 offen
    s_cmp_ge_u32 s2, 108
    s_cselect_b32 exec_lo, -1, 0x03030303
    buffer_store_dwordx4 v[24:27], v9, s[8:11], s22 offen
K0_END:
    s_endpgm
K0_T7:
    s_cmp_ge_u32 s3, 3
    s_cbranch_scc1 K0_END
    s_sub_u32 s16, s2, 220
    s_mul_i32 s16, s16, 3
    s_add_u32 s16, s16, s3
    s_cmp_lt_u32 s16, 80
    s_cbranch_scc1 K0_T5B
    s_endpgm
.globl main_kernel
.p2align 8
.type main_kernel,@function
main_kernel:
    s_load_dwordx2 s[8:9], s[0:1], 80
    s_load_dwordx2 s[12:13], s[0:1], 64
    s_cmp_ge_u32 s2, 256
    s_cbranch_scc1 P4_END
    s_mov_b32 s10, 21237760
    s_mov_b32 s11, 0x20000
    s_mov_b32 s14, 2359296
    s_mov_b32 s15, 0x20000
    v_lshrrev_b32 v4, 6, v0
    v_and_b32 v1, 63, v0
    v_readfirstlane_b32 s3, v4
    s_mov_b32 s45, 0
MID:
    v_lshlrev_b32 v5, 4, v1
    s_mul_i32 s44, s45, 2359296
    s_mov_b32 s46, 0
    s_and_b32 s18, s2, 7
    s_lshr_b32 s19, s2, 3
    s_lshr_b32 s16, s18, 1
    s_lshl_b32 s16, s16, 2
    s_and_b32 s20, s19, 3
    s_add_u32 s16, s16, s20
    s_and_b32 s17, s18, 1
    s_lshl_b32 s17, s17, 3
    s_lshr_b32 s20, s19, 2
    s_add_u32 s17, s17, s20
    s_cmp_lt_u32 s3, 4
    s_cbranch_scc1 P1_COMP
    s_sub_u32 s6, s3, 4
    s_lshl_b32 s7, s6, 10
    s_lshl_b32 s24, s16, 3
    s_sub_u32 s25, s24, 1
    s_max_i32 s25, s25, 0
    s_mul_i32 s25, s25, 18432
    s_add_u32 s25, s25, s44
    s_and_b32 s27, s17, 7
    s_mul_i32 s28, s27, 92160
    s_add_u32 s28, s28, s7
    s_add_u32 s29, s28, 19834880
    s_add_u32 s28, s28, 19095552
    s_lshl_b32 s47, s16, 4
    s_add_u32 s47, s47, s17
    s_mul_i32 s47, s47, 9216
    s_lshl_b32 s31, s6, 11
    s_add_u32 s47, s47, s31
    s_waitcnt lgkmcnt(0)
    s_cmp_lg_u32 s45, 0
    s_cbranch_scc1 H_WARM
    s_mul_i32 s20, s17, 129024
    s_lshl_b32 s21, s6, 11
    s_add_u32 s20, s20, s21
    s_add_u32 s20, s20, 17031168
    s_add_u32 s22, s20, 1024
    s_movk_i32 s23, 7168
    s_cmp_eq_u32 s6, 3
    s_cselect_b32 s23, 1024, s23
    s_cselect_b32 s22, s25, s22
    s_waitcnt lgkmcnt(0)
    s_load_dwordx2 s[36:37], s[0:1], 0
    s_mov_b32 m0, s21
    s_add_u32 s21, s21, 1024
    buffer_load_dwordx4 v5, s[8:11], s20 offen lds
    s_mov_b32 m0, s21
    s_add_u32 s21, s21, 7168
    buffer_load_dwordx4 v5, s[8:11], s22 offen lds
    s_add_u32 s20, s20, 7168
    s_add_u32 s22, s22, s23
    s_mov_b32 m0, s21
    s_add_u32 s21, s21, 1024
    buffer_load_dwordx4 v5, s[8:11], s20 offen lds
    s_mov_b32 m0, s21
    s_add_u32 s21, s21, 7168
    buffer_load_dwordx4 v5, s[8:11], s22 offen lds
    s_add_u32 s20, s20, 7168
    s_add_u32 s22, s22, s23
    s_mov_b32 m0, s21
    s_add_u32 s21, s21, 1024
    buffer_load_dwordx4 v5, s[8:11], s20 offen lds
    s_mov_b32 m0, s21
    s_add_u32 s21, s21, 7168
    buffer_load_dwordx4 v5, s[8:11], s22 offen lds
    s_add_u32 s20, s20, 7168
    s_add_u32 s22, s22, s23
    s_mov_b32 m0, s21
    s_add_u32 s21, s21, 1024
    buffer_load_dwordx4 v5, s[8:11], s20 offen lds
    s_mov_b32 m0, s21
    s_add_u32 s21, s21, 7168
    buffer_load_dwordx4 v5, s[8:11], s22 offen lds
    s_add_u32 s20, s20, 7168
    s_add_u32 s22, s22, s23
    s_mov_b32 m0, s21
    s_add_u32 s21, s21, 1024
    buffer_load_dwordx4 v5, s[8:11], s20 offen lds
    s_mov_b32 m0, s21
    s_add_u32 s21, s21, 7168
    buffer_load_dwordx4 v5, s[8:11], s22 offen lds
    s_add_u32 s20, s20, 7168
    s_add_u32 s22, s22, s23
    s_mov_b32 m0, s21
    s_add_u32 s21, s21, 1024
    buffer_load_dwordx4 v5, s[8:11], s20 offen lds
    s_mov_b32 m0, s21
    s_add_u32 s21, s21, 7168
    buffer_load_dwordx4 v5, s[8:11], s22 offen lds
    s_add_u32 s20, s20, 7168
    s_add_u32 s22, s22, s23
    s_mov_b32 s38, 2359296
    s_mov_b32 s39, 0x20000
    s_lshl_b32 s30, s16, 1
    s_lshr_b32 s31, s17, 3
    s_add_u32 s30, s30, s31
    s_lshl_b32 s30, s30, 2
    s_add_u32 s30, s30, s6
    s_mul_i32 s32, s30, 18432
    s_mul_i32 s31, s27, 144
    s_add_u32 s32, s32, s31
    s_waitcnt lgkmcnt(0)
    s_add_u32 s30, s7, 2048
    s_cmp_ge_u32 s6, 2
    s_cselect_b32 s31, 7168, s30
    s_cselect_b32 s30, s30, 7168
    v_add_u32 v12, s31, v5
    v_add_u32 v13, s30, v5
    v_add_u32 v14, 6144, v5
    v_mov_b32 v16, 0
    v_mov_b32 v17, 0
    v_mov_b32 v18, 0
    v_mov_b32 v19, 0
    v_mov_b32 v20, 0
    v_mov_b32 v21, 0
    v_mov_b32 v22, 0
    v_mov_b32 v23, 0
    v_mov_b32 v248, -1
    v_mov_b32 v249, -1
    v_mov_b32 v250, -1
    v_mov_b32 v251, -1
    s_add_u32 s47, s47, 9437184
    s_lshl_b32 s34, s16, 4
    s_add_u32 s34, s34, s17
    s_lshl_b32 s35, s34, 10
    s_lshl_b32 s34, s34, 13
    s_lshl_b32 s33, s6, 11
    s_add_u32 s34, s34, s33
    s_add_u32 s34, s34, 14155776
    s_add_u32 s35, s35, 16252928
    s_add_u32 s33, s47, 8192
    s_cmp_eq_u32 s6, 0
    s_cselect_b32 s35, s33, s35
    s_waitcnt vmcnt(8)
    s_barrier
    s_mov_b32 m0, s21
    s_add_u32 s21, s21, 1024
    buffer_load_dwordx4 v5, s[8:11], s20 offen lds
    s_mov_b32 m0, s21
    s_add_u32 s21, s21, 7168
    buffer_load_dwordx4 v5, s[8:11], s22 offen lds
    s_add_u32 s20, s20, 7168
    s_add_u32 s22, s22, s23
    s_mov_b32 m0, s21
    s_add_u32 s21, s21, 1024
    buffer_load_dwordx4 v5, s[8:11], s20 offen lds
    s_mov_b32 m0, s21
    s_add_u32 s21, s21, 7168
    buffer_load_dwordx4 v5, s[8:11], s22 offen lds
    s_add_u32 s20, s20, 7168
    s_add_u32 s22, s22, s23
    s_setprio 2
    ds_read_b128 v[24:27], v12 offset:0
    ds_read_b128 v[28:31], v13 offset:0
    ds_read_b128 v[36:39], v12 offset:8192
    ds_read_b128 v[40:43], v13 offset:8192
    s_cmp_lg_u32 s6, 0
    s_cbranch_scc1 H_NR0
    ds_read_b128 v[32:35], v14 offset:0
    ds_read_b128 v[44:47], v14 offset:8192
    s_waitcnt lgkmcnt(0)
    v_mfma_f32_16x16x32_bf16 v[20:23], v[32:35], v[28:31], v[20:23]
    v_mfma_f32_16x16x32_bf16 v[20:23], v[44:47], v[40:43], v[20:23]
H_NR0:
    s_waitcnt lgkmcnt(0)
    v_mfma_f32_16x16x32_bf16 v[16:19], v[24:27], v[28:31], v[16:19]
    v_mfma_f32_16x16x32_bf16 v[16:19], v[36:39], v[40:43], v[16:19]
    v_add_u32 v12, 16384, v12
    v_add_u32 v13, 16384, v13
    v_add_u32 v14, 16384, v14
    s_setprio 0
    s_waitcnt vmcnt(8)
    s_barrier
    s_mov_b32 m0, s21
    s_add_u32 s21, s21, 1024
    buffer_load_dwordx4 v5, s[8:11], s20 offen lds
    s_mov_b32 m0, s21
    s_add_u32 s21, s21, 7168
    buffer_load_dwordx4 v5, s[8:11], s22 offen lds
    s_add_u32 s20, s20, 7168
    s_add_u32 s22, s22, s23
    s_mov_b32 m0, s21
    s_add_u32 s21, s21, 1024
    buffer_load_dwordx4 v5, s[8:11], s20 offen lds
    s_mov_b32 m0, s21
    s_add_u32 s21, s21, 7168
    buffer_load_dwordx4 v5, s[8:11], s22 offen lds
    s_add_u32 s20, s20, 7168
    s_add_u32 s22, s22, s23
    s_setprio 2
    ds_read_b128 v[24:27], v12 offset:0
    ds_read_b128 v[28:31], v13 offset:0
    ds_read_b128 v[36:39], v12 offset:8192
    ds_read_b128 v[40:43], v13 offset:8192
    s_cmp_lg_u32 s6, 0
    s_cbranch_scc1 H_NR1
    ds_read_b128 v[32:35], v14 offset:0
    ds_read_b128 v[44:47], v14 offset:8192
    s_waitcnt lgkmcnt(0)
    v_mfma_f32_16x16x32_bf16 v[20:23], v[32:35], v[28:31], v[20:23]
    v_mfma_f32_16x16x32_bf16 v[20:23], v[44:47], v[40:43], v[20:23]
H_NR1:
    s_waitcnt lgkmcnt(0)
    v_mfma_f32_16x16x32_bf16 v[16:19], v[24:27], v[28:31], v[16:19]
    v_mfma_f32_16x16x32_bf16 v[16:19], v[36:39], v[40:43], v[16:19]
    v_add_u32 v12, 16384, v12
    v_add_u32 v13, 16384, v13
    v_add_u32 v14, 16384, v14
    s_setprio 0
    s_waitcnt vmcnt(8)
    s_barrier
    s_mov_b32 m0, s21
    s_add_u32 s21, s21, 1024
    buffer_load_dwordx4 v5, s[8:11], s20 offen lds
    s_mov_b32 m0, s21
    s_add_u32 s21, s21, 7168
    buffer_load_dwordx4 v5, s[8:11], s22 offen lds
    s_add_u32 s20, s20, 7168
    s_add_u32 s22, s22, s23
    s_mov_b32 m0, s21
    s_add_u32 s21, s21, 1024
    buffer_load_dwordx4 v5, s[8:11], s20 offen lds
    s_mov_b32 m0, s21
    s_add_u32 s21, s21, 7168
    buffer_load_dwordx4 v5, s[8:11], s22 offen lds
    s_add_u32 s20, s20, 7168
    s_add_u32 s22, s22, s23
    s_setprio 2
    ds_read_b128 v[24:27], v12 offset:0
    ds_read_b128 v[28:31], v13 offset:0
    ds_read_b128 v[36:39], v12 offset:8192
    ds_read_b128 v[40:43], v13 offset:8192
    s_cmp_lg_u32 s6, 0
    s_cbranch_scc1 H_NR2
    ds_read_b128 v[32:35], v14 offset:0
    ds_read_b128 v[44:47], v14 offset:8192
    s_waitcnt lgkmcnt(0)
    v_mfma_f32_16x16x32_bf16 v[20:23], v[32:35], v[28:31], v[20:23]
    v_mfma_f32_16x16x32_bf16 v[20:23], v[44:47], v[40:43], v[20:23]
H_NR2:
    s_waitcnt lgkmcnt(0)
    v_mfma_f32_16x16x32_bf16 v[16:19], v[24:27], v[28:31], v[16:19]
    v_mfma_f32_16x16x32_bf16 v[16:19], v[36:39], v[40:43], v[16:19]
    v_add_u32 v12, 16384, v12
    v_add_u32 v13, 16384, v13
    v_add_u32 v14, 16384, v14
    s_setprio 0
    s_waitcnt vmcnt(8)
    s_barrier
    s_mov_b32 m0, s21
    s_add_u32 s21, s21, 1024
    buffer_load_dwordx4 v5, s[8:11], s20 offen lds
    s_mov_b32 m0, s21
    s_add_u32 s21, s21, 7168
    buffer_load_dwordx4 v5, s[8:11], s22 offen lds
    s_add_u32 s20, s20, 7168
    s_add_u32 s22, s22, s23
    s_mov_b32 m0, s21
    s_add_u32 s21, s21, 1024
    buffer_load_dwordx4 v5, s[8:11], s20 offen lds
    s_mov_b32 m0, s21
    s_add_u32 s21, s21, 7168
    buffer_load_dwordx4 v5, s[8:11], s22 offen lds
    s_add_u32 s20, s20, 7168
    s_add_u32 s22, s22, s23
    s_setprio 2
    ds_read_b128 v[24:27], v12 offset:0
    ds_read_b128 v[28:31], v13 offset:0
    ds_read_b128 v[36:39], v12 offset:8192
    ds_read_b128 v[40:43], v13 offset:8192
    s_cmp_lg_u32 s6, 0
    s_cbranch_scc1 H_NR3
    ds_read_b128 v[32:35], v14 offset:0
    ds_read_b128 v[44:47], v14 offset:8192
    s_waitcnt lgkmcnt(0)
    v_mfma_f32_16x16x32_bf16 v[20:23], v[32:35], v[28:31], v[20:23]
    v_mfma_f32_16x16x32_bf16 v[20:23], v[44:47], v[40:43], v[20:23]
H_NR3:
    s_waitcnt lgkmcnt(0)
    v_mfma_f32_16x16x32_bf16 v[16:19], v[24:27], v[28:31], v[16:19]
    v_mfma_f32_16x16x32_bf16 v[16:19], v[36:39], v[40:43], v[16:19]
    v_add_u32 v12, 16384, v12
    v_add_u32 v13, 16384, v13
    v_add_u32 v14, 16384, v14
    s_setprio 0
    s_waitcnt vmcnt(8)
    s_barrier
    s_mov_b32 m0, s21
    s_add_u32 s21, s21, 1024
    buffer_load_dwordx4 v5, s[8:11], s20 offen lds
    s_mov_b32 m0, s21
    s_add_u32 s21, s21, 7168
    buffer_load_dwordx4 v5, s[8:11], s22 offen lds
    s_add_u32 s20, s20, 7168
    s_add_u32 s22, s22, s23
    s_mov_b32 m0, s21
    s_add_u32 s21, s21, 1024
    buffer_load_dwordx4 v5, s[8:11], s20 offen lds
    s_mov_b32 m0, s21
    s_add_u32 s21, s21, 7168
    buffer_load_dwordx4 v5, s[8:11], s22 offen lds
    s_add_u32 s20, s20, 7168
    s_add_u32 s22, s22, s23
    buffer_store_dwordx4 v[248:251], v5, s[8:11], s47 offen offset:0 sc1
    s_setprio 2
    ds_read_b128 v[24:27], v12 offset:0
    ds_read_b128 v[28:31], v13 offset:0
    ds_read_b128 v[36:39], v12 offset:8192
    ds_read_b128 v[40:43], v13 offset:8192
    s_cmp_lg_u32 s6, 0
    s_cbranch_scc1 H_NR4
    ds_read_b128 v[32:35], v14 offset:0
    ds_read_b128 v[44:47], v14 offset:8192
    s_waitcnt lgkmcnt(0)
    v_mfma_f32_16x16x32_bf16 v[20:23], v[32:35], v[28:31], v[20:23]
    v_mfma_f32_16x16x32_bf16 v[20:23], v[44:47], v[40:43], v[20:23]
H_NR4:
    s_waitcnt lgkmcnt(0)
    v_mfma_f32_16x16x32_bf16 v[16:19], v[24:27], v[28:31], v[16:19]
    v_mfma_f32_16x16x32_bf16 v[16:19], v[36:39], v[40:43], v[16:19]
    v_add_u32 v12, 16384, v12
    v_add_u32 v13, 16384, v13
    v_add_u32 v14, 16384, v14
    s_setprio 0
    s_waitcnt vmcnt(9)
    s_barrier
    s_mov_b32 m0, s21
    s_add_u32 s21, s21, 1024
    buffer_load_dwordx4 v5, s[8:11], s20 offen lds
    s_mov_b32 m0, s21
    s_add_u32 s21, s21, 7168
    buffer_load_dwordx4 v5, s[8:11], s22 offen lds
    s_add_u32 s20, s20, 7168
    s_add_u32 s22, s22, s23
    s_mov_b32 m0, s21
    s_add_u32 s21, s21, 1024
    buffer_load_dwordx4 v5, s[8:11], s20 offen lds
    s_mov_b32 m0, s21
    s_add_u32 s21, s21, 7168
    buffer_load_dwordx4 v5, s[8:11], s22 offen lds
    s_add_u32 s20, s20, 7168
    s_add_u32 s22, s22, s23
    buffer_store_dwordx4 v[248:251], v5, s[8:11], s47 offen offset:1024 sc1
    s_setprio 2
    ds_read_b128 v[24:27], v12 offset:0
    ds_read_b128 v[28:31], v13 offset:0
    ds_read_b128 v[36:39], v12 offset:8192
    ds_read_b128 v[40:43], v13 offset:8192
    s_cmp_lg_u32 s6, 0
    s_cbranch_scc1 H_NR5
    ds_read_b128 v[32:35], v14 offset:0
    ds_read_b128 v[44:47], v14 offset:8192
    s_waitcnt lgkmcnt(0)
    v_mfma_f32_16x16x32_bf16 v[20:23], v[32:35], v[28:31], v[20:23]
    v_mfma_f32_16x16x32_bf16 v[20:23], v[44:47], v[40:43], v[20:23]
H_NR5:
    s_waitcnt lgkmcnt(0)
    v_mfma_f32_16x16x32_bf16 v[16:19], v[24:27], v[28:31], v[16:19]
    v_mfma_f32_16x16x32_bf16 v[16:19], v[36:39], v[40:43], v[16:19]
    v_add_u32 v12, 16384, v12
    v_add_u32 v13, 16384, v13
    v_add_u32 v14, 16384, v14
    s_setprio 0
    s_add_u32 m0, s7, 0
    s_add_u32 s30, s28, 0
    buffer_load_dwordx4 v5, s[8:11], s30 offen lds
    s_add_u32 m0, s7, 4096
    s_add_u32 s30, s28, 4096
    buffer_load_dwordx4 v5, s[8:11], s30 offen lds
    s_waitcnt vmcnt(12)
    s_barrier
    buffer_store_dwordx4 v[248:251], v5, s[8:11], s34 offen offset:0 sc1
    s_setprio 2
    ds_read_b128 v[24:27], v12 offset:0
    ds_read_b128 v[28:31], v13 offset:0
    ds_read_b128 v[36:39], v12 offset:8192
    ds_read_b128 v[40:43], v13 offset:8192
    s_cmp_lg_u32 s6, 0
    s_cbranch_scc1 H_NR6
    ds_read_b128 v[32:35], v14 offset:0
    ds_read_b128 v[44:47], v14 offset:8192
    s_waitcnt lgkmcnt(0)
    v_mfma_f32_16x16x32_bf16 v[20:23], v[32:35], v[28:31], v[20:23]
    v_mfma_f32_16x16x32_bf16 v[20:23], v[44:47], v[40:43], v[20:23]
H_NR6:
    s_waitcnt lgkmcnt(0)
    v_mfma_f32_16x16x32_bf16 v[16:19], v[24:27], v[28:31], v[16:19]
    v_mfma_f32_16x16x32_bf16 v[16:19], v[36:39], v[40:43], v[16:19]
    v_add_u32 v12, 16384, v12
    v_add_u32 v13, 16384, v13
    v_add_u32 v14, 16384, v14
    s_setprio 0
    s_add_u32 m0, s7, 8192
    s_add_u32 s30, s28, 8192
    buffer_load_dwordx4 v5, s[8:11], s30 offen lds
    s_add_u32 m0, s7, 12288
    s_add_u32 s30, s28, 12288
    buffer_load_dwordx4 v5, s[8:11], s30 offen lds
    s_add_u32 m0, s7, 16384
    s_add_u32 s30, s28, 16384
    buffer_load_dwordx4 v5, s[8:11], s30 offen lds
    s_add_u32 m0, s7, 20480
    s_add_u32 s30, s28, 20480
    buffer_load_dwordx4 v5, s[8:11], s30 offen lds
    s_waitcnt vmcnt(13)
    s_barrier
    buffer_store_dwordx4 v[248:251], v5, s[8:11], s34 offen offset:1024 sc1
    s_setprio 2
    ds_read_b128 v[24:27], v12 offset:0
    ds_read_b128 v[28:31], v13 offset:0
    ds_read_b128 v[36:39], v12 offset:8192
    ds_read_b128 v[40:43], v13 offset:8192
    s_cmp_lg_u32 s6, 0
    s_cbranch_scc1 H_NR7
    ds_read_b128 v[32:35], v14 offset:0
    ds_read_b128 v[44:47], v14 offset:8192
    s_waitcnt lgkmcnt(0)
    v_mfma_f32_16x16x32_bf16 v[20:23], v[32:35], v[28:31], v[20:23]
    v_mfma_f32_16x16x32_bf16 v[20:23], v[44:47], v[40:43], v[20:23]
H_NR7:
    s_waitcnt lgkmcnt(0)
    v_mfma_f32_16x16x32_bf16 v[16:19], v[24:27], v[28:31], v[16:19]
    v_mfma_f32_16x16x32_bf16 v[16:19], v[36:39], v[40:43], v[16:19]
    v_add_u32 v12, 16384, v12
    v_add_u32 v13, 16384, v13
    v_add_u32 v14, 16384, v14
    s_setprio 0
    s_add_u32 m0, s7, 24576
    s_add_u32 s30, s28, 24576
    buffer_load_dwordx4 v5, s[8:11], s30 offen lds
    s_add_u32 m0, s7, 28672
    s_add_u32 s30, s28, 28672
    buffer_load_dwordx4 v5, s[8:11], s30 offen lds
    s_add_u32 m0, s7, 32768
    s_add_u32 s30, s28, 32768
    buffer_load_dwordx4 v5, s[8:11], s30 offen lds
    s_add_u32 m0, s7, 36864
    s_add_u32 s30, s28, 36864
    buffer_load_dwordx4 v5, s[8:11], s30 offen lds
    s_add_u32 m0, s7, 40960
    s_add_u32 s30, s28, 40960
    buffer_load_dwordx4 v5, s[8:11], s30 offen lds
    s_add_u32 m0, s7, 45056
    s_add_u32 s30, s28, 45056
    buffer_load_dwordx4 v5, s[8:11], s30 offen lds
    s_waitcnt vmcnt(15)
    s_barrier
    buffer_store_dwordx4 v[248:251], v5, s[8:11], s35 offen offset:0 sc1
    s_setprio 2
    ds_read_b128 v[24:27], v12 offset:0
    ds_read_b128 v[28:31], v13 offset:0
    ds_read_b128 v[36:39], v12 offset:8192
    ds_read_b128 v[40:43], v13 offset:8192
    s_cmp_lg_u32 s6, 0
    s_cbranch_scc1 H_NR8
    ds_read_b128 v[32:35], v14 offset:0
    ds_read_b128 v[44:47], v14 offset:8192
    s_waitcnt lgkmcnt(0)
    v_mfma_f32_16x16x32_bf16 v[20:23], v[32:35], v[28:31], v[20:23]
    v_mfma_f32_16x16x32_bf16 v[20:23], v[44:47], v[40:43], v[20:23]
H_NR8:
    s_waitcnt lgkmcnt(0)
    v_mfma_f32_16x16x32_bf16 v[16:19], v[24:27], v[28:31], v[16:19]
    v_mfma_f32_16x16x32_bf16 v[16:19], v[36:39], v[40:43], v[16:19]
    v_add_u32 v12, 16384, v12
    v_add_u32 v13, 16384, v13
    v_add_u32 v14, 16384, v14
    s_setprio 0
    s_branch H_J1
H_WARM:
    s_add_u32 s30, s7, 2048
    s_cmp_ge_u32 s6, 2
    s_cselect_b32 s31, 7168, s30
    s_cselect_b32 s30, s30, 7168
    v_add_u32 v12, s31, v5
    v_add_u32 v13, s30, v5
    v_add_u32 v14, 6144, v5
    v_mov_b32 v16, 0
    v_mov_b32 v17, 0
    v_mov_b32 v18, 0
    v_mov_b32 v19, 0
    v_mov_b32 v20, 0
    v_mov_b32 v21, 0
    v_mov_b32 v22, 0
    v_mov_b32 v23, 0
    s_mul_i32 s20, s17, 129024
    s_add_u32 s20, s20, s7
    s_add_u32 s20, s20, 17117184
    s_add_u32 s21, s7, 98304
    s_cmp_eq_u32 s6, 3
    s_cselect_b32 s22, 0, 4096
    s_add_u32 m0, s21, 0
    s_add_u32 s23, s20, 0
    buffer_load_dwordx4 v5, s[8:11], s23 offen lds
    s_add_u32 m0, m0, s22
    s_add_u32 s23, s23, s22
    buffer_load_dwordx4 v5, s[8:11], s23 offen lds
    s_add_u32 m0, s21, 8192
    s_add_u32 s23, s20, 7168
    buffer_load_dwordx4 v5, s[8:11], s23 offen lds
    s_add_u32 m0, m0, s22
    s_add_u32 s23, s23, s22
    buffer_load_dwordx4 v5, s[8:11], s23 offen lds
    s_add_u32 s25, s25, s7
    s_mov_b32 s26, 0
    s_lshl_b32 s24, s6, 13
    v_add_u32 v6, s24, v5
    v_add_u32 v7, 0x10000, v6
    v_add_u32 v8, 0x20000, v6
    s_cmp_lt_u32 s6, 2
    s_cselect_b32 s24, 16384, 0
H_W4L:
    s_add_u32 s27, s25, 0
    buffer_load_dwordx4 v[24:27], v5, s[8:11], s27 offen sc1
    s_add_u32 s27, s25, 4096
    buffer_load_dwordx4 v[28:31], v5, s[8:11], s27 offen sc1
    s_add_u32 s27, s25, 8192
    buffer_load_dwordx4 v[32:35], v5, s[8:11], s27 offen sc1
    s_add_u32 s27, s25, 12288
    buffer_load_dwordx4 v[36:39], v5, s[8:11], s27 offen sc1
    s_add_u32 s27, s25, s24
    buffer_load_dwordx4 v[40:43], v5, s[8:11], s27 offen sc1
    s_waitcnt vmcnt(0)
    v_max3_u32 v9, v24, v28, v32
    v_max3_u32 v9, v36, v40, v9
    v_cmp_eq_u32 vcc, -1, v9
    s_add_u32 s26, s26, 1
    s_cbranch_vccz H_W4D
    s_sleep 2
    s_cmp_lt_u32 s26, 131072
    s_cbranch_scc1 H_W4L
H_W4D:
    ds_write_b128 v6, v[24:27] offset:7168
    ds_write_b128 v6, v[28:31] offset:39936
    ds_write_b128 v7, v[32:35] offset:7168
    ds_write_b128 v7, v[36:39] offset:39936
    s_cmp_ge_u32 s6, 2
    s_cbranch_scc1 H_W4E
    ds_write_b128 v8, v[40:43] offset:7168
H_W4E:
    s_lshl_b32 s24, s6, 2
    s_add_u32 s24, s24, 163584
    v_mov_b32 v6, s24
    v_and_b32 v7, 3, v1
    v_lshlrev_b32 v7, 2, v7
    v_add_u32 v7, 163584, v7
    ds_write_b32 v6, v6
    s_add_u32 m0, s21, 16384
    s_add_u32 s23, s20, 14336
    buffer_load_dwordx4 v5, s[8:11], s23 offen lds
    s_add_u32 m0, m0, s22
    s_add_u32 s23, s23, s22
    buffer_load_dwordx4 v5, s[8:11], s23 offen lds
    s_add_u32 m0, s21, 24576
    s_add_u32 s23, s20, 21504
    buffer_load_dwordx4 v5, s[8:11], s23 offen lds
    s_add_u32 m0, m0, s22
    s_add_u32 s23, s23, s22
    buffer_load_dwordx4 v5, s[8:11], s23 offen lds
    s_add_u32 m0, s21, 32768
    s_add_u32 s23, s20, 28672
    buffer_load_dwordx4 v5, s[8:11], s23 offen lds
    s_add_u32 m0, m0, s22
    s_add_u32 s23, s23, s22
    buffer_load_dwordx4 v5, s[8:11], s23 offen lds
    s_add_u32 m0, s21, 40960
    s_add_u32 s23, s20, 35840
    buffer_load_dwordx4 v5, s[8:11], s23 offen lds
    s_add_u32 m0, m0, s22
    s_add_u32 s23, s23, s22
    buffer_load_dwordx4 v5, s[8:11], s23 offen lds
H_W4F:
    ds_read_b32 v8, v7
    s_waitcnt lgkmcnt(0)
    v_cmp_eq_u32 vcc, 0, v8
    s_cbranch_vccz H_W4G
    s_sleep 1
    s_branch H_W4F
H_W4G:
    s_setprio 2
    ds_read_b128 v[24:27], v12 offset:0
    ds_read_b128 v[28:31], v13 offset:0
    ds_read_b128 v[36:39], v12 offset:8192
    ds_read_b128 v[40:43], v13 offset:8192
    ds_read_b128 v[48:51], v12 offset:16384
    ds_read_b128 v[52:55], v13 offset:16384
    ds_read_b128 v[60:63], v12 offset:24576
    ds_read_b128 v[64:67], v13 offset:24576
    ds_read_b128 v[72:75], v12 offset:32768
    ds_read_b128 v[76:79], v13 offset:32768
    ds_read_b128 v[84:87], v12 offset:40960
    ds_read_b128 v[88:91], v13 offset:40960
    s_cmp_lg_u32 s6, 0
    s_cbranch_scc1 H_NR9
    ds_read_b128 v[32:35], v14 offset:0
    ds_read_b128 v[44:47], v14 offset:8192
    ds_read_b128 v[56:59], v14 offset:16384
    ds_read_b128 v[68:71], v14 offset:24576
    ds_read_b128 v[80:83], v14 offset:32768
    ds_read_b128 v[92:95], v14 offset:40960
    s_waitcnt lgkmcnt(0)
    v_mfma_f32_16x16x32_bf16 v[20:23], v[32:35], v[28:31], v[20:23]
    v_mfma_f32_16x16x32_bf16 v[20:23], v[44:47], v[40:43], v[20:23]
    v_mfma_f32_16x16x32_bf16 v[20:23], v[56:59], v[52:55], v[20:23]
    v_mfma_f32_16x16x32_bf16 v[20:23], v[68:71], v[64:67], v[20:23]
    v_mfma_f32_16x16x32_bf16 v[20:23], v[80:83], v[76:79], v[20:23]
    v_mfma_f32_16x16x32_bf16 v[20:23], v[92:95], v[88:91], v[20:23]
H_NR9:
    s_waitcnt lgkmcnt(0)
    v_mfma_f32_16x16x32_bf16 v[16:19], v[24:27], v[28:31], v[16:19]
    v_mfma_f32_16x16x32_bf16 v[16:19], v[36:39], v[40:43], v[16:19]
    v_mfma_f32_16x16x32_bf16 v[16:19], v[48:51], v[52:55], v[16:19]
    v_mfma_f32_16x16x32_bf16 v[16:19], v[60:63], v[64:67], v[16:19]
    v_mfma_f32_16x16x32_bf16 v[16:19], v[72:75], v[76:79], v[16:19]
    v_mfma_f32_16x16x32_bf16 v[16:19], v[84:87], v[88:91], v[16:19]
    v_add_u32 v12, 49152, v12
    v_add_u32 v13, 49152, v13
    v_add_u32 v14, 49152, v14
    s_setprio 0
    s_setprio 2
    ds_read_b128 v[24:27], v12 offset:0
    ds_read_b128 v[28:31], v13 offset:0
    ds_read_b128 v[36:39], v12 offset:8192
    ds_read_b128 v[40:43], v13 offset:8192
    ds_read_b128 v[48:51], v12 offset:16384
    ds_read_b128 v[52:55], v13 offset:16384
    ds_read_b128 v[60:63], v12 offset:24576
    ds_read_b128 v[64:67], v13 offset:24576
    ds_read_b128 v[72:75], v12 offset:32768
    ds_read_b128 v[76:79], v13 offset:32768
    ds_read_b128 v[84:87], v12 offset:40960
    ds_read_b128 v[88:91], v13 offset:40960
    s_cmp_lg_u32 s6, 0
    s_cbranch_scc1 H_NR10
    ds_read_b128 v[32:35], v14 offset:0
    ds_read_b128 v[44:47], v14 offset:8192
    ds_read_b128 v[56:59], v14 offset:16384
    ds_read_b128 v[68:71], v14 offset:24576
    ds_read_b128 v[80:83], v14 offset:32768
    ds_read_b128 v[92:95], v14 offset:40960
    s_waitcnt lgkmcnt(0)
    v_mfma_f32_16x16x32_bf16 v[20:23], v[32:35], v[28:31], v[20:23]
    v_mfma_f32_16x16x32_bf16 v[20:23], v[44:47], v[40:43], v[20:23]
    v_mfma_f32_16x16x32_bf16 v[20:23], v[56:59], v[52:55], v[20:23]
    v_mfma_f32_16x16x32_bf16 v[20:23], v[68:71], v[64:67], v[20:23]
    v_mfma_f32_16x16x32_bf16 v[20:23], v[80:83], v[76:79], v[20:23]
    v_mfma_f32_16x16x32_bf16 v[20:23], v[92:95], v[88:91], v[20:23]
H_NR10:
    s_waitcnt lgkmcnt(0)
    v_mfma_f32_16x16x32_bf16 v[16:19], v[24:27], v[28:31], v[16:19]
    v_mfma_f32_16x16x32_bf16 v[16:19], v[36:39], v[40:43], v[16:19]
    v_mfma_f32_16x16x32_bf16 v[16:19], v[48:51], v[52:55], v[16:19]
    v_mfma_f32_16x16x32_bf16 v[16:19], v[60:63], v[64:67], v[16:19]
    v_mfma_f32_16x16x32_bf16 v[16:19], v[72:75], v[76:79], v[16:19]
    v_mfma_f32_16x16x32_bf16 v[16:19], v[84:87], v[88:91], v[16:19]
    v_add_u32 v12, 49152, v12
    v_add_u32 v13, 49152, v13
    v_add_u32 v14, 49152, v14
    s_setprio 0
    s_waitcnt vmcnt(0)
    s_barrier
    s_add_u32 m0, s7, 0
    s_add_u32 s30, s28, 0
    buffer_load_dwordx4 v5, s[8:11], s30 offen lds
    s_add_u32 m0, s7, 4096
    s_add_u32 s30, s28, 4096
    buffer_load_dwordx4 v5, s[8:11], s30 offen lds
    s_add_u32 m0, s7, 8192
    s_add_u32 s30, s28, 8192
    buffer_load_dwordx4 v5, s[8:11], s30 offen lds
    s_add_u32 m0, s7, 12288
    s_add_u32 s30, s28, 12288
    buffer_load_dwordx4 v5, s[8:11], s30 offen lds
    s_add_u32 m0, s7, 16384
    s_add_u32 s30, s28, 16384
    buffer_load_dwordx4 v5, s[8:11], s30 offen lds
    s_add_u32 m0, s7, 20480
    s_add_u32 s30, s28, 20480
    buffer_load_dwordx4 v5, s[8:11], s30 offen lds
    s_add_u32 m0, s7, 24576
    s_add_u32 s30, s28, 24576
    buffer_load_dwordx4 v5, s[8:11], s30 offen lds
    s_add_u32 m0, s7, 28672
    s_add_u32 s30, s28, 28672
    buffer_load_dwordx4 v5, s[8:11], s30 offen lds
    s_add_u32 m0, s7, 32768
    s_add_u32 s30, s28, 32768
    buffer_load_dwordx4 v5, s[8:11], s30 offen lds
    s_add_u32 m0, s7, 36864
    s_add_u32 s30, s28, 36864
    buffer_load_dwordx4 v5, s[8:11], s30 offen lds
    s_setprio 2
    ds_read_b128 v[24:27], v12 offset:0
    ds_read_b128 v[28:31], v13 offset:0
    ds_read_b128 v[36:39], v12 offset:8192
    ds_read_b128 v[40:43], v13 offset:8192
    ds_read_b128 v[48:51], v12 offset:16384
    ds_read_b128 v[52:55], v13 offset:16384
    ds_read_b128 v[60:63], v12 offset:24576
    ds_read_b128 v[64:67], v13 offset:24576
    ds_read_b128 v[72:75], v12 offset:32768
    ds_read_b128 v[76:79], v13 offset:32768
    ds_read_b128 v[84:87], v12 offset:40960
    ds_read_b128 v[88:91], v13 offset:40960
    s_cmp_lg_u32 s6, 0
    s_cbranch_scc1 H_NR11
    ds_read_b128 v[32:35], v14 offset:0
    ds_read_b128 v[44:47], v14 offset:8192
    ds_read_b128 v[56:59], v14 offset:16384
    ds_read_b128 v[68:71], v14 offset:24576
    ds_read_b128 v[80:83], v14 offset:32768
    ds_read_b128 v[92:95], v14 offset:40960
    s_waitcnt lgkmcnt(0)
    v_mfma_f32_16x16x32_bf16 v[20:23], v[32:35], v[28:31], v[20:23]
    v_mfma_f32_16x16x32_bf16 v[20:23], v[44:47], v[40:43], v[20:23]
    v_mfma_f32_16x16x32_bf16 v[20:23], v[56:59], v[52:55], v[20:23]
    v_mfma_f32_16x16x32_bf16 v[20:23], v[68:71], v[64:67], v[20:23]
    v_mfma_f32_16x16x32_bf16 v[20:23], v[80:83], v[76:79], v[20:23]
    v_mfma_f32_16x16x32_bf16 v[20:23], v[92:95], v[88:91], v[20:23]
H_NR11:
    s_waitcnt lgkmcnt(0)
    v_mfma_f32_16x16x32_bf16 v[16:19], v[24:27], v[28:31], v[16:19]
    v_mfma_f32_16x16x32_bf16 v[16:19], v[36:39], v[40:43], v[16:19]
    v_mfma_f32_16x16x32_bf16 v[16:19], v[48:51], v[52:55], v[16:19]
    v_mfma_f32_16x16x32_bf16 v[16:19], v[60:63], v[64:67], v[16:19]
    v_mfma_f32_16x16x32_bf16 v[16:19], v[72:75], v[76:79], v[16:19]
    v_mfma_f32_16x16x32_bf16 v[16:19], v[84:87], v[88:91], v[16:19]
    v_add_u32 v12, 49152, v12
    v_add_u32 v13, 49152, v13
    v_add_u32 v14, 49152, v14
    s_setprio 0
    s_add_u32 m0, s7, 40960
    s_add_u32 s30, s28, 40960
    buffer_load_dwordx4 v5, s[8:11], s30 offen lds
    s_add_u32 m0, s7, 45056
    s_add_u32 s30, s28, 45056
    buffer_load_dwordx4 v5, s[8:11], s30 offen lds
H_J1:
    v_and_b32 v2, 15, v1
    v_lshrrev_b32 v3, 4, v1
    v_cmp_gt_u32 s[40:41], 2, v3
    s_lshl_b32 s21, s6, 9
    s_add_u32 s21, s21, 147456
    v_lshlrev_b32 v6, 3, v1
    v_add_u32 v6, s21, v6
    v_cvt_pk_bf16_f32 v24, v16, v17
    v_cvt_pk_bf16_f32 v25, v18, v19
    ds_write_b64 v6, v[24:25]
    s_cmp_lg_u32 s6, 0
    s_cbranch_scc1 H_J2
    v_cvt_pk_bf16_f32 v26, v20, v21
    v_cvt_pk_bf16_f32 v27, v22, v23
    v_lshlrev_b32 v6, 2, v1
    v_add_u32 v6, 147456, v6
    v_cndmask_b32 v28, 0, v27, s[40:41]
    ds_write_b32 v6, v28 offset:2048
    v_lshlrev_b32 v7, 1, v2
    v_add_u32 v7, 158976, v7
    s_mov_b32 exec_lo, 0
    s_mov_b32 exec_hi, 0xffff
    ds_write_b16 v7, v26
    ds_write_b16_d16_hi v7, v26 offset:288
    ds_write_b16 v7, v27 offset:576
    ds_write_b16_d16_hi v7, v27 offset:864
    s_mov_b64 exec, -1
H_J2:
    s_add_u32 m0, s7, 49152
    s_add_u32 s30, s28, 49152
    buffer_load_dwordx4 v5, s[8:11], s30 offen lds
    s_add_u32 m0, s7, 53248
    s_add_u32 s30, s28, 53248
    buffer_load_dwordx4 v5, s[8:11], s30 offen lds
    s_add_u32 m0, s7, 57344
    s_add_u32 s30, s28, 57344
    buffer_load_dwordx4 v5, s[8:11], s30 offen lds
    s_add_u32 m0, s7, 61440
    s_add_u32 s30, s28, 61440
    buffer_load_dwordx4 v5, s[8:11], s30 offen lds
    s_add_u32 m0, s7, 65536
    s_add_u32 s30, s28, 65536
    buffer_load_dwordx4 v5, s[8:11], s30 offen lds
    s_add_u32 m0, s7, 69632
    s_add_u32 s30, s28, 69632
    buffer_load_dwordx4 v5, s[8:11], s30 offen lds
    s_add_u32 m0, s7, 73728
    s_add_u32 s30, s28, 73728
    buffer_load_dwordx4 v5, s[8:11], s30 offen lds
    s_add_u32 m0, s7, 77824
    s_add_u32 s30, s28, 77824
    buffer_load_dwordx4 v5, s[8:11], s30 offen lds
    s_add_u32 m0, s7, 81920
    s_add_u32 s30, s28, 81920
    buffer_load_dwordx4 v5, s[8:11], s30 offen lds
    s_add_u32 m0, s7, 86016
    s_add_u32 s30, s28, 86016
    buffer_load_dwordx4 v5, s[8:11], s30 offen lds
    s_cmp_lg_u32 s45, 0
    s_cbranch_scc1 H_J3
    s_waitcnt vmcnt(10)
H_J3:
    s_waitcnt lgkmcnt(0)
    s_barrier
    s_add_u32 m0, s7, 90112
    s_add_u32 s30, s28, 90112
    buffer_load_dwordx4 v5, s[8:11], s30 offen lds
    s_lshl_b32 s16, s16, 1
    s_lshr_b32 s18, s17, 3
    s_add_u32 s16, s16, s18
    s_and_b32 s17, s17, 7
    s_lshl_b32 s43, s16, 2
    s_add_u32 s43, s43, s6
    s_mul_i32 s18, s43, 18432
    v_add_u32 v10, 0x10000, v5
    v_add_u32 v11, 0x20000, v5
    s_add_u32 s24, s18, 7077888
    s_mul_i32 s20, s17, 2304
    s_add_u32 s19, s18, s20
    s_add_u32 s20, s19, 4718592
    v_lshrrev_b32 v12, 1, v3
    v_lshlrev_b32 v12, 8, v12
    v_lshl_add_u32 v12, v2, 4, v12
    v_and_b32 v4, 1, v3
    v_lshl_add_u32 v13, v4, 9, v12
    v_lshl_add_u32 v12, v4, 3, v12
    s_cmp_lg_u32 s45, 0
    s_cbranch_scc1 H_R2
    s_mul_i32 s33, s6, 3072
    s_add_u32 s33, s33, 135168
    v_add_u32 v6, 0, v1
    v_min_u32 v6, 143, v6
    v_mul_u32_u24 v7, 7282, v6
    v_lshrrev_b32 v7, 16, v7
    v_mul_u32_u24 v7, 1008, v7
    v_lshl_add_u32 v6, v6, 4, v7
    s_add_u32 m0, s33, 0
    s_nop 0
    buffer_load_dwordx4 v6, s[36:39], s32 offen lds
    v_add_u32 v6, 64, v1
    v_min_u32 v6, 143, v6
    v_mul_u32_u24 v7, 7282, v6
    v_lshrrev_b32 v7, 16, v7
    v_mul_u32_u24 v7, 1008, v7
    v_lshl_add_u32 v6, v6, 4, v7
    s_add_u32 m0, s33, 1024
    s_nop 0
    buffer_load_dwordx4 v6, s[36:39], s32 offen lds
    v_add_u32 v6, 128, v1
    v_min_u32 v6, 143, v6
    v_mul_u32_u24 v7, 7282, v6
    v_lshrrev_b32 v7, 16, v7
    v_mul_u32_u24 v7, 1008, v7
    v_lshl_add_u32 v6, v6, 4, v7
    s_add_u32 m0, s33, 2048
    s_nop 0
    buffer_load_dwordx4 v6, s[36:39], s32 offen lds
    v_mul_u32_u24 v6, 144, v2
    v_lshl_add_u32 v6, v3, 3, v6
    v_add_u32 v6, s33, v6
    s_waitcnt vmcnt(0)
    ds_read_b64 v[176:177], v6 offset:0
    ds_read_b64 v[178:179], v6 offset:32
    ds_read_b64 v[180:181], v6 offset:64
    ds_read_b64 v[182:183], v6 offset:96
    ds_read_b64 v[184:185], v6 offset:128
    s_branch H_NR
H_R2:
    s_waitcnt vmcnt(0)
    buffer_load_dwordx2 v[176:177], v12, s[8:11], s20 offen offset:0 sc1
    buffer_load_dwordx2 v[178:179], v12, s[8:11], s20 offen offset:512 sc1
    buffer_load_dwordx2 v[180:181], v12, s[8:11], s20 offen offset:1024 sc1
    buffer_load_dwordx2 v[182:183], v12, s[8:11], s20 offen offset:1536 sc1
    buffer_load_dwordx2 v[184:185], v12, s[8:11], s20 offen offset:2048 sc1
H_NR:
    s_mov_b32 s31, s29
    s_setprio 2
    s_add_u32 s25, s24, 4096
    s_add_u32 s26, s24, 8192
    s_add_u32 s27, s24, 12288
    s_add_u32 s28, s24, 16384
    s_waitcnt lgkmcnt(0)
    s_barrier
    ds_read_b128 v[88:91], v5 offset:0
    ds_read_b128 v[92:95], v5 offset:1024
    ds_read_b128 v[96:99], v5 offset:2048
    ds_read_b128 v[100:103], v5 offset:3072
    ds_read_b128 v[104:107], v5 offset:4096
    ds_read_b128 v[108:111], v5 offset:5120
    ds_read_b128 v[112:115], v5 offset:6144
    ds_read_b128 v[116:119], v5 offset:7168
    ds_read_b128 v[120:123], v5 offset:8192
    ds_read_b128 v[124:127], v5 offset:9216
    s_sleep 12
    buffer_load_dwordx4 v[16:19], v5, s[8:11], s24 offen offset:0 sc1
    buffer_load_dwordx4 v[20:23], v5, s[8:11], s24 offen offset:1024 sc1
    buffer_load_dwordx4 v[24:27], v5, s[8:11], s24 offen offset:2048 sc1
    buffer_load_dwordx4 v[28:31], v5, s[8:11], s24 offen offset:3072 sc1
    buffer_load_dwordx4 v[32:35], v5, s[8:11], s25 offen offset:0 sc1
    buffer_load_dwordx4 v[36:39], v5, s[8:11], s25 offen offset:1024 sc1
    buffer_load_dwordx4 v[40:43], v5, s[8:11], s25 offen offset:2048 sc1
    buffer_load_dwordx4 v[44:47], v5, s[8:11], s25 offen offset:3072 sc1
    buffer_load_dwordx4 v[48:51], v5, s[8:11], s26 offen offset:0 sc1
    buffer_load_dwordx4 v[52:55], v5, s[8:11], s26 offen offset:1024 sc1
    buffer_load_dwordx4 v[56:59], v5, s[8:11], s26 offen offset:2048 sc1
    buffer_load_dwordx4 v[60:63], v5, s[8:11], s26 offen offset:3072 sc1
    ds_read_b128 v[128:131], v5 offset:10240
    ds_read_b128 v[132:135], v5 offset:11264
    ds_read_b128 v[136:139], v5 offset:12288
    ds_read_b128 v[140:143], v5 offset:13312
    ds_read_b128 v[144:147], v5 offset:14336
    ds_read_b128 v[188:191], v5 offset:15360
    ds_read_b128 v[192:195], v5 offset:16384
    ds_read_b128 v[196:199], v5 offset:17408
    ds_read_b128 v[200:203], v5 offset:18432
    ds_read_b128 v[204:207], v5 offset:19456
    ds_read_b128 v[208:211], v5 offset:20480
    ds_read_b128 v[212:215], v5 offset:21504
    ds_read_b128 v[216:219], v5 offset:22528
    ds_read_b128 v[220:223], v5 offset:23552
    ds_read_b128 v[224:227], v5 offset:24576
    ds_read_b128 v[228:231], v5 offset:25600
    ds_read_b128 v[232:235], v5 offset:26624
    ds_read_b128 v[236:239], v5 offset:27648
    ds_read_b128 v[240:243], v5 offset:28672
    ds_read_b128 v[244:247], v5 offset:29696
    s_waitcnt vmcnt(10)
    v_max_u32 v15, v16, v20
    v_cmp_eq_u32 vcc, -1, v15
    s_cbranch_vccnz P2_R0
P2_R0B:
    s_waitcnt lgkmcnt(6)
    v_mfma_f32_16x16x32_bf16 v[148:151], v[88:91], v[16:19], 0
    ds_read_b128 v[88:91], v5 offset:30720
    v_mfma_f32_16x16x32_bf16 v[152:155], v[92:95], v[16:19], 0
    ds_read_b128 v[92:95], v5 offset:31744
    buffer_load_dwordx4 v[64:67], v5, s[8:11], s27 offen offset:0 sc1
    v_mfma_f32_16x16x32_bf16 v[156:159], v[96:99], v[16:19], 0
    ds_read_b128 v[96:99], v5 offset:32768
    v_mfma_f32_16x16x32_bf16 v[160:163], v[100:103], v[16:19], 0
    ds_read_b128 v[100:103], v5 offset:33792
    v_mfma_f32_16x16x32_bf16 v[164:167], v[104:107], v[16:19], 0
    v_mfma_f32_16x16x32_bf16 v[148:151], v[108:111], v[20:23], v[148:151]
    ds_read_b128 v[104:107], v5 offset:34816
    v_mfma_f32_16x16x32_bf16 v[152:155], v[112:115], v[20:23], v[152:155]
    ds_read_b128 v[108:111], v5 offset:35840
    buffer_load_dwordx4 v[68:71], v5, s[8:11], s27 offen offset:1024 sc1
    v_mfma_f32_16x16x32_bf16 v[156:159], v[116:119], v[20:23], v[156:159]
    ds_read_b128 v[112:115], v5 offset:36864
    v_mfma_f32_16x16x32_bf16 v[160:163], v[120:123], v[20:23], v[160:163]
    ds_read_b128 v[116:119], v5 offset:37888
    s_waitcnt vmcnt(10)
    v_max_u32 v15, v24, v28
    v_cmp_eq_u32 vcc, -1, v15
    v_mfma_f32_16x16x32_bf16 v[164:167], v[124:127], v[20:23], v[164:167]
    s_cbranch_vccnz P2_R1
P2_R1B:
    v_mfma_f32_16x16x32_bf16 v[148:151], v[128:131], v[24:27], v[148:151]
    ds_read_b128 v[120:123], v5 offset:38912
    v_mfma_f32_16x16x32_bf16 v[152:155], v[132:135], v[24:27], v[152:155]
    ds_read_b128 v[124:127], v5 offset:39936
    buffer_load_dwordx4 v[72:75], v5, s[8:11], s27 offen offset:2048 sc1
    v_mfma_f32_16x16x32_bf16 v[156:159], v[136:139], v[24:27], v[156:159]
    ds_read_b128 v[128:131], v5 offset:40960
    v_mfma_f32_16x16x32_bf16 v[160:163], v[140:143], v[24:27], v[160:163]
    ds_read_b128 v[132:135], v5 offset:41984
    v_mfma_f32_16x16x32_bf16 v[164:167], v[144:147], v[24:27], v[164:167]
    v_mfma_f32_16x16x32_bf16 v[148:151], v[188:191], v[28:31], v[148:151]
    ds_read_b128 v[136:139], v5 offset:43008
    v_mfma_f32_16x16x32_bf16 v[152:155], v[192:195], v[28:31], v[152:155]
    ds_read_b128 v[140:143], v5 offset:44032
    buffer_load_dwordx4 v[76:79], v5, s[8:11], s27 offen offset:3072 sc1
    v_mfma_f32_16x16x32_bf16 v[156:159], v[196:199], v[28:31], v[156:159]
    ds_read_b128 v[144:147], v5 offset:45056
    v_mfma_f32_16x16x32_bf16 v[160:163], v[200:203], v[28:31], v[160:163]
    ds_read_b128 v[188:191], v5 offset:46080
    s_waitcnt vmcnt(10)
    v_max_u32 v15, v32, v36
    v_cmp_eq_u32 vcc, -1, v15
    v_mfma_f32_16x16x32_bf16 v[164:167], v[204:207], v[28:31], v[164:167]
    s_cbranch_vccnz P2_R2
P2_R2B:
    s_waitcnt lgkmcnt(6)
    v_mfma_f32_16x16x32_bf16 v[148:151], v[208:211], v[32:35], v[148:151]
    ds_read_b128 v[192:195], v5 offset:47104
    v_mfma_f32_16x16x32_bf16 v[152:155], v[212:215], v[32:35], v[152:155]
    ds_read_b128 v[196:199], v5 offset:48128
    buffer_load_dwordx4 v[80:83], v5, s[8:11], s28 offen offset:0 sc1
    v_mfma_f32_16x16x32_bf16 v[156:159], v[216:219], v[32:35], v[156:159]
    ds_read_b128 v[200:203], v5 offset:49152
    v_mfma_f32_16x16x32_bf16 v[160:163], v[220:223], v[32:35], v[160:163]
    ds_read_b128 v[204:207], v5 offset:50176
    v_mfma_f32_16x16x32_bf16 v[164:167], v[224:227], v[32:35], v[164:167]
    s_barrier
    v_mfma_f32_16x16x32_bf16 v[148:151], v[228:231], v[36:39], v[148:151]
    ds_read_b128 v[208:211], v5 offset:51200
    v_mfma_f32_16x16x32_bf16 v[152:155], v[232:235], v[36:39], v[152:155]
    ds_read_b128 v[212:215], v5 offset:52224
    buffer_load_dwordx4 v[84:87], v5, s[8:11], s28 offen offset:1024 sc1
    v_mfma_f32_16x16x32_bf16 v[156:159], v[236:239], v[36:39], v[156:159]
    ds_read_b128 v[216:219], v5 offset:53248
    v_mfma_f32_16x16x32_bf16 v[160:163], v[240:243], v[36:39], v[160:163]
    ds_read_b128 v[220:223], v5 offset:54272
    s_waitcnt vmcnt(10)
    v_max_u32 v15, v40, v44
    v_cmp_eq_u32 vcc, -1, v15
    v_mfma_f32_16x16x32_bf16 v[164:167], v[244:247], v[36:39], v[164:167]
    s_cbranch_vccnz P2_R3
P2_R3B:
    v_mfma_f32_16x16x32_bf16 v[148:151], v[88:91], v[40:43], v[148:151]
    ds_read_b128 v[224:227], v5 offset:55296
    v_mfma_f32_16x16x32_bf16 v[152:155], v[92:95], v[40:43], v[152:155]
    ds_read_b128 v[228:231], v5 offset:56320
    v_mfma_f32_16x16x32_bf16 v[156:159], v[96:99], v[40:43], v[156:159]
    ds_read_b128 v[232:235], v5 offset:57344
    v_mfma_f32_16x16x32_bf16 v[160:163], v[100:103], v[40:43], v[160:163]
    ds_read_b128 v[236:239], v5 offset:58368
    v_mfma_f32_16x16x32_bf16 v[164:167], v[104:107], v[40:43], v[164:167]
    v_mfma_f32_16x16x32_bf16 v[148:151], v[108:111], v[44:47], v[148:151]
    ds_read_b128 v[240:243], v5 offset:59392
    v_mfma_f32_16x16x32_bf16 v[152:155], v[112:115], v[44:47], v[152:155]
    ds_read_b128 v[244:247], v5 offset:60416
    v_mfma_f32_16x16x32_bf16 v[156:159], v[116:119], v[44:47], v[156:159]
    ds_read_b128 v[88:91], v5 offset:61440
    v_mfma_f32_16x16x32_bf16 v[160:163], v[120:123], v[44:47], v[160:163]
    ds_read_b128 v[92:95], v5 offset:62464
    s_waitcnt vmcnt(8)
    v_max_u32 v15, v48, v52
    v_cmp_eq_u32 vcc, -1, v15
    v_mfma_f32_16x16x32_bf16 v[164:167], v[124:127], v[44:47], v[164:167]
    s_cbranch_vccnz P2_R4
P2_R4B:
    s_waitcnt lgkmcnt(6)
    v_mfma_f32_16x16x32_bf16 v[148:151], v[128:131], v[48:51], v[148:151]
    ds_read_b128 v[96:99], v5 offset:63488
    v_mfma_f32_16x16x32_bf16 v[152:155], v[132:135], v[48:51], v[152:155]
    ds_read_b128 v[100:103], v5 offset:64512
    v_mfma_f32_16x16x32_bf16 v[156:159], v[136:139], v[48:51], v[156:159]
    ds_read_b128 v[104:107], v10 offset:0
    v_mfma_f32_16x16x32_bf16 v[160:163], v[140:143], v[48:51], v[160:163]
    ds_read_b128 v[108:111], v10 offset:1024
    v_mfma_f32_16x16x32_bf16 v[164:167], v[144:147], v[48:51], v[164:167]
    v_mfma_f32_16x16x32_bf16 v[148:151], v[188:191], v[52:55], v[148:151]
    ds_read_b128 v[112:115], v10 offset:2048
    v_mfma_f32_16x16x32_bf16 v[152:155], v[192:195], v[52:55], v[152:155]
    ds_read_b128 v[116:119], v10 offset:3072
    v_mfma_f32_16x16x32_bf16 v[156:159], v[196:199], v[52:55], v[156:159]
    ds_read_b128 v[120:123], v10 offset:4096
    v_mfma_f32_16x16x32_bf16 v[160:163], v[200:203], v[52:55], v[160:163]
    ds_read_b128 v[124:127], v10 offset:5120
    s_waitcnt vmcnt(6)
    v_max_u32 v15, v56, v60
    v_cmp_eq_u32 vcc, -1, v15
    v_mfma_f32_16x16x32_bf16 v[164:167], v[204:207], v[52:55], v[164:167]
    s_cbranch_vccnz P2_R5
P2_R5B:
    v_mfma_f32_16x16x32_bf16 v[148:151], v[208:211], v[56:59], v[148:151]
    ds_read_b128 v[128:131], v10 offset:6144
    v_mfma_f32_16x16x32_bf16 v[152:155], v[212:215], v[56:59], v[152:155]
    ds_read_b128 v[132:135], v10 offset:7168
    v_mfma_f32_16x16x32_bf16 v[156:159], v[216:219], v[56:59], v[156:159]
    ds_read_b128 v[136:139], v10 offset:8192
    v_mfma_f32_16x16x32_bf16 v[160:163], v[220:223], v[56:59], v[160:163]
    ds_read_b128 v[140:143], v10 offset:9216
    v_mfma_f32_16x16x32_bf16 v[164:167], v[224:227], v[56:59], v[164:167]
    s_waitcnt lgkmcnt(6)
    v_mfma_f32_16x16x32_bf16 v[148:151], v[228:231], v[60:63], v[148:151]
    ds_read_b128 v[144:147], v10 offset:10240
    v_mfma_f32_16x16x32_bf16 v[152:155], v[232:235], v[60:63], v[152:155]
    ds_read_b128 v[188:191], v10 offset:11264
    v_mfma_f32_16x16x32_bf16 v[156:159], v[236:239], v[60:63], v[156:159]
    ds_read_b128 v[192:195], v10 offset:12288
    v_mfma_f32_16x16x32_bf16 v[160:163], v[240:243], v[60:63], v[160:163]
    ds_read_b128 v[196:199], v10 offset:13312
    s_waitcnt vmcnt(4)
    v_max_u32 v15, v64, v68
    v_cmp_eq_u32 vcc, -1, v15
    v_mfma_f32_16x16x32_bf16 v[164:167], v[244:247], v[60:63], v[164:167]
    s_cbranch_vccnz P2_R6
P2_R6B:
    v_mfma_f32_16x16x32_bf16 v[148:151], v[88:91], v[64:67], v[148:151]
    ds_read_b128 v[200:203], v10 offset:14336
    v_mfma_f32_16x16x32_bf16 v[152:155], v[92:95], v[64:67], v[152:155]
    ds_read_b128 v[204:207], v10 offset:15360
    v_mfma_f32_16x16x32_bf16 v[156:159], v[96:99], v[64:67], v[156:159]
    ds_read_b128 v[208:211], v10 offset:16384
    v_mfma_f32_16x16x32_bf16 v[160:163], v[100:103], v[64:67], v[160:163]
    ds_read_b128 v[212:215], v10 offset:17408
    v_mfma_f32_16x16x32_bf16 v[164:167], v[104:107], v[64:67], v[164:167]
    s_waitcnt lgkmcnt(6)
    v_mfma_f32_16x16x32_bf16 v[148:151], v[108:111], v[68:71], v[148:151]
    ds_read_b128 v[216:219], v10 offset:18432
    v_mfma_f32_16x16x32_bf16 v[152:155], v[112:115], v[68:71], v[152:155]
    ds_read_b128 v[220:223], v10 offset:19456
    v_mfma_f32_16x16x32_bf16 v[156:159], v[116:119], v[68:71], v[156:159]
    ds_read_b128 v[224:227], v10 offset:20480
    v_mfma_f32_16x16x32_bf16 v[160:163], v[120:123], v[68:71], v[160:163]
    ds_read_b128 v[228:231], v10 offset:21504
    s_waitcnt vmcnt(2)
    v_max_u32 v15, v72, v76
    v_cmp_eq_u32 vcc, -1, v15
    v_mfma_f32_16x16x32_bf16 v[164:167], v[124:127], v[68:71], v[164:167]
    s_cbranch_vccnz P2_R7
P2_R7B:
    v_mfma_f32_16x16x32_bf16 v[148:151], v[128:131], v[72:75], v[148:151]
    ds_read_b128 v[232:235], v10 offset:22528
    v_mfma_f32_16x16x32_bf16 v[152:155], v[132:135], v[72:75], v[152:155]
    ds_read_b128 v[236:239], v10 offset:23552
    v_mfma_f32_16x16x32_bf16 v[156:159], v[136:139], v[72:75], v[156:159]
    ds_read_b128 v[240:243], v10 offset:24576
    v_mfma_f32_16x16x32_bf16 v[160:163], v[140:143], v[72:75], v[160:163]
    ds_read_b128 v[244:247], v10 offset:25600
    v_mfma_f32_16x16x32_bf16 v[164:167], v[144:147], v[72:75], v[164:167]
    s_waitcnt lgkmcnt(6)
    v_mfma_f32_16x16x32_bf16 v[148:151], v[188:191], v[76:79], v[148:151]
    v_mfma_f32_16x16x32_bf16 v[152:155], v[192:195], v[76:79], v[152:155]
    v_mfma_f32_16x16x32_bf16 v[156:159], v[196:199], v[76:79], v[156:159]
    v_mfma_f32_16x16x32_bf16 v[160:163], v[200:203], v[76:79], v[160:163]
    s_waitcnt vmcnt(0)
    v_max_u32 v15, v80, v84
    v_max3_u32 v15, v82, v86, v15
    v_cmp_eq_u32 vcc, -1, v15
    v_mfma_f32_16x16x32_bf16 v[164:167], v[204:207], v[76:79], v[164:167]
    s_cbranch_vccnz P2_R8
P2_R8B:
    s_waitcnt lgkmcnt(5)
    v_mfma_f32_16x16x32_bf16 v[148:151], v[208:211], v[80:83], v[148:151]
    v_mfma_f32_16x16x32_bf16 v[152:155], v[212:215], v[80:83], v[152:155]
    v_mfma_f32_16x16x32_bf16 v[156:159], v[216:219], v[80:83], v[156:159]
    v_mfma_f32_16x16x32_bf16 v[160:163], v[220:223], v[80:83], v[160:163]
    v_mfma_f32_16x16x32_bf16 v[164:167], v[224:227], v[80:83], v[164:167]
    s_waitcnt lgkmcnt(0)
    v_mfma_f32_16x16x32_bf16 v[148:151], v[228:231], v[84:87], v[148:151]
    v_mfma_f32_16x16x32_bf16 v[152:155], v[232:235], v[84:87], v[152:155]
    v_mfma_f32_16x16x32_bf16 v[156:159], v[236:239], v[84:87], v[156:159]
    v_mfma_f32_16x16x32_bf16 v[160:163], v[240:243], v[84:87], v[160:163]
    v_mfma_f32_16x16x32_bf16 v[164:167], v[244:247], v[84:87], v[164:167]
    s_mov_b32 s29, 0xffff0000
    s_add_u32 s20, s19, s44
    s_add_u32 s20, s20, 9437184
    v_lshlrev_b32 v8, 16, v176
    v_and_b32 v9, s29, v176
    v_add_f32 v8, v8, v148
    v_add_f32 v9, v9, v149
    v_cvt_pk_bf16_f32 v176, v8, v9
    v_lshlrev_b32 v8, 16, v177
    v_and_b32 v9, s29, v177
    v_add_f32 v8, v8, v150
    v_add_f32 v9, v9, v151
    v_cvt_pk_bf16_f32 v177, v8, v9
    v_lshlrev_b32 v8, 16, v178
    v_and_b32 v9, s29, v178
    v_add_f32 v8, v8, v152
    v_add_f32 v9, v9, v153
    v_cvt_pk_bf16_f32 v178, v8, v9
    v_lshlrev_b32 v8, 16, v179
    v_and_b32 v9, s29, v179
    v_add_f32 v8, v8, v154
    v_add_f32 v9, v9, v155
    v_cvt_pk_bf16_f32 v179, v8, v9
    v_permlane16_swap_b32 v176, v178
    s_nop 0
    v_permlane16_swap_b32 v177, v179
    v_min_u32 v176, -2, v176
    buffer_store_dwordx4 v[176:179], v13, s[8:11], s20 offen offset:0 sc1
    v_lshlrev_b32 v8, 16, v180
    v_and_b32 v9, s29, v180
    v_add_f32 v8, v8, v156
    v_add_f32 v9, v9, v157
    v_cvt_pk_bf16_f32 v180, v8, v9
    v_lshlrev_b32 v8, 16, v181
    v_and_b32 v9, s29, v181
    v_add_f32 v8, v8, v158
    v_add_f32 v9, v9, v159
    v_cvt_pk_bf16_f32 v181, v8, v9
    v_lshlrev_b32 v8, 16, v182
    v_and_b32 v9, s29, v182
    v_add_f32 v8, v8, v160
    v_add_f32 v9, v9, v161
    v_cvt_pk_bf16_f32 v182, v8, v9
    v_lshlrev_b32 v8, 16, v183
    v_and_b32 v9, s29, v183
    v_add_f32 v8, v8, v162
    v_add_f32 v9, v9, v163
    v_cvt_pk_bf16_f32 v183, v8, v9
    v_permlane16_swap_b32 v180, v182
    s_nop 0
    v_permlane16_swap_b32 v181, v183
    v_min_u32 v180, -2, v180
    buffer_store_dwordx4 v[180:183], v13, s[8:11], s20 offen offset:1024 sc1
    v_lshlrev_b32 v8, 16, v184
    v_and_b32 v9, s29, v184
    v_add_f32 v8, v8, v164
    v_add_f32 v9, v9, v165
    v_cvt_pk_bf16_f32 v184, v8, v9
    v_lshlrev_b32 v8, 16, v185
    v_and_b32 v9, s29, v185
    v_add_f32 v8, v8, v166
    v_add_f32 v9, v9, v167
    v_cvt_pk_bf16_f32 v185, v8, v9
    v_permlane16_swap_b32 v184, v186
    s_nop 0
    v_permlane16_swap_b32 v185, v187
    v_min_u32 v184, -2, v184
    s_mov_b64 exec, 0xffff
    buffer_store_dwordx4 v[184:187], v13, s[8:11], s20 offen offset:2048 sc1
    s_mov_b64 exec, -1
    s_barrier
    s_setprio 0
    s_add_u32 m0, s7, 0
    s_add_u32 s28, s31, 65536
    buffer_load_dwordx4 v5, s[8:11], s28 offen lds
    s_add_u32 m0, s7, 4096
    s_add_u32 s28, s31, 69632
    buffer_load_dwordx4 v5, s[8:11], s28 offen lds
    s_add_u32 m0, s7, 8192
    s_add_u32 s28, s31, 73728
    buffer_load_dwordx4 v5, s[8:11], s28 offen lds
    s_add_u32 m0, s7, 12288
    s_add_u32 s28, s31, 77824
    buffer_load_dwordx4 v5, s[8:11], s28 offen lds
    s_add_u32 m0, s7, 16384
    s_add_u32 s28, s31, 81920
    buffer_load_dwordx4 v5, s[8:11], s28 offen lds
    s_add_u32 m0, s7, 20480
    s_add_u32 s28, s31, 86016
    buffer_load_dwordx4 v5, s[8:11], s28 offen lds
    s_add_u32 m0, s7, 24576
    s_add_u32 s28, s31, 90112
    buffer_load_dwordx4 v5, s[8:11], s28 offen lds
    s_cmp_lg_u32 s45, 0
    s_cbranch_scc1 H_NM
    s_cmp_ge_u32 s17, 3
    s_cbranch_scc1 H_NM
    s_mul_i32 s20, s17, 6144
    s_add_u32 s20, s20, s18
    s_add_u32 s20, s20, 2359296
    s_add_u32 s21, s20, 4096
    buffer_store_dwordx4 v[248:251], v5, s[8:11], s20 offen offset:0 sc1
    buffer_store_dwordx4 v[248:251], v5, s[8:11], s20 offen offset:1024 sc1
    buffer_store_dwordx4 v[248:251], v5, s[8:11], s20 offen offset:2048 sc1
    buffer_store_dwordx4 v[248:251], v5, s[8:11], s20 offen offset:3072 sc1
    buffer_store_dwordx4 v[248:251], v5, s[8:11], s21 offen offset:0 sc1
    buffer_store_dwordx4 v[248:251], v5, s[8:11], s21 offen offset:1024 sc1
H_NM:
    s_branch P4_BODY
P1_COMP:
    s_lshl_b32 s24, s16, 3
    s_lshl_b32 s26, s3, 1
    s_add_u32 s24, s24, s26
    s_mul_i32 s27, s24, 18432
    s_add_u32 s6, s27, s44
    s_add_u32 s7, s6, 4096
    s_add_u32 s18, s6, 8192
    s_add_u32 s19, s6, 12288
    s_add_u32 s24, s6, 16384
    s_add_u32 s25, s6, 20480
    s_add_u32 s26, s6, 24576
    s_add_u32 s43, s6, 28672
    s_add_u32 s47, s6, 32768
    s_waitcnt lgkmcnt(0)
    s_cmp_lg_u32 s45, 0
    s_cbranch_scc1 P1_C1
    buffer_load_dwordx4 v[128:131], v5, s[8:11], s6 offen offset:0 sc1
    buffer_load_dwordx4 v[132:135], v5, s[8:11], s24 offen offset:2048 sc1
    buffer_load_dwordx4 v[136:139], v5, s[8:11], s6 offen offset:1024 sc1
    buffer_load_dwordx4 v[140:143], v5, s[8:11], s24 offen offset:3072 sc1
    buffer_load_dwordx4 v[144:147], v5, s[8:11], s6 offen offset:2048 sc1
    buffer_load_dwordx4 v[148:151], v5, s[8:11], s25 offen offset:0 sc1
    buffer_load_dwordx4 v[152:155], v5, s[8:11], s6 offen offset:3072 sc1
    buffer_load_dwordx4 v[156:159], v5, s[8:11], s25 offen offset:1024 sc1
    buffer_load_dwordx4 v[160:163], v5, s[8:11], s7 offen offset:0 sc1
    buffer_load_dwordx4 v[164:167], v5, s[8:11], s25 offen offset:2048 sc1
P1_C1:
    v_add_u32 v7, 0x10000, v5
    v_add_u32 v8, 0x20000, v5
    v_and_b32 v2, 15, v1
    v_lshrrev_b32 v3, 4, v1
    v_and_b32 v6, 1, v2
    v_lshl_add_u32 v4, v3, 2, v6
    v_cmp_eq_u32 s[30:31], 1, v6
    v_cmp_le_u32 s[32:33], v4, v2
    v_add_u32 v4, 2, v4
    v_cmp_le_u32 s[34:35], v4, v2
    v_cmp_eq_u32 s[36:37], 0, v3
    v_cmp_eq_u32 s[38:39], 1, v3
    v_cmp_gt_u32 s[40:41], 2, v3
    v_mov_b32 v204, 0x0c0c0100
    v_mov_b32 v205, 0x01000c0c
    v_cndmask_b32 v204, v204, v205, s[30:31]
    v_mov_b32 v206, 0x0c0c0302
    v_mov_b32 v205, 0x03020c0c
    v_cndmask_b32 v206, v206, v205, s[30:31]
    v_mov_b32 v205, 0x0c0c0c0c
    v_cndmask_b32 v200, v204, v205, s[32:33]
    v_cndmask_b32 v201, v206, v205, s[34:35]
    v_cndmask_b32 v202, v205, v204, s[32:33]
    v_cndmask_b32 v203, v205, v206, s[34:35]
    s_mul_i32 s20, s3, 2304
    s_add_u32 s20, s20, 147456
    v_lshlrev_b32 v4, 3, v1
    v_add_u32 v204, s20, v4
    v_lshlrev_b32 v205, 2, v1
    v_add_u32 v205, s20, v205
    s_lshl_b32 s21, s3, 9
    s_add_u32 s21, s21, 147456
    v_add_u32 v206, s21, v4
    s_lshl_b32 s21, s3, 6
    s_add_u32 s21, s21, 158976
    v_lshlrev_b32 v207, 1, v2
    v_add_u32 v207, s21, v207
    v_and_b32 v208, 3, v2
    v_mul_u32_u24 v208, 288, v208
    v_lshl_add_u32 v208, v3, 3, v208
    v_add_u32 v208, s21, v208
    v_lshrrev_b32 v209, 1, v3
    v_lshlrev_b32 v209, 8, v209
    v_lshl_add_u32 v209, v2, 4, v209
    v_and_b32 v4, 1, v3
    v_lshl_add_u32 v211, v4, 9, v209
    v_lshl_add_u32 v209, v4, 3, v209
    v_lshlrev_b32 v210, 4, v2
    s_or_b32 s21, s16, s3
    s_cmp_eq_u32 s21, 0
    s_cselect_b32 s21, 4048155338, 0
    v_mov_b32 v212, s21
    v_mov_b32 v213, s21
    v_mov_b32 v214, s21
    v_mov_b32 v215, s21
    s_add_u32 s20, s27, 7077888
    s_lshr_b32 s22, s17, 1
    s_lshl_b32 s22, s22, 8
    s_and_b32 s23, s17, 1
    s_lshl_b32 s23, s23, 3
    s_add_u32 s22, s22, s23
    s_add_u32 s22, s22, s20
    s_add_u32 s22, s22, 16384
    s_add_u32 s23, s22, 18432
    s_lshl_b32 s21, s17, 10
    s_add_u32 s20, s20, s21
    s_add_u32 s21, s20, 18432
    s_mov_b32 s42, 1051597459
    v_mov_b32 v219, 0
    v_mov_b32 v223, 0
    v_mov_b32 v227, 0
    v_mov_b32 v231, 0
    v_mov_b32 v235, 0
    v_mov_b32 v239, 0
    v_mov_b32 v243, 0
    v_mov_b32 v247, 0
    v_mov_b32 v251, 0
    v_mov_b32 v255, 0
    s_cmp_eq_u32 s45, 0
    s_cbranch_scc1 P1_C2
    buffer_load_dwordx4 v[128:131], v5, s[8:11], s6 offen offset:0 sc1
    buffer_load_dwordx4 v[132:135], v5, s[8:11], s24 offen offset:2048 sc1
    buffer_load_dwordx4 v[136:139], v5, s[8:11], s6 offen offset:1024 sc1
    buffer_load_dwordx4 v[140:143], v5, s[8:11], s24 offen offset:3072 sc1
    buffer_load_dwordx4 v[144:147], v5, s[8:11], s6 offen offset:2048 sc1
    buffer_load_dwordx4 v[148:151], v5, s[8:11], s25 offen offset:0 sc1
    buffer_load_dwordx4 v[152:155], v5, s[8:11], s6 offen offset:3072 sc1
    buffer_load_dwordx4 v[156:159], v5, s[8:11], s25 offen offset:1024 sc1
    buffer_load_dwordx4 v[160:163], v5, s[8:11], s7 offen offset:0 sc1
    buffer_load_dwordx4 v[164:167], v5, s[8:11], s25 offen offset:2048 sc1
P1_C2:
    s_cmp_lg_u32 s45, 0
    s_cbranch_scc1 P1_NB
    s_barrier
P1_NB:
    ds_read_b128 v[24:27], v5 offset:2048
    ds_read_b128 v[28:31], v5 offset:3072
    ds_read_b128 v[32:35], v5 offset:4096
    ds_read_b128 v[36:39], v5 offset:5120
    ds_read_b128 v[40:43], v5 offset:6144
    ds_read_b128 v[16:19], v5 offset:0
    ds_read_b128 v[20:23], v5 offset:1024
    s_waitcnt vmcnt(8)
    v_max_u32 v15, v128, v132
    v_cmp_eq_u32 vcc, -1, v15
    s_cbranch_vccnz P1_R0
P1_R0B:
    s_waitcnt lgkmcnt(6)
    v_mfma_f32_16x16x32_bf16 v[108:111], v[24:27], v[132:135], 0
    v_mfma_f32_16x16x32_bf16 v[80:83], v[24:27], v[128:131], 0
    buffer_load_dwordx4 v[168:171], v5, s[8:11], s7 offen offset:1024 sc1
    s_waitcnt lgkmcnt(5)
    v_mfma_f32_16x16x32_bf16 v[112:115], v[28:31], v[132:135], 0
    ds_read_b128 v[52:55], v5 offset:10240
    v_mfma_f32_16x16x32_bf16 v[84:87], v[28:31], v[128:131], 0
    ds_read_b128 v[56:59], v5 offset:11264
    s_waitcnt lgkmcnt(2)
    v_mfma_f32_16x16x32_bf16 v[116:119], v[132:135], v[32:35], 0
    ds_read_b128 v[60:63], v5 offset:12288
    v_mfma_f32_16x16x32_bf16 v[88:91], v[128:131], v[32:35], 0
    ds_read_b128 v[64:67], v5 offset:13312
    v_mfma_f32_16x16x32_bf16 v[120:123], v[132:135], v[36:39], 0
    ds_read_b128 v[68:71], v5 offset:14336
    v_mfma_f32_16x16x32_bf16 v[92:95], v[128:131], v[36:39], 0
    ds_read_b128 v[44:47], v5 offset:8192
    v_mfma_f32_16x16x32_bf16 v[124:127], v[40:43], v[132:135], 0
    buffer_load_dwordx4 v[172:175], v5, s[8:11], s25 offen offset:3072 sc1
    ds_read_b128 v[48:51], v5 offset:9216
    v_mfma_f32_16x16x32_bf16 v[96:99], v[40:43], v[128:131], 0
    v_mfma_f32_16x16x32_bf16 v[100:103], v[16:19], v[132:135], 0
    v_mfma_f32_16x16x32_bf16 v[72:75], v[16:19], v[128:131], 0
    s_waitcnt vmcnt(8)
    v_max_u32 v15, v136, v140
    v_cmp_eq_u32 vcc, -1, v15
    v_mfma_f32_16x16x32_bf16 v[104:107], v[20:23], v[132:135], 0
    v_mfma_f32_16x16x32_bf16 v[76:79], v[20:23], v[128:131], 0
    s_cbranch_vccnz P1_R1
P1_R1B:
    s_waitcnt lgkmcnt(6)
    v_mfma_f32_16x16x32_bf16 v[108:111], v[52:55], v[140:143], v[108:111]
    v_mfma_f32_16x16x32_bf16 v[80:83], v[52:55], v[136:139], v[80:83]
    buffer_load_dwordx4 v[128:131], v5, s[8:11], s7 offen offset:2048 sc1
    s_waitcnt lgkmcnt(5)
    v_mfma_f32_16x16x32_bf16 v[112:115], v[56:59], v[140:143], v[112:115]
    s_cmp_lg_u32 s45, 0
    s_cbranch_scc1 P1_NB1
    s_barrier
P1_NB1:
    ds_read_b128 v[24:27], v5 offset:18432
    v_mfma_f32_16x16x32_bf16 v[84:87], v[56:59], v[136:139], v[84:87]
    ds_read_b128 v[28:31], v5 offset:19456
    s_waitcnt lgkmcnt(2)
    v_mfma_f32_16x16x32_bf16 v[116:119], v[140:143], v[60:63], v[116:119]
    ds_read_b128 v[32:35], v5 offset:20480
    v_mfma_f32_16x16x32_bf16 v[88:91], v[136:139], v[60:63], v[88:91]
    ds_read_b128 v[36:39], v5 offset:21504
    v_mfma_f32_16x16x32_bf16 v[120:123], v[140:143], v[64:67], v[120:123]
    ds_read_b128 v[40:43], v5 offset:22528
    v_mfma_f32_16x16x32_bf16 v[92:95], v[136:139], v[64:67], v[92:95]
    ds_read_b128 v[16:19], v5 offset:16384
    v_mfma_f32_16x16x32_bf16 v[124:127], v[68:71], v[140:143], v[124:127]
    buffer_load_dwordx4 v[132:135], v5, s[8:11], s26 offen offset:0 sc1
    ds_read_b128 v[20:23], v5 offset:17408
    v_mfma_f32_16x16x32_bf16 v[96:99], v[68:71], v[136:139], v[96:99]
    v_mfma_f32_16x16x32_bf16 v[100:103], v[44:47], v[140:143], v[100:103]
    v_mfma_f32_16x16x32_bf16 v[72:75], v[44:47], v[136:139], v[72:75]
    s_waitcnt vmcnt(8)
    v_max_u32 v15, v144, v148
    v_cmp_eq_u32 vcc, -1, v15
    v_mfma_f32_16x16x32_bf16 v[104:107], v[48:51], v[140:143], v[104:107]
    v_mfma_f32_16x16x32_bf16 v[76:79], v[48:51], v[136:139], v[76:79]
    s_cbranch_vccnz P1_R2
P1_R2B:
    s_waitcnt lgkmcnt(6)
    v_mfma_f32_16x16x32_bf16 v[108:111], v[24:27], v[148:151], v[108:111]
    v_mfma_f32_16x16x32_bf16 v[80:83], v[24:27], v[144:147], v[80:83]
    buffer_load_dwordx4 v[136:139], v5, s[8:11], s7 offen offset:3072 sc1
    s_waitcnt lgkmcnt(5)
    v_mfma_f32_16x16x32_bf16 v[112:115], v[28:31], v[148:151], v[112:115]
    ds_read_b128 v[52:55], v5 offset:26624
    v_mfma_f32_16x16x32_bf16 v[84:87], v[28:31], v[144:147], v[84:87]
    ds_read_b128 v[56:59], v5 offset:27648
    s_waitcnt lgkmcnt(2)
    v_mfma_f32_16x16x32_bf16 v[116:119], v[148:151], v[32:35], v[116:119]
    ds_read_b128 v[60:63], v5 offset:28672
    v_mfma_f32_16x16x32_bf16 v[88:91], v[144:147], v[32:35], v[88:91]
    ds_read_b128 v[64:67], v5 offset:29696
    v_mfma_f32_16x16x32_bf16 v[120:123], v[148:151], v[36:39], v[120:123]
    ds_read_b128 v[68:71], v5 offset:30720
    v_mfma_f32_16x16x32_bf16 v[92:95], v[144:147], v[36:39], v[92:95]
    ds_read_b128 v[44:47], v5 offset:24576
    v_mfma_f32_16x16x32_bf16 v[124:127], v[40:43], v[148:151], v[124:127]
    buffer_load_dwordx4 v[140:143], v5, s[8:11], s26 offen offset:1024 sc1
    ds_read_b128 v[48:51], v5 offset:25600
    v_mfma_f32_16x16x32_bf16 v[96:99], v[40:43], v[144:147], v[96:99]
    v_mfma_f32_16x16x32_bf16 v[100:103], v[16:19], v[148:151], v[100:103]
    v_mfma_f32_16x16x32_bf16 v[72:75], v[16:19], v[144:147], v[72:75]
    s_waitcnt vmcnt(8)
    v_max_u32 v15, v152, v156
    v_cmp_eq_u32 vcc, -1, v15
    v_mfma_f32_16x16x32_bf16 v[104:107], v[20:23], v[148:151], v[104:107]
    v_mfma_f32_16x16x32_bf16 v[76:79], v[20:23], v[144:147], v[76:79]
    s_cbranch_vccnz P1_R3
P1_R3B:
    s_waitcnt lgkmcnt(6)
    v_mfma_f32_16x16x32_bf16 v[108:111], v[52:55], v[156:159], v[108:111]
    v_mfma_f32_16x16x32_bf16 v[80:83], v[52:55], v[152:155], v[80:83]
    buffer_load_dwordx4 v[144:147], v5, s[8:11], s18 offen offset:0 sc1
    s_waitcnt lgkmcnt(5)
    v_mfma_f32_16x16x32_bf16 v[112:115], v[56:59], v[156:159], v[112:115]
    s_cmp_lg_u32 s45, 0
    s_cbranch_scc1 P1_NB3
    s_barrier
P1_NB3:
    ds_read_b128 v[24:27], v5 offset:34816
    v_mfma_f32_16x16x32_bf16 v[84:87], v[56:59], v[152:155], v[84:87]
    ds_read_b128 v[28:31], v5 offset:35840
    s_waitcnt lgkmcnt(2)
    v_mfma_f32_16x16x32_bf16 v[116:119], v[156:159], v[60:63], v[116:119]
    ds_read_b128 v[32:35], v5 offset:36864
    v_mfma_f32_16x16x32_bf16 v[88:91], v[152:155], v[60:63], v[88:91]
    ds_read_b128 v[36:39], v5 offset:37888
    v_mfma_f32_16x16x32_bf16 v[120:123], v[156:159], v[64:67], v[120:123]
    ds_read_b128 v[40:43], v5 offset:38912
    v_mfma_f32_16x16x32_bf16 v[92:95], v[152:155], v[64:67], v[92:95]
    ds_read_b128 v[16:19], v5 offset:32768
    v_mfma_f32_16x16x32_bf16 v[124:127], v[68:71], v[156:159], v[124:127]
    buffer_load_dwordx4 v[148:151], v5, s[8:11], s26 offen offset:2048 sc1
    ds_read_b128 v[20:23], v5 offset:33792
    v_mfma_f32_16x16x32_bf16 v[96:99], v[68:71], v[152:155], v[96:99]
    v_mfma_f32_16x16x32_bf16 v[100:103], v[44:47], v[156:159], v[100:103]
    v_mfma_f32_16x16x32_bf16 v[72:75], v[44:47], v[152:155], v[72:75]
    s_waitcnt vmcnt(8)
    v_max_u32 v15, v160, v164
    v_cmp_eq_u32 vcc, -1, v15
    v_mfma_f32_16x16x32_bf16 v[104:107], v[48:51], v[156:159], v[104:107]
    v_mfma_f32_16x16x32_bf16 v[76:79], v[48:51], v[152:155], v[76:79]
    s_cbranch_vccnz P1_R4
P1_R4B:
    s_waitcnt lgkmcnt(6)
    v_mfma_f32_16x16x32_bf16 v[108:111], v[24:27], v[164:167], v[108:111]
    v_mfma_f32_16x16x32_bf16 v[80:83], v[24:27], v[160:163], v[80:83]
    buffer_load_dwordx4 v[152:155], v5, s[8:11], s18 offen offset:1024 sc1
    s_waitcnt lgkmcnt(5)
    v_mfma_f32_16x16x32_bf16 v[112:115], v[28:31], v[164:167], v[112:115]
    ds_read_b128 v[52:55], v5 offset:43008
    v_mfma_f32_16x16x32_bf16 v[84:87], v[28:31], v[160:163], v[84:87]
    ds_read_b128 v[56:59], v5 offset:44032
    s_waitcnt lgkmcnt(2)
    v_mfma_f32_16x16x32_bf16 v[116:119], v[164:167], v[32:35], v[116:119]
    ds_read_b128 v[60:63], v5 offset:45056
    v_mfma_f32_16x16x32_bf16 v[88:91], v[160:163], v[32:35], v[88:91]
    ds_read_b128 v[64:67], v5 offset:46080
    v_mfma_f32_16x16x32_bf16 v[120:123], v[164:167], v[36:39], v[120:123]
    ds_read_b128 v[68:71], v5 offset:47104
    v_mfma_f32_16x16x32_bf16 v[92:95], v[160:163], v[36:39], v[92:95]
    ds_read_b128 v[44:47], v5 offset:40960
    v_mfma_f32_16x16x32_bf16 v[124:127], v[40:43], v[164:167], v[124:127]
    buffer_load_dwordx4 v[156:159], v5, s[8:11], s26 offen offset:3072 sc1
    ds_read_b128 v[48:51], v5 offset:41984
    v_mfma_f32_16x16x32_bf16 v[96:99], v[40:43], v[160:163], v[96:99]
    v_mfma_f32_16x16x32_bf16 v[100:103], v[16:19], v[164:167], v[100:103]
    v_mfma_f32_16x16x32_bf16 v[72:75], v[16:19], v[160:163], v[72:75]
    s_waitcnt vmcnt(8)
    v_max_u32 v15, v168, v172
    v_cmp_eq_u32 vcc, -1, v15
    v_mfma_f32_16x16x32_bf16 v[104:107], v[20:23], v[164:167], v[104:107]
    v_mfma_f32_16x16x32_bf16 v[76:79], v[20:23], v[160:163], v[76:79]
    s_cbranch_vccnz P1_R5
P1_R5B:
    s_waitcnt lgkmcnt(6)
    v_mfma_f32_16x16x32_bf16 v[108:111], v[52:55], v[172:175], v[108:111]
    v_mfma_f32_16x16x32_bf16 v[80:83], v[52:55], v[168:171], v[80:83]
    buffer_load_dwordx4 v[160:163], v5, s[8:11], s18 offen offset:2048 sc1
    s_waitcnt lgkmcnt(5)
    v_mfma_f32_16x16x32_bf16 v[112:115], v[56:59], v[172:175], v[112:115]
    s_cmp_lg_u32 s45, 0
    s_cbranch_scc1 P1_NB5
    s_barrier
P1_NB5:
    ds_read_b128 v[24:27], v5 offset:51200
    v_mfma_f32_16x16x32_bf16 v[84:87], v[56:59], v[168:171], v[84:87]
    ds_read_b128 v[28:31], v5 offset:52224
    s_waitcnt lgkmcnt(2)
    v_mfma_f32_16x16x32_bf16 v[116:119], v[172:175], v[60:63], v[116:119]
    ds_read_b128 v[32:35], v5 offset:53248
    v_mfma_f32_16x16x32_bf16 v[88:91], v[168:171], v[60:63], v[88:91]
    ds_read_b128 v[36:39], v5 offset:54272
    v_mfma_f32_16x16x32_bf16 v[120:123], v[172:175], v[64:67], v[120:123]
    ds_read_b128 v[40:43], v5 offset:55296
    v_mfma_f32_16x16x32_bf16 v[92:95], v[168:171], v[64:67], v[92:95]
    ds_read_b128 v[16:19], v5 offset:49152
    v_mfma_f32_16x16x32_bf16 v[124:127], v[68:71], v[172:175], v[124:127]
    buffer_load_dwordx4 v[164:167], v5, s[8:11], s43 offen offset:0 sc1
    ds_read_b128 v[20:23], v5 offset:50176
    v_mfma_f32_16x16x32_bf16 v[96:99], v[68:71], v[168:171], v[96:99]
    v_mfma_f32_16x16x32_bf16 v[100:103], v[44:47], v[172:175], v[100:103]
    v_mfma_f32_16x16x32_bf16 v[72:75], v[44:47], v[168:171], v[72:75]
    s_waitcnt vmcnt(8)
    v_max_u32 v15, v128, v132
    v_cmp_eq_u32 vcc, -1, v15
    v_mfma_f32_16x16x32_bf16 v[104:107], v[48:51], v[172:175], v[104:107]
    v_mfma_f32_16x16x32_bf16 v[76:79], v[48:51], v[168:171], v[76:79]
    s_cbranch_vccnz P1_R6
P1_R6B:
    s_waitcnt lgkmcnt(6)
    v_mfma_f32_16x16x32_bf16 v[108:111], v[24:27], v[132:135], v[108:111]
    v_mfma_f32_16x16x32_bf16 v[80:83], v[24:27], v[128:131], v[80:83]
    buffer_load_dwordx4 v[168:171], v5, s[8:11], s18 offen offset:3072 sc1
    s_waitcnt lgkmcnt(5)
    v_mfma_f32_16x16x32_bf16 v[112:115], v[28:31], v[132:135], v[112:115]
    ds_read_b128 v[52:55], v5 offset:59392
    v_mfma_f32_16x16x32_bf16 v[84:87], v[28:31], v[128:131], v[84:87]
    ds_read_b128 v[56:59], v5 offset:60416
    s_waitcnt lgkmcnt(2)
    v_mfma_f32_16x16x32_bf16 v[116:119], v[132:135], v[32:35], v[116:119]
    ds_read_b128 v[60:63], v5 offset:61440
    v_mfma_f32_16x16x32_bf16 v[88:91], v[128:131], v[32:35], v[88:91]
    ds_read_b128 v[64:67], v5 offset:62464
    v_mfma_f32_16x16x32_bf16 v[120:123], v[132:135], v[36:39], v[120:123]
    ds_read_b128 v[68:71], v5 offset:63488
    v_mfma_f32_16x16x32_bf16 v[92:95], v[128:131], v[36:39], v[92:95]
    ds_read_b128 v[44:47], v5 offset:57344
    v_mfma_f32_16x16x32_bf16 v[124:127], v[40:43], v[132:135], v[124:127]
    buffer_load_dwordx4 v[172:175], v5, s[8:11], s43 offen offset:1024 sc1
    ds_read_b128 v[48:51], v5 offset:58368
    v_mfma_f32_16x16x32_bf16 v[96:99], v[40:43], v[128:131], v[96:99]
    v_mfma_f32_16x16x32_bf16 v[100:103], v[16:19], v[132:135], v[100:103]
    v_mfma_f32_16x16x32_bf16 v[72:75], v[16:19], v[128:131], v[72:75]
    s_waitcnt vmcnt(8)
    v_max_u32 v15, v136, v140
    v_cmp_eq_u32 vcc, -1, v15
    v_mfma_f32_16x16x32_bf16 v[104:107], v[20:23], v[132:135], v[104:107]
    v_mfma_f32_16x16x32_bf16 v[76:79], v[20:23], v[128:131], v[76:79]
    s_cbranch_vccnz P1_R7
P1_R7B:
    s_waitcnt lgkmcnt(6)
    v_mfma_f32_16x16x32_bf16 v[108:111], v[52:55], v[140:143], v[108:111]
    v_mfma_f32_16x16x32_bf16 v[80:83], v[52:55], v[136:139], v[80:83]
    buffer_load_dwordx4 v[128:131], v5, s[8:11], s19 offen offset:0 sc1
    s_waitcnt lgkmcnt(5)
    v_mfma_f32_16x16x32_bf16 v[112:115], v[56:59], v[140:143], v[112:115]
    s_cmp_lg_u32 s45, 0
    s_cbranch_scc1 P1_NB7
    s_barrier
P1_NB7:
    ds_read_b128 v[24:27], v7 offset:2048
    v_mfma_f32_16x16x32_bf16 v[84:87], v[56:59], v[136:139], v[84:87]
    ds_read_b128 v[28:31], v7 offset:3072
    s_waitcnt lgkmcnt(2)
    v_mfma_f32_16x16x32_bf16 v[116:119], v[140:143], v[60:63], v[116:119]
    ds_read_b128 v[32:35], v7 offset:4096
    v_mfma_f32_16x16x32_bf16 v[88:91], v[136:139], v[60:63], v[88:91]
    ds_read_b128 v[36:39], v7 offset:5120
    v_mfma_f32_16x16x32_bf16 v[120:123], v[140:143], v[64:67], v[120:123]
    ds_read_b128 v[40:43], v7 offset:6144
    v_mfma_f32_16x16x32_bf16 v[92:95], v[136:139], v[64:67], v[92:95]
    ds_read_b128 v[16:19], v7 offset:0
    v_mfma_f32_16x16x32_bf16 v[124:127], v[68:71], v[140:143], v[124:127]
    buffer_load_dwordx4 v[132:135], v5, s[8:11], s43 offen offset:2048 sc1
    ds_read_b128 v[20:23], v7 offset:1024
    v_mfma_f32_16x16x32_bf16 v[96:99], v[68:71], v[136:139], v[96:99]
    v_mfma_f32_16x16x32_bf16 v[100:103], v[44:47], v[140:143], v[100:103]
    v_mfma_f32_16x16x32_bf16 v[72:75], v[44:47], v[136:139], v[72:75]
    s_waitcnt vmcnt(8)
    v_max_u32 v15, v144, v148
    v_cmp_eq_u32 vcc, -1, v15
    v_mfma_f32_16x16x32_bf16 v[104:107], v[48:51], v[140:143], v[104:107]
    v_mfma_f32_16x16x32_bf16 v[76:79], v[48:51], v[136:139], v[76:79]
    s_cbranch_vccnz P1_R8
P1_R8B:
    s_waitcnt lgkmcnt(6)
    v_mfma_f32_16x16x32_bf16 v[108:111], v[24:27], v[148:151], v[108:111]
    v_mfma_f32_16x16x32_bf16 v[80:83], v[24:27], v[144:147], v[80:83]
    buffer_load_dwordx4 v[136:139], v5, s[8:11], s19 offen offset:1024 sc1
    s_waitcnt lgkmcnt(5)
    v_mfma_f32_16x16x32_bf16 v[112:115], v[28:31], v[148:151], v[112:115]
    ds_read_b128 v[52:55], v7 offset:10240
    v_mfma_f32_16x16x32_bf16 v[84:87], v[28:31], v[144:147], v[84:87]
    ds_read_b128 v[56:59], v7 offset:11264
    s_waitcnt lgkmcnt(2)
    v_mfma_f32_16x16x32_bf16 v[116:119], v[148:151], v[32:35], v[116:119]
    ds_read_b128 v[60:63], v7 offset:12288
    v_mfma_f32_16x16x32_bf16 v[88:91], v[144:147], v[32:35], v[88:91]
    ds_read_b128 v[64:67], v7 offset:13312
    v_mfma_f32_16x16x32_bf16 v[120:123], v[148:151], v[36:39], v[120:123]
    ds_read_b128 v[68:71], v7 offset:14336
    v_mfma_f32_16x16x32_bf16 v[92:95], v[144:147], v[36:39], v[92:95]
    ds_read_b128 v[44:47], v7 offset:8192
    v_mfma_f32_16x16x32_bf16 v[124:127], v[40:43], v[148:151], v[124:127]
    buffer_load_dwordx4 v[140:143], v5, s[8:11], s43 offen offset:3072 sc1
    ds_read_b128 v[48:51], v7 offset:9216
    v_mfma_f32_16x16x32_bf16 v[96:99], v[40:43], v[144:147], v[96:99]
    v_mfma_f32_16x16x32_bf16 v[100:103], v[16:19], v[148:151], v[100:103]
    v_mfma_f32_16x16x32_bf16 v[72:75], v[16:19], v[144:147], v[72:75]
    s_waitcnt vmcnt(8)
    v_max_u32 v15, v152, v156
    v_cmp_eq_u32 vcc, -1, v15
    v_mfma_f32_16x16x32_bf16 v[104:107], v[20:23], v[148:151], v[104:107]
    v_mfma_f32_16x16x32_bf16 v[76:79], v[20:23], v[144:147], v[76:79]
    s_cbranch_vccnz P1_R9
P1_R9B:
    s_waitcnt lgkmcnt(6)
    v_mfma_f32_16x16x32_bf16 v[108:111], v[52:55], v[156:159], v[108:111]
    v_mfma_f32_16x16x32_bf16 v[80:83], v[52:55], v[152:155], v[80:83]
    buffer_load_dwordx4 v[144:147], v5, s[8:11], s19 offen offset:2048 sc1
    s_waitcnt lgkmcnt(5)
    v_mfma_f32_16x16x32_bf16 v[112:115], v[56:59], v[156:159], v[112:115]
    s_cmp_lg_u32 s45, 0
    s_cbranch_scc1 P1_NB9
    s_barrier
P1_NB9:
    ds_read_b128 v[24:27], v7 offset:18432
    v_mfma_f32_16x16x32_bf16 v[84:87], v[56:59], v[152:155], v[84:87]
    ds_read_b128 v[28:31], v7 offset:19456
    s_waitcnt lgkmcnt(2)
    v_mfma_f32_16x16x32_bf16 v[116:119], v[156:159], v[60:63], v[116:119]
    ds_read_b128 v[32:35], v7 offset:20480
    v_mfma_f32_16x16x32_bf16 v[88:91], v[152:155], v[60:63], v[88:91]
    ds_read_b128 v[36:39], v7 offset:21504
    v_mfma_f32_16x16x32_bf16 v[120:123], v[156:159], v[64:67], v[120:123]
    ds_read_b128 v[40:43], v7 offset:22528
    v_mfma_f32_16x16x32_bf16 v[92:95], v[152:155], v[64:67], v[92:95]
    ds_read_b128 v[16:19], v7 offset:16384
    v_mfma_f32_16x16x32_bf16 v[124:127], v[68:71], v[156:159], v[124:127]
    buffer_load_dwordx4 v[148:151], v5, s[8:11], s47 offen offset:0 sc1
    ds_read_b128 v[20:23], v7 offset:17408
    v_mfma_f32_16x16x32_bf16 v[96:99], v[68:71], v[152:155], v[96:99]
    v_mfma_f32_16x16x32_bf16 v[100:103], v[44:47], v[156:159], v[100:103]
    v_mfma_f32_16x16x32_bf16 v[72:75], v[44:47], v[152:155], v[72:75]
    s_waitcnt vmcnt(8)
    v_max_u32 v15, v160, v164
    v_cmp_eq_u32 vcc, -1, v15
    v_mfma_f32_16x16x32_bf16 v[104:107], v[48:51], v[156:159], v[104:107]
    v_mfma_f32_16x16x32_bf16 v[76:79], v[48:51], v[152:155], v[76:79]
    s_cbranch_vccnz P1_R10
P1_R10B:
    s_waitcnt lgkmcnt(6)
    v_mfma_f32_16x16x32_bf16 v[108:111], v[24:27], v[164:167], v[108:111]
    v_mfma_f32_16x16x32_bf16 v[80:83], v[24:27], v[160:163], v[80:83]
    buffer_load_dwordx4 v[152:155], v5, s[8:11], s19 offen offset:3072 sc1
    s_waitcnt lgkmcnt(5)
    v_mfma_f32_16x16x32_bf16 v[112:115], v[28:31], v[164:167], v[112:115]
    ds_read_b128 v[52:55], v7 offset:26624
    v_mfma_f32_16x16x32_bf16 v[84:87], v[28:31], v[160:163], v[84:87]
    ds_read_b128 v[56:59], v7 offset:27648
    s_waitcnt lgkmcnt(2)
    v_mfma_f32_16x16x32_bf16 v[116:119], v[164:167], v[32:35], v[116:119]
    ds_read_b128 v[60:63], v7 offset:28672
    v_mfma_f32_16x16x32_bf16 v[88:91], v[160:163], v[32:35], v[88:91]
    ds_read_b128 v[64:67], v7 offset:29696
    v_mfma_f32_16x16x32_bf16 v[120:123], v[164:167], v[36:39], v[120:123]
    ds_read_b128 v[68:71], v7 offset:30720
    v_mfma_f32_16x16x32_bf16 v[92:95], v[160:163], v[36:39], v[92:95]
    ds_read_b128 v[44:47], v7 offset:24576
    v_mfma_f32_16x16x32_bf16 v[124:127], v[40:43], v[164:167], v[124:127]
    buffer_load_dwordx4 v[156:159], v5, s[8:11], s47 offen offset:1024 sc1
    ds_read_b128 v[48:51], v7 offset:25600
    v_mfma_f32_16x16x32_bf16 v[96:99], v[40:43], v[160:163], v[96:99]
    v_mfma_f32_16x16x32_bf16 v[100:103], v[16:19], v[164:167], v[100:103]
    v_mfma_f32_16x16x32_bf16 v[72:75], v[16:19], v[160:163], v[72:75]
    s_waitcnt vmcnt(8)
    v_max_u32 v15, v168, v172
    v_cmp_eq_u32 vcc, -1, v15
    v_mfma_f32_16x16x32_bf16 v[104:107], v[20:23], v[164:167], v[104:107]
    v_mfma_f32_16x16x32_bf16 v[76:79], v[20:23], v[160:163], v[76:79]
    s_cbranch_vccnz P1_R11
P1_R11B:
    s_waitcnt lgkmcnt(6)
    v_mfma_f32_16x16x32_bf16 v[108:111], v[52:55], v[172:175], v[108:111]
    v_mfma_f32_16x16x32_bf16 v[80:83], v[52:55], v[168:171], v[80:83]
    buffer_load_dwordx4 v[160:163], v5, s[8:11], s24 offen offset:0 sc1
    s_waitcnt lgkmcnt(5)
    v_mfma_f32_16x16x32_bf16 v[112:115], v[56:59], v[172:175], v[112:115]
    s_barrier
    ds_read_b128 v[24:27], v7 offset:34816
    v_mfma_f32_16x16x32_bf16 v[84:87], v[56:59], v[168:171], v[84:87]
    ds_read_b128 v[28:31], v7 offset:35840
    s_waitcnt lgkmcnt(2)
    v_mfma_f32_16x16x32_bf16 v[116:119], v[172:175], v[60:63], v[116:119]
    ds_read_b128 v[32:35], v7 offset:36864
    v_mfma_f32_16x16x32_bf16 v[88:91], v[168:171], v[60:63], v[88:91]
    ds_read_b128 v[36:39], v7 offset:37888
    v_mfma_f32_16x16x32_bf16 v[120:123], v[172:175], v[64:67], v[120:123]
    ds_read_b128 v[40:43], v7 offset:38912
    v_mfma_f32_16x16x32_bf16 v[92:95], v[168:171], v[64:67], v[92:95]
    ds_read_b128 v[16:19], v7 offset:32768
    v_mfma_f32_16x16x32_bf16 v[124:127], v[68:71], v[172:175], v[124:127]
    buffer_load_dwordx4 v[164:167], v5, s[8:11], s47 offen offset:2048 sc1
    ds_read_b128 v[20:23], v7 offset:33792
    v_mfma_f32_16x16x32_bf16 v[96:99], v[68:71], v[168:171], v[96:99]
    v_mfma_f32_16x16x32_bf16 v[100:103], v[44:47], v[172:175], v[100:103]
    v_mfma_f32_16x16x32_bf16 v[72:75], v[44:47], v[168:171], v[72:75]
    s_waitcnt vmcnt(8)
    v_max_u32 v15, v128, v132
    v_cmp_eq_u32 vcc, -1, v15
    v_mfma_f32_16x16x32_bf16 v[104:107], v[48:51], v[172:175], v[104:107]
    v_mfma_f32_16x16x32_bf16 v[76:79], v[48:51], v[168:171], v[76:79]
    s_cbranch_vccnz P1_R12
P1_R12B:
    s_waitcnt lgkmcnt(6)
    v_mfma_f32_16x16x32_bf16 v[108:111], v[24:27], v[132:135], v[108:111]
    v_mfma_f32_16x16x32_bf16 v[80:83], v[24:27], v[128:131], v[80:83]
    buffer_load_dwordx4 v[168:171], v5, s[8:11], s24 offen offset:1024 sc1
    s_waitcnt lgkmcnt(5)
    v_mfma_f32_16x16x32_bf16 v[112:115], v[28:31], v[132:135], v[112:115]
    ds_read_b128 v[52:55], v7 offset:43008
    v_mfma_f32_16x16x32_bf16 v[84:87], v[28:31], v[128:131], v[84:87]
    ds_read_b128 v[56:59], v7 offset:44032
    s_waitcnt lgkmcnt(2)
    v_mfma_f32_16x16x32_bf16 v[116:119], v[132:135], v[32:35], v[116:119]
    ds_read_b128 v[60:63], v7 offset:45056
    v_mfma_f32_16x16x32_bf16 v[88:91], v[128:131], v[32:35], v[88:91]
    ds_read_b128 v[64:67], v7 offset:46080
    v_mfma_f32_16x16x32_bf16 v[120:123], v[132:135], v[36:39], v[120:123]
    ds_read_b128 v[68:71], v7 offset:47104
    v_mfma_f32_16x16x32_bf16 v[92:95], v[128:131], v[36:39], v[92:95]
    ds_read_b128 v[44:47], v7 offset:40960
    v_mfma_f32_16x16x32_bf16 v[124:127], v[40:43], v[132:135], v[124:127]
    buffer_load_dwordx4 v[172:175], v5, s[8:11], s47 offen offset:3072 sc1
    ds_read_b128 v[48:51], v7 offset:41984
    v_mfma_f32_16x16x32_bf16 v[96:99], v[40:43], v[128:131], v[96:99]
    v_mfma_f32_16x16x32_bf16 v[100:103], v[16:19], v[132:135], v[100:103]
    v_mfma_f32_16x16x32_bf16 v[72:75], v[16:19], v[128:131], v[72:75]
    s_waitcnt vmcnt(8)
    v_max_u32 v15, v136, v140
    v_cmp_eq_u32 vcc, -1, v15
    v_mfma_f32_16x16x32_bf16 v[104:107], v[20:23], v[132:135], v[104:107]
    v_mfma_f32_16x16x32_bf16 v[76:79], v[20:23], v[128:131], v[76:79]
    s_cbranch_vccnz P1_R13
P1_R13B:
    s_waitcnt lgkmcnt(6)
    v_mfma_f32_16x16x32_bf16 v[108:111], v[52:55], v[140:143], v[108:111]
    v_mfma_f32_16x16x32_bf16 v[80:83], v[52:55], v[136:139], v[80:83]
    s_waitcnt lgkmcnt(5)
    v_mfma_f32_16x16x32_bf16 v[112:115], v[56:59], v[140:143], v[112:115]
    s_cmp_lg_u32 s45, 0
    s_cbranch_scc1 P1_NB13
    s_barrier
P1_NB13:
    ds_read_b128 v[24:27], v7 offset:51200
    v_mfma_f32_16x16x32_bf16 v[84:87], v[56:59], v[136:139], v[84:87]
    ds_read_b128 v[28:31], v7 offset:52224
    s_waitcnt lgkmcnt(2)
    v_mfma_f32_16x16x32_bf16 v[116:119], v[140:143], v[60:63], v[116:119]
    ds_read_b128 v[32:35], v7 offset:53248
    v_mfma_f32_16x16x32_bf16 v[88:91], v[136:139], v[60:63], v[88:91]
    ds_read_b128 v[36:39], v7 offset:54272
    v_mfma_f32_16x16x32_bf16 v[120:123], v[140:143], v[64:67], v[120:123]
    ds_read_b128 v[40:43], v7 offset:55296
    v_mfma_f32_16x16x32_bf16 v[92:95], v[136:139], v[64:67], v[92:95]
    ds_read_b128 v[16:19], v7 offset:49152
    v_mfma_f32_16x16x32_bf16 v[124:127], v[68:71], v[140:143], v[124:127]
    ds_read_b128 v[20:23], v7 offset:50176
    v_mfma_f32_16x16x32_bf16 v[96:99], v[68:71], v[136:139], v[96:99]
    v_mfma_f32_16x16x32_bf16 v[100:103], v[44:47], v[140:143], v[100:103]
    v_mfma_f32_16x16x32_bf16 v[72:75], v[44:47], v[136:139], v[72:75]
    s_waitcnt vmcnt(6)
    v_max_u32 v15, v144, v148
    v_cmp_eq_u32 vcc, -1, v15
    v_mfma_f32_16x16x32_bf16 v[104:107], v[48:51], v[140:143], v[104:107]
    v_mfma_f32_16x16x32_bf16 v[76:79], v[48:51], v[136:139], v[76:79]
    s_cbranch_vccnz P1_R14
P1_R14B:
    s_waitcnt lgkmcnt(6)
    v_mfma_f32_16x16x32_bf16 v[108:111], v[24:27], v[148:151], v[108:111]
    v_mfma_f32_16x16x32_bf16 v[80:83], v[24:27], v[144:147], v[80:83]
    s_waitcnt lgkmcnt(5)
    v_mfma_f32_16x16x32_bf16 v[112:115], v[28:31], v[148:151], v[112:115]
    ds_read_b128 v[52:55], v7 offset:59392
    v_mfma_f32_16x16x32_bf16 v[84:87], v[28:31], v[144:147], v[84:87]
    ds_read_b128 v[56:59], v7 offset:60416
    s_waitcnt lgkmcnt(2)
    v_mfma_f32_16x16x32_bf16 v[116:119], v[148:151], v[32:35], v[116:119]
    ds_read_b128 v[60:63], v7 offset:61440
    v_mfma_f32_16x16x32_bf16 v[88:91], v[144:147], v[32:35], v[88:91]
    ds_read_b128 v[64:67], v7 offset:62464
    v_mfma_f32_16x16x32_bf16 v[120:123], v[148:151], v[36:39], v[120:123]
    ds_read_b128 v[68:71], v7 offset:63488
    v_mfma_f32_16x16x32_bf16 v[92:95], v[144:147], v[36:39], v[92:95]
    ds_read_b128 v[44:47], v7 offset:57344
    v_mfma_f32_16x16x32_bf16 v[124:127], v[40:43], v[148:151], v[124:127]
    ds_read_b128 v[48:51], v7 offset:58368
    v_mfma_f32_16x16x32_bf16 v[96:99], v[40:43], v[144:147], v[96:99]
    v_mfma_f32_16x16x32_bf16 v[100:103], v[16:19], v[148:151], v[100:103]
    v_mfma_f32_16x16x32_bf16 v[72:75], v[16:19], v[144:147], v[72:75]
    s_waitcnt vmcnt(4)
    v_max_u32 v15, v152, v156
    v_cmp_eq_u32 vcc, -1, v15
    v_mfma_f32_16x16x32_bf16 v[104:107], v[20:23], v[148:151], v[104:107]
    v_mfma_f32_16x16x32_bf16 v[76:79], v[20:23], v[144:147], v[76:79]
    s_cbranch_vccnz P1_R15
P1_R15B:
    s_waitcnt lgkmcnt(6)
    v_mfma_f32_16x16x32_bf16 v[108:111], v[52:55], v[156:159], v[108:111]
    v_mfma_f32_16x16x32_bf16 v[80:83], v[52:55], v[152:155], v[80:83]
    s_waitcnt lgkmcnt(5)
    v_mfma_f32_16x16x32_bf16 v[112:115], v[56:59], v[156:159], v[112:115]
    s_cmp_lg_u32 s45, 0
    s_cbranch_scc1 P1_NB15
    s_barrier
P1_NB15:
    ds_read_b128 v[24:27], v8 offset:2048
    v_mfma_f32_16x16x32_bf16 v[84:87], v[56:59], v[152:155], v[84:87]
    ds_read_b128 v[28:31], v8 offset:3072
    s_waitcnt lgkmcnt(2)
    v_mfma_f32_16x16x32_bf16 v[116:119], v[156:159], v[60:63], v[116:119]
    ds_read_b128 v[32:35], v8 offset:4096
    v_mfma_f32_16x16x32_bf16 v[88:91], v[152:155], v[60:63], v[88:91]
    ds_read_b128 v[36:39], v8 offset:5120
    v_mfma_f32_16x16x32_bf16 v[120:123], v[156:159], v[64:67], v[120:123]
    ds_read_b128 v[40:43], v8 offset:6144
    v_mfma_f32_16x16x32_bf16 v[92:95], v[152:155], v[64:67], v[92:95]
    ds_read_b128 v[16:19], v8 offset:0
    v_mfma_f32_16x16x32_bf16 v[124:127], v[68:71], v[156:159], v[124:127]
    ds_read_b128 v[20:23], v8 offset:1024
    v_mfma_f32_16x16x32_bf16 v[96:99], v[68:71], v[152:155], v[96:99]
    v_mfma_f32_16x16x32_bf16 v[100:103], v[44:47], v[156:159], v[100:103]
    v_mfma_f32_16x16x32_bf16 v[72:75], v[44:47], v[152:155], v[72:75]
    s_waitcnt vmcnt(2)
    v_max_u32 v15, v160, v164
    v_cmp_eq_u32 vcc, -1, v15
    v_mfma_f32_16x16x32_bf16 v[104:107], v[48:51], v[156:159], v[104:107]
    v_mfma_f32_16x16x32_bf16 v[76:79], v[48:51], v[152:155], v[76:79]
    s_cbranch_vccnz P1_R16
P1_R16B:
    s_waitcnt lgkmcnt(6)
    v_mfma_f32_16x16x32_bf16 v[108:111], v[24:27], v[164:167], v[108:111]
    v_mfma_f32_16x16x32_bf16 v[80:83], v[24:27], v[160:163], v[80:83]
    s_waitcnt lgkmcnt(5)
    v_mfma_f32_16x16x32_bf16 v[112:115], v[28:31], v[164:167], v[112:115]
    ds_read_b128 v[52:55], v8 offset:10240
    v_mfma_f32_16x16x32_bf16 v[84:87], v[28:31], v[160:163], v[84:87]
    ds_read_b128 v[56:59], v8 offset:11264
    s_waitcnt lgkmcnt(2)
    v_mfma_f32_16x16x32_bf16 v[116:119], v[164:167], v[32:35], v[116:119]
    ds_read_b128 v[60:63], v8 offset:12288
    v_mfma_f32_16x16x32_bf16 v[88:91], v[160:163], v[32:35], v[88:91]
    ds_read_b128 v[64:67], v8 offset:13312
    v_mfma_f32_16x16x32_bf16 v[120:123], v[164:167], v[36:39], v[120:123]
    ds_read_b128 v[68:71], v8 offset:14336
    v_mfma_f32_16x16x32_bf16 v[92:95], v[160:163], v[36:39], v[92:95]
    ds_read_b128 v[44:47], v8 offset:8192
    v_mfma_f32_16x16x32_bf16 v[124:127], v[40:43], v[164:167], v[124:127]
    ds_read_b128 v[48:51], v8 offset:9216
    v_mfma_f32_16x16x32_bf16 v[96:99], v[40:43], v[160:163], v[96:99]
    v_mfma_f32_16x16x32_bf16 v[100:103], v[16:19], v[164:167], v[100:103]
    v_mfma_f32_16x16x32_bf16 v[72:75], v[16:19], v[160:163], v[72:75]
    s_waitcnt vmcnt(0)
    v_max_u32 v15, v168, v172
    v_cmp_eq_u32 vcc, -1, v15
    v_mfma_f32_16x16x32_bf16 v[104:107], v[20:23], v[164:167], v[104:107]
    v_mfma_f32_16x16x32_bf16 v[76:79], v[20:23], v[160:163], v[76:79]
    s_cbranch_vccnz P1_R17
P1_R17B:
    s_waitcnt lgkmcnt(6)
    v_mfma_f32_16x16x32_bf16 v[108:111], v[52:55], v[172:175], v[108:111]
    v_mfma_f32_16x16x32_bf16 v[80:83], v[52:55], v[168:171], v[80:83]
    s_waitcnt lgkmcnt(5)
    v_mfma_f32_16x16x32_bf16 v[112:115], v[56:59], v[172:175], v[112:115]
    v_mfma_f32_16x16x32_bf16 v[84:87], v[56:59], v[168:171], v[84:87]
    s_waitcnt lgkmcnt(0)
    v_mfma_f32_16x16x32_bf16 v[116:119], v[172:175], v[60:63], v[116:119]
    v_mfma_f32_16x16x32_bf16 v[88:91], v[168:171], v[60:63], v[88:91]
    v_mfma_f32_16x16x32_bf16 v[120:123], v[172:175], v[64:67], v[120:123]
    v_cvt_pk_bf16_f32 v232, v108, v109
    v_cvt_pk_bf16_f32 v233, v110, v111
    v_mfma_f32_16x16x32_bf16 v[92:95], v[168:171], v[64:67], v[92:95]
    v_cvt_pk_bf16_f32 v224, v80, v81
    v_cvt_pk_bf16_f32 v225, v82, v83
    v_mfma_f32_16x16x32_bf16 v[124:127], v[68:71], v[172:175], v[124:127]
    v_cvt_pk_bf16_f32 v236, v112, v113
    v_cvt_pk_bf16_f32 v237, v114, v115
    v_mfma_f32_16x16x32_bf16 v[96:99], v[68:71], v[168:171], v[96:99]
    v_cvt_pk_bf16_f32 v228, v84, v85
    v_cvt_pk_bf16_f32 v229, v86, v87
    ds_write_b64 v204, v[232:233] offset:2304
    v_mfma_f32_16x16x32_bf16 v[100:103], v[44:47], v[172:175], v[100:103]
    v_cvt_pk_bf16_f32 v20, v116, v117
    v_cvt_pk_bf16_f32 v21, v118, v119
    ds_write_b64 v204, v[236:237] offset:2816
    v_mfma_f32_16x16x32_bf16 v[72:75], v[44:47], v[168:171], v[72:75]
    v_cvt_pk_bf16_f32 v18, v88, v89
    v_cvt_pk_bf16_f32 v19, v90, v91
    v_mfma_f32_16x16x32_bf16 v[104:107], v[48:51], v[172:175], v[104:107]
    v_cvt_pk_bf16_f32 v26, v120, v121
    v_cvt_pk_bf16_f32 v27, v122, v123
    ds_write_b64 v204, v[20:21] offset:3328
    v_mfma_f32_16x16x32_bf16 v[76:79], v[48:51], v[168:171], v[76:79]
    v_cvt_pk_bf16_f32 v24, v92, v93
    v_cvt_pk_bf16_f32 v25, v94, v95
    v_cvt_pk_bf16_f32 v36, v124, v125
    v_cvt_pk_bf16_f32 v37, v126, v127
    ds_write_b64 v204, v[26:27] offset:3840
    v_cvt_pk_bf16_f32 v34, v96, v97
    v_cvt_pk_bf16_f32 v35, v98, v99
    v_cndmask_b32 v234, 0, v37, s[40:41]
    ds_write_b32 v205, v234 offset:4352
    s_mov_b32 exec_lo, 0
    s_mov_b32 exec_hi, 0xffff
    ds_write_b16 v207, v34 offset:32
    ds_write_b16_d16_hi v207, v34 offset:320
    ds_write_b16 v207, v35 offset:608
    ds_write_b16_d16_hi v207, v35 offset:896
    ds_write_b16 v207, v36 offset:64
    ds_write_b16_d16_hi v207, v36 offset:352
    ds_write_b16 v207, v37 offset:640
    ds_write_b16_d16_hi v207, v37 offset:928
    s_mov_b64 exec, -1
    v_cndmask_b32 v238, 0, v37, s[40:41]
    v_cndmask_b32 v226, 0, v35, s[40:41]
    v_cndmask_b32 v230, 0, v35, s[40:41]
    v_cvt_pk_bf16_f32 v248, v100, v101
    v_cvt_pk_bf16_f32 v249, v102, v103
    v_cndmask_b32 v250, 0, v36, s[36:37]
    v_cvt_pk_bf16_f32 v252, v104, v105
    v_cvt_pk_bf16_f32 v253, v106, v107
    v_cndmask_b32 v254, 0, v36, s[38:39]
    v_mfma_f32_16x16x32_bf16 v[168:171], v[232:235], v[248:251], 0
    v_mfma_f32_16x16x32_bf16 v[172:175], v[224:227], v[248:251], 0
    v_mfma_f32_16x16x32_bf16 v[176:179], v[236:239], v[252:255], 0
    v_mfma_f32_16x16x32_bf16 v[180:183], v[228:231], v[252:255], 0
    v_cvt_pk_bf16_f32 v240, v72, v73
    v_cvt_pk_bf16_f32 v241, v74, v75
    v_cndmask_b32 v242, 0, v34, s[36:37]
    v_cvt_pk_bf16_f32 v244, v76, v77
    v_cvt_pk_bf16_f32 v245, v78, v79
    v_cndmask_b32 v246, 0, v34, s[38:39]
    v_mfma_f32_16x16x32_bf16 v[152:155], v[224:227], v[240:243], 0
    s_nop 0
    v_mfma_f32_16x16x32_bf16 v[160:163], v[228:231], v[244:247], 0
    v_cndmask_b32 v168, v168, v169, s[30:31]
    v_cndmask_b32 v170, v170, v171, s[30:31]
    v_cndmask_b32 v172, v172, v173, s[30:31]
    v_cndmask_b32 v174, v174, v175, s[30:31]
    v_cndmask_b32 v168, v172, v168, s[32:33]
    v_cndmask_b32 v169, v174, v170, s[34:35]
    v_max_f32 v186, v168, v169
    v_cndmask_b32 v176, v176, v177, s[30:31]
    v_cndmask_b32 v178, v178, v179, s[30:31]
    v_cndmask_b32 v180, v180, v181, s[30:31]
    v_cndmask_b32 v182, v182, v183, s[30:31]
    v_cndmask_b32 v176, v180, v176, s[32:33]
    v_cndmask_b32 v177, v182, v178, s[34:35]
    v_max_f32 v187, v176, v177
    s_waitcnt lgkmcnt(0)
    s_barrier
    ds_read_b64 v[216:217], v204
    ds_read_b64 v[220:221], v204 offset:512
    ds_read_b32 v218, v205 offset:2048
    ds_read_b32 v222, v205 offset:2048
    ds_read_b64 v[16:17], v204 offset:1024
    ds_read_b64 v[22:23], v204 offset:1536
    ds_read_b64 v[28:29], v208
    ds_read_b64 v[30:31], v208 offset:32
    ds_read_b64 v[32:33], v208 offset:64
    v_cndmask_b32 v152, v152, v153, s[30:31]
    v_cndmask_b32 v154, v154, v155, s[30:31]
    v_cndmask_b32 v160, v160, v161, s[30:31]
    v_cndmask_b32 v162, v162, v163, s[30:31]
    v_permlane32_swap_b32 v186, v187
    s_waitcnt lgkmcnt(5)
    v_mfma_f32_16x16x32_bf16 v[156:159], v[216:219], v[240:243], v[212:215]
    v_mfma_f32_16x16x32_bf16 v[164:167], v[220:223], v[244:247], v[212:215]
    s_nop 6
    v_cndmask_b32 v156, v156, v157, s[30:31]
    v_cndmask_b32 v158, v158, v159, s[30:31]
    v_cndmask_b32 v152, v156, v152, s[32:33]
    v_cndmask_b32 v153, v158, v154, s[34:35]
    v_max_f32 v184, v152, v153
    v_cndmask_b32 v164, v164, v165, s[30:31]
    v_cndmask_b32 v166, v166, v167, s[30:31]
    v_cndmask_b32 v160, v164, v160, s[32:33]
    v_cndmask_b32 v161, v166, v162, s[34:35]
    v_max_f32 v185, v160, v161
    v_max_f32 v186, v186, v187
    s_nop 0
    v_permlane32_swap_b32 v184, v185
    v_max_f32 v184, v184, v185
    s_nop 1
    v_permlane16_swap_b32 v184, v186
    v_max_f32 v184, v184, v186
    v_mul_f32 v184, s42, v184
    v_mov_b32 v186, v184
    s_nop 1
    v_permlane16_swap_b32 v184, v186
    v_mov_b32 v185, v184
    v_mov_b32 v187, v186
    s_nop 0
    v_permlane32_swap_b32 v184, v185
    v_permlane32_swap_b32 v186, v187
    v_fma_f32 v152, v152, s42, -v184
    v_fma_f32 v153, v153, s42, -v184
    v_fma_f32 v160, v160, s42, -v185
    v_fma_f32 v161, v161, s42, -v185
    v_fma_f32 v168, v168, s42, -v186
    v_fma_f32 v169, v169, s42, -v186
    v_fma_f32 v176, v176, s42, -v187
    v_fma_f32 v177, v177, s42, -v187
    v_exp_f32 v168, v168
    v_exp_f32 v169, v169
    v_exp_f32 v176, v176
    v_exp_f32 v177, v177
    v_exp_f32 v152, v152
    v_exp_f32 v153, v153
    v_exp_f32 v160, v160
    v_exp_f32 v161, v161
    v_add_f32 v186, v168, v169
    v_add_f32 v187, v176, v177
    v_add_f32 v184, v152, v153
    v_add_f32 v185, v160, v161
    v_permlane32_swap_b32 v186, v187
    v_add_f32 v186, v186, v187
    v_permlane32_swap_b32 v184, v185
    v_add_f32 v184, v184, v185
    s_nop 1
    v_permlane16_swap_b32 v184, v186
    v_add_f32 v184, v184, v186
    v_rcp_f32 v184, v184
    s_nop 0
    v_mov_b32 v186, v184
    s_nop 1
    v_permlane16_swap_b32 v184, v186
    v_mov_b32 v185, v184
    v_mov_b32 v187, v186
    s_nop 0
    v_permlane32_swap_b32 v184, v185
    v_permlane32_swap_b32 v186, v187
    s_waitcnt lgkmcnt(0)
    v_mul_f32 v152, v152, v184
    v_mul_f32 v153, v153, v184
    v_cvt_pk_bf16_f32 v152, v152, v153
    v_perm_b32 v156, v152, v152, v200
    v_perm_b32 v157, v152, v152, v201
    v_perm_b32 v158, v152, v152, v202
    v_perm_b32 v159, v152, v152, v203
    v_mul_f32 v160, v160, v185
    v_mul_f32 v161, v161, v185
    v_cvt_pk_bf16_f32 v160, v160, v161
    v_perm_b32 v164, v160, v160, v200
    v_perm_b32 v165, v160, v160, v201
    v_perm_b32 v166, v160, v160, v202
    v_perm_b32 v167, v160, v160, v203
    v_mfma_f32_16x16x32_bf16 v[72:75], v[16:19], v[156:159], 0
    v_mfma_f32_16x16x32_bf16 v[88:91], v[28:31], v[156:159], 0
    v_mul_f32 v168, v168, v186
    v_mul_f32 v169, v169, v186
    v_cvt_pk_bf16_f32 v168, v168, v169
    v_perm_b32 v172, v168, v168, v200
    v_perm_b32 v173, v168, v168, v201
    v_perm_b32 v174, v168, v168, v202
    v_perm_b32 v175, v168, v168, v203
    v_mfma_f32_16x16x32_bf16 v[76:79], v[22:25], v[164:167], 0
    v_mfma_f32_16x16x32_bf16 v[92:95], v[28:31], v[164:167], 0
    v_mul_f32 v176, v176, v187
    v_mul_f32 v177, v177, v187
    v_cvt_pk_bf16_f32 v176, v176, v177
    v_perm_b32 v180, v176, v176, v200
    v_perm_b32 v181, v176, v176, v201
    v_perm_b32 v182, v176, v176, v202
    v_perm_b32 v183, v176, v176, v203
    v_mfma_f32_16x16x32_bf16 v[80:83], v[18:21], v[172:175], 0
    v_mfma_f32_16x16x32_bf16 v[96:99], v[30:33], v[172:175], 0
    v_mfma_f32_16x16x32_bf16 v[84:87], v[24:27], v[180:183], 0
    v_mfma_f32_16x16x32_bf16 v[100:103], v[30:33], v[180:183], 0
    v_cvt_pk_bf16_f32 v72, v72, v73
    v_cvt_pk_bf16_f32 v73, v74, v75
    v_cvt_pk_bf16_f32 v74, v76, v77
    v_cvt_pk_bf16_f32 v75, v78, v79
    v_cvt_pk_bf16_f32 v88, v88, v89
    v_cvt_pk_bf16_f32 v89, v94, v95
    v_permlane16_swap_b32 v72, v74
    v_permlane16_swap_b32 v73, v75
    v_min_u32 v88, -2, v88
    v_min_u32 v72, -2, v72
    buffer_store_dwordx4 v[72:75], v211, s[8:11], s20 offen sc1
    s_mov_b64 exec, 0xffff
    buffer_store_dwordx2 v[88:89], v210, s[8:11], s22 offen sc1
    s_mov_b64 exec, -1
    v_cvt_pk_bf16_f32 v80, v80, v81
    v_cvt_pk_bf16_f32 v81, v82, v83
    v_cvt_pk_bf16_f32 v82, v84, v85
    v_cvt_pk_bf16_f32 v83, v86, v87
    v_cvt_pk_bf16_f32 v96, v96, v97
    v_cvt_pk_bf16_f32 v97, v102, v103
    v_permlane16_swap_b32 v80, v82
    v_permlane16_swap_b32 v81, v83
    v_min_u32 v96, -2, v96
    v_min_u32 v80, -2, v80
    buffer_store_dwordx4 v[80:83], v211, s[8:11], s21 offen sc1
    s_mov_b64 exec, 0xffff
    buffer_store_dwordx2 v[96:97], v210, s[8:11], s23 offen sc1
    s_mov_b64 exec, -1
    s_barrier
    s_mov_b32 s6, s3
    s_lshl_b32 s16, s16, 1
    s_lshr_b32 s18, s17, 3
    s_add_u32 s16, s16, s18
    s_and_b32 s17, s17, 7
    s_lshl_b32 s43, s16, 2
    s_add_u32 s43, s43, s6
    s_mul_i32 s18, s43, 18432
    v_add_u32 v10, 0x10000, v5
    v_add_u32 v11, 0x20000, v5
    v_and_b32 v13, 1, v3
    v_lshlrev_b32 v14, 4, v3
    s_mul_i32 s21, s17, 320
    s_add_u32 s21, s21, 17022976
    s_add_u32 s24, s18, s44
    s_add_u32 s24, s24, 9437184
    s_lshl_b32 s7, s3, 10
    s_mul_i32 s29, s17, 92160
    s_add_u32 s29, s29, s7
    s_add_u32 s29, s29, 19834880
    s_add_u32 m0, s7, 94208
    s_add_u32 s28, s29, 0
    buffer_load_dwordx4 v5, s[8:11], s28 offen lds
    s_add_u32 m0, s7, 98304
    s_add_u32 s28, s29, 4096
    buffer_load_dwordx4 v5, s[8:11], s28 offen lds
    s_add_u32 m0, s7, 102400
    s_add_u32 s28, s29, 8192
    buffer_load_dwordx4 v5, s[8:11], s28 offen lds
    s_add_u32 m0, s7, 106496
    s_add_u32 s28, s29, 12288
    buffer_load_dwordx4 v5, s[8:11], s28 offen lds
    s_barrier
    s_add_u32 m0, s7, 110592
    s_add_u32 s28, s29, 16384
    buffer_load_dwordx4 v5, s[8:11], s28 offen lds
    s_add_u32 m0, s7, 114688
    s_add_u32 s28, s29, 20480
    buffer_load_dwordx4 v5, s[8:11], s28 offen lds
    s_add_u32 m0, s7, 118784
    s_add_u32 s28, s29, 24576
    buffer_load_dwordx4 v5, s[8:11], s28 offen lds
    s_add_u32 m0, s7, 122880
    s_add_u32 s28, s29, 28672
    buffer_load_dwordx4 v5, s[8:11], s28 offen lds
    s_add_u32 m0, s7, 126976
    s_add_u32 s28, s29, 32768
    buffer_load_dwordx4 v5, s[8:11], s28 offen lds
    s_add_u32 m0, s7, 131072
    s_add_u32 s28, s29, 36864
    buffer_load_dwordx4 v5, s[8:11], s28 offen lds
    s_add_u32 m0, s7, 135168
    s_add_u32 s28, s29, 40960
    buffer_load_dwordx4 v5, s[8:11], s28 offen lds
    s_add_u32 m0, s7, 139264
    s_add_u32 s28, s29, 45056
    buffer_load_dwordx4 v5, s[8:11], s28 offen lds
    s_add_u32 m0, s7, 143360
    s_add_u32 s28, s29, 49152
    buffer_load_dwordx4 v5, s[8:11], s28 offen lds
    s_add_u32 m0, s7, 147456
    s_add_u32 s28, s29, 53248
    buffer_load_dwordx4 v5, s[8:11], s28 offen lds
    s_add_u32 m0, s7, 151552
    s_add_u32 s28, s29, 57344
    buffer_load_dwordx4 v5, s[8:11], s28 offen lds
    s_add_u32 m0, s7, 155648
    s_add_u32 s28, s29, 61440
    buffer_load_dwordx4 v5, s[8:11], s28 offen lds
    s_cmp_lg_u32 s3, 0
    s_cbranch_scc1 P2_NC
    v_add_u32 v8, 2048, v5
    v_cndmask_b32 v8, v8, v5, s[40:41]
    s_mov_b32 m0, 160256
    s_nop 0
    buffer_load_dwordx4 v8, s[8:11], s21 offen lds
P2_NC:
    v_add_u32 v14, 160256, v14
    v_and_b32 v6, 2, v2
    v_cmp_eq_u32 s[32:33], 2, v6
    v_lshrrev_b32 v6, 2, v2
    v_lshl_add_u32 v6, v6, 4, v2
    v_lshlrev_b32 v6, 2, v6
    v_lshlrev_b32 v7, 2, v2
    v_lshrrev_b32 v8, 3, v2
    v_lshlrev_b32 v193, 10, v8
    v_lshlrev_b32 v192, 13, v8
    v_lshrrev_b32 v9, 1, v3
    v_lshl_add_u32 v192, v9, 9, v192
    v_and_b32 v9, 7, v2
    v_lshl_add_u32 v192, v9, 4, v192
    v_lshl_add_u32 v192, v13, 7, v192
    v_lshl_add_u32 v193, v3, 5, v193
    v_lshl_add_u32 v193, v9, 2, v193
    s_lshl_b32 s20, s43, 14
    s_lshl_b32 s21, s17, 10
    s_add_u32 s20, s20, s21
    s_add_u32 s20, s20, 14155776
    s_lshl_b32 s21, s43, 11
    s_lshl_b32 s22, s17, 7
    s_add_u32 s21, s21, s22
    s_add_u32 s21, s21, 16252928
    s_cmp_ge_u32 s17, 3
    s_cselect_b32 s22, 3, 0
    s_sub_u32 s22, s17, s22
    s_mul_i32 s22, s22, 6
    s_sub_u32 s22, s22, 2
    v_lshl_add_u32 v12, v3, 1, s22
    v_mul_u32_u24 v195, 320, v8
    v_and_b32 v196, 6, v2
    v_lshl_add_u32 v195, v196, 1, v195
    v_and_b32 v196, 1, v2
    v_add_u32 v196, v196, v12
    v_lshl_add_u32 v195, v196, 4, v195
    s_lshr_b32 s6, s43, 1
    s_and_b32 s7, s43, 1
    s_lshl_b32 s7, s7, 4
    v_add_u32 v8, s7, v2
    v_lshrrev_b32 v9, 3, v12
    v_lshlrev_b32 v194, 9, v9
    v_lshl_add_u32 v194, v8, 4, v194
    v_and_b32 v9, 7, v12
    v_lshl_add_u32 v194, v9, 1, v194
    s_lshl_b32 s7, s6, 10
    v_add_u32 v194, s7, v194
    s_lshr_b32 s7, s6, 3
    s_lshl_b32 s7, s7, 10
    s_and_b32 s6, s6, 7
    s_lshl_b32 s6, s6, 2
    s_add_u32 s7, s7, s6
    s_add_u32 s7, s7, 65536
    v_lshlrev_b32 v8, 5, v8
    v_add_u32 v8, s7, v8
    v_cmp_eq_u32 s[34:35], 16, v12
    s_nop 1
    v_cndmask_b32 v194, v194, v8, s[34:35]
    s_mul_i32 s6, s45, 253952
    v_mov_b32 v197, 0x05040100
    v_mov_b32 v196, 0x03020706
    v_cndmask_b32 v196, v197, v196, s[30:31]
    s_waitcnt vmcnt(0)
    s_add_u32 s25, s24, 4096
    s_add_u32 s26, s24, 8192
    s_add_u32 s27, s24, 12288
    s_add_u32 s28, s24, 16384
    s_waitcnt lgkmcnt(0)
    s_barrier
    ds_read_b128 v[172:175], v14 offset:0
    ds_read_b128 v[176:179], v14 offset:64
    ds_read_b128 v[180:183], v14 offset:128
    ds_read_b128 v[184:187], v14 offset:192
    ds_read_b128 v[188:191], v14 offset:256
    ds_read_b128 v[200:203], v14 offset:512
    ds_read_b128 v[204:207], v14 offset:576
    ds_read_b128 v[208:211], v14 offset:640
    ds_read_b128 v[212:215], v14 offset:704
    ds_read_b128 v[216:219], v14 offset:768
    s_waitcnt lgkmcnt(0)
    v_add_f32 v172, v172, v200
    v_add_f32 v173, v173, v201
    v_add_f32 v174, v174, v202
    v_add_f32 v175, v175, v203
    v_add_f32 v176, v176, v204
    v_add_f32 v177, v177, v205
    v_add_f32 v178, v178, v206
    v_add_f32 v179, v179, v207
    v_add_f32 v180, v180, v208
    v_add_f32 v181, v181, v209
    v_add_f32 v182, v182, v210
    v_add_f32 v183, v183, v211
    v_add_f32 v184, v184, v212
    v_add_f32 v185, v185, v213
    v_add_f32 v186, v186, v214
    v_add_f32 v187, v187, v215
    v_add_f32 v188, v188, v216
    v_add_f32 v189, v189, v217
    v_add_f32 v190, v190, v218
    v_add_f32 v191, v191, v219
    ds_read_b128 v[88:91], v10 offset:28672
    ds_read_b128 v[92:95], v10 offset:29696
    ds_read_b128 v[96:99], v10 offset:30720
    ds_read_b128 v[100:103], v10 offset:31744
    ds_read_b128 v[104:107], v10 offset:32768
    ds_read_b128 v[108:111], v10 offset:33792
    ds_read_b128 v[112:115], v10 offset:34816
    ds_read_b128 v[116:119], v10 offset:35840
    ds_read_b128 v[120:123], v10 offset:36864
    ds_read_b128 v[124:127], v10 offset:37888
    s_sleep 5
    buffer_load_dwordx4 v[16:19], v5, s[8:11], s24 offen offset:0 sc1
    buffer_load_dwordx4 v[20:23], v5, s[8:11], s24 offen offset:1024 sc1
    buffer_load_dwordx4 v[24:27], v5, s[8:11], s24 offen offset:2048 sc1
    buffer_load_dwordx4 v[28:31], v5, s[8:11], s24 offen offset:3072 sc1
    buffer_load_dwordx4 v[32:35], v5, s[8:11], s25 offen offset:0 sc1
    buffer_load_dwordx4 v[36:39], v5, s[8:11], s25 offen offset:1024 sc1
    buffer_load_dwordx4 v[40:43], v5, s[8:11], s25 offen offset:2048 sc1
    buffer_load_dwordx4 v[44:47], v5, s[8:11], s25 offen offset:3072 sc1
    buffer_load_dwordx4 v[48:51], v5, s[8:11], s26 offen offset:0 sc1
    buffer_load_dwordx4 v[52:55], v5, s[8:11], s26 offen offset:1024 sc1
    buffer_load_dwordx4 v[56:59], v5, s[8:11], s26 offen offset:2048 sc1
    buffer_load_dwordx4 v[60:63], v5, s[8:11], s26 offen offset:3072 sc1
    ds_read_b128 v[128:131], v10 offset:38912
    ds_read_b128 v[132:135], v10 offset:39936
    ds_read_b128 v[136:139], v10 offset:40960
    ds_read_b128 v[140:143], v10 offset:41984
    ds_read_b128 v[144:147], v10 offset:43008
    ds_read_b128 v[200:203], v10 offset:44032
    ds_read_b128 v[204:207], v10 offset:45056
    ds_read_b128 v[208:211], v10 offset:46080
    ds_read_b128 v[212:215], v10 offset:47104
    ds_read_b128 v[216:219], v10 offset:48128
    ds_read_b128 v[220:223], v10 offset:49152
    ds_read_b128 v[224:227], v10 offset:50176
    ds_read_b128 v[228:231], v10 offset:51200
    ds_read_b128 v[232:235], v10 offset:52224
    ds_read_b128 v[236:239], v10 offset:53248
    ds_read_b128 v[240:243], v10 offset:54272
    ds_read_b128 v[244:247], v10 offset:55296
    ds_read_b128 v[248:251], v10 offset:56320
    ds_read_b128 v[252:255], v10 offset:57344
    s_waitcnt vmcnt(10)
    v_max_u32 v15, v16, v20
    v_cmp_eq_u32 vcc, -1, v15
    s_cbranch_vccnz P3_R0
P3_R0B:
    v_mfma_f32_16x16x32_bf16 v[168:171], v[16:19], v[16:19], 0
    s_waitcnt lgkmcnt(6)
    v_mfma_f32_16x16x32_bf16 v[148:151], v[88:91], v[16:19], 0
    ds_read_b128 v[88:91], v10 offset:58368
    v_mfma_f32_16x16x32_bf16 v[152:155], v[92:95], v[16:19], 0
    ds_read_b128 v[92:95], v10 offset:59392
    buffer_load_dwordx4 v[64:67], v5, s[8:11], s27 offen offset:0 sc1
    v_mfma_f32_16x16x32_bf16 v[156:159], v[96:99], v[16:19], 0
    ds_read_b128 v[96:99], v10 offset:60416
    v_mfma_f32_16x16x32_bf16 v[160:163], v[100:103], v[16:19], 0
    ds_read_b128 v[100:103], v10 offset:61440
    v_mfma_f32_16x16x32_bf16 v[164:167], v[104:107], v[16:19], 0
    ds_read_b128 v[104:107], v10 offset:62464
    v_mfma_f32_16x16x32_bf16 v[168:171], v[20:23], v[20:23], v[168:171]
    v_mfma_f32_16x16x32_bf16 v[148:151], v[108:111], v[20:23], v[148:151]
    ds_read_b128 v[108:111], v10 offset:63488
    v_mfma_f32_16x16x32_bf16 v[152:155], v[112:115], v[20:23], v[152:155]
    ds_read_b128 v[112:115], v10 offset:64512
    buffer_load_dwordx4 v[68:71], v5, s[8:11], s27 offen offset:1024 sc1
    v_mfma_f32_16x16x32_bf16 v[156:159], v[116:119], v[20:23], v[156:159]
    ds_read_b128 v[116:119], v11 offset:0
    v_mfma_f32_16x16x32_bf16 v[160:163], v[120:123], v[20:23], v[160:163]
    ds_read_b128 v[120:123], v11 offset:1024
    s_waitcnt vmcnt(10)
    v_max_u32 v15, v24, v28
    v_cmp_eq_u32 vcc, -1, v15
    v_mfma_f32_16x16x32_bf16 v[164:167], v[124:127], v[20:23], v[164:167]
    s_cbranch_vccnz P3_R1
P3_R1B:
    v_mfma_f32_16x16x32_bf16 v[168:171], v[24:27], v[24:27], v[168:171]
    v_mfma_f32_16x16x32_bf16 v[148:151], v[128:131], v[24:27], v[148:151]
    ds_read_b128 v[124:127], v11 offset:2048
    v_mfma_f32_16x16x32_bf16 v[152:155], v[132:135], v[24:27], v[152:155]
    ds_read_b128 v[128:131], v11 offset:3072
    buffer_load_dwordx4 v[72:75], v5, s[8:11], s27 offen offset:2048 sc1
    v_mfma_f32_16x16x32_bf16 v[156:159], v[136:139], v[24:27], v[156:159]
    ds_read_b128 v[132:135], v11 offset:4096
    v_mfma_f32_16x16x32_bf16 v[160:163], v[140:143], v[24:27], v[160:163]
    ds_read_b128 v[136:139], v11 offset:5120
    v_mfma_f32_16x16x32_bf16 v[164:167], v[144:147], v[24:27], v[164:167]
    v_mfma_f32_16x16x32_bf16 v[168:171], v[28:31], v[28:31], v[168:171]
    v_mfma_f32_16x16x32_bf16 v[148:151], v[200:203], v[28:31], v[148:151]
    ds_read_b128 v[140:143], v11 offset:6144
    v_mfma_f32_16x16x32_bf16 v[152:155], v[204:207], v[28:31], v[152:155]
    ds_read_b128 v[144:147], v11 offset:7168
    buffer_load_dwordx4 v[76:79], v5, s[8:11], s27 offen offset:3072 sc1
    v_mfma_f32_16x16x32_bf16 v[156:159], v[208:211], v[28:31], v[156:159]
    ds_read_b128 v[200:203], v11 offset:8192
    v_mfma_f32_16x16x32_bf16 v[160:163], v[212:215], v[28:31], v[160:163]
    ds_read_b128 v[204:207], v11 offset:9216
    s_waitcnt vmcnt(10)
    v_max_u32 v15, v32, v36
    v_cmp_eq_u32 vcc, -1, v15
    v_mfma_f32_16x16x32_bf16 v[164:167], v[216:219], v[28:31], v[164:167]
    s_cbranch_vccnz P3_R2
P3_R2B:
    v_mfma_f32_16x16x32_bf16 v[168:171], v[32:35], v[32:35], v[168:171]
    s_waitcnt lgkmcnt(6)
    v_mfma_f32_16x16x32_bf16 v[148:151], v[220:223], v[32:35], v[148:151]
    ds_read_b128 v[208:211], v11 offset:10240
    v_mfma_f32_16x16x32_bf16 v[152:155], v[224:227], v[32:35], v[152:155]
    ds_read_b128 v[212:215], v11 offset:11264
    buffer_load_dwordx4 v[80:83], v5, s[8:11], s28 offen offset:0 sc1
    v_mfma_f32_16x16x32_bf16 v[156:159], v[228:231], v[32:35], v[156:159]
    ds_read_b128 v[216:219], v11 offset:12288
    v_mfma_f32_16x16x32_bf16 v[160:163], v[232:235], v[32:35], v[160:163]
    ds_read_b128 v[220:223], v11 offset:13312
    v_mfma_f32_16x16x32_bf16 v[164:167], v[236:239], v[32:35], v[164:167]
    v_mfma_f32_16x16x32_bf16 v[168:171], v[36:39], v[36:39], v[168:171]
    v_mfma_f32_16x16x32_bf16 v[148:151], v[240:243], v[36:39], v[148:151]
    ds_read_b128 v[224:227], v11 offset:14336
    v_mfma_f32_16x16x32_bf16 v[152:155], v[244:247], v[36:39], v[152:155]
    ds_read_b128 v[228:231], v11 offset:15360
    buffer_load_dwordx4 v[84:87], v5, s[8:11], s28 offen offset:1024 sc1
    v_mfma_f32_16x16x32_bf16 v[156:159], v[248:251], v[36:39], v[156:159]
    ds_read_b128 v[232:235], v11 offset:16384
    v_mfma_f32_16x16x32_bf16 v[160:163], v[252:255], v[36:39], v[160:163]
    ds_read_b128 v[236:239], v11 offset:17408
    s_waitcnt vmcnt(10)
    v_max_u32 v15, v40, v44
    v_cmp_eq_u32 vcc, -1, v15
    v_mfma_f32_16x16x32_bf16 v[164:167], v[88:91], v[36:39], v[164:167]
    s_cbranch_vccnz P3_R3
P3_R3B:
    v_mfma_f32_16x16x32_bf16 v[168:171], v[40:43], v[40:43], v[168:171]
    v_mfma_f32_16x16x32_bf16 v[148:151], v[92:95], v[40:43], v[148:151]
    ds_read_b128 v[240:243], v11 offset:18432
    v_mfma_f32_16x16x32_bf16 v[152:155], v[96:99], v[40:43], v[152:155]
    ds_read_b128 v[244:247], v11 offset:19456
    v_mfma_f32_16x16x32_bf16 v[156:159], v[100:103], v[40:43], v[156:159]
    ds_read_b128 v[248:251], v11 offset:20480
    v_mfma_f32_16x16x32_bf16 v[160:163], v[104:107], v[40:43], v[160:163]
    ds_read_b128 v[252:255], v11 offset:21504
    v_mfma_f32_16x16x32_bf16 v[164:167], v[108:111], v[40:43], v[164:167]
    v_mfma_f32_16x16x32_bf16 v[168:171], v[44:47], v[44:47], v[168:171]
    v_mfma_f32_16x16x32_bf16 v[148:151], v[112:115], v[44:47], v[148:151]
    ds_read_b128 v[88:91], v11 offset:22528
    v_mfma_f32_16x16x32_bf16 v[152:155], v[116:119], v[44:47], v[152:155]
    ds_read_b128 v[92:95], v11 offset:23552
    v_mfma_f32_16x16x32_bf16 v[156:159], v[120:123], v[44:47], v[156:159]
    ds_read_b128 v[96:99], v11 offset:24576
    v_mfma_f32_16x16x32_bf16 v[160:163], v[124:127], v[44:47], v[160:163]
    ds_read_b128 v[100:103], v11 offset:25600
    s_waitcnt vmcnt(8)
    v_max_u32 v15, v48, v52
    v_cmp_eq_u32 vcc, -1, v15
    v_mfma_f32_16x16x32_bf16 v[164:167], v[128:131], v[44:47], v[164:167]
    s_cbranch_vccnz P3_R4
P3_R4B:
    v_mfma_f32_16x16x32_bf16 v[168:171], v[48:51], v[48:51], v[168:171]
    s_waitcnt lgkmcnt(6)
    v_mfma_f32_16x16x32_bf16 v[148:151], v[132:135], v[48:51], v[148:151]
    ds_read_b128 v[104:107], v11 offset:26624
    v_mfma_f32_16x16x32_bf16 v[152:155], v[136:139], v[48:51], v[152:155]
    ds_read_b128 v[108:111], v11 offset:27648
    v_mfma_f32_16x16x32_bf16 v[156:159], v[140:143], v[48:51], v[156:159]
    v_mfma_f32_16x16x32_bf16 v[160:163], v[144:147], v[48:51], v[160:163]
    v_mfma_f32_16x16x32_bf16 v[164:167], v[200:203], v[48:51], v[164:167]
    v_mfma_f32_16x16x32_bf16 v[168:171], v[52:55], v[52:55], v[168:171]
    v_mfma_f32_16x16x32_bf16 v[148:151], v[204:207], v[52:55], v[148:151]
    v_mfma_f32_16x16x32_bf16 v[152:155], v[208:211], v[52:55], v[152:155]
    v_mfma_f32_16x16x32_bf16 v[156:159], v[212:215], v[52:55], v[156:159]
    v_mfma_f32_16x16x32_bf16 v[160:163], v[216:219], v[52:55], v[160:163]
    s_waitcnt vmcnt(6)
    v_max_u32 v15, v56, v60
    v_cmp_eq_u32 vcc, -1, v15
    v_mfma_f32_16x16x32_bf16 v[164:167], v[220:223], v[52:55], v[164:167]
    s_cbranch_vccnz P3_R5
P3_R5B:
    v_mfma_f32_16x16x32_bf16 v[168:171], v[56:59], v[56:59], v[168:171]
    v_mfma_f32_16x16x32_bf16 v[148:151], v[224:227], v[56:59], v[148:151]
    s_barrier
    ds_read_b128 v[112:115], v5 offset:0
    v_mfma_f32_16x16x32_bf16 v[152:155], v[228:231], v[56:59], v[152:155]
    ds_read_b128 v[116:119], v5 offset:1024
    v_mfma_f32_16x16x32_bf16 v[156:159], v[232:235], v[56:59], v[156:159]
    ds_read_b128 v[120:123], v5 offset:2048
    v_mfma_f32_16x16x32_bf16 v[160:163], v[236:239], v[56:59], v[160:163]
    ds_read_b128 v[124:127], v5 offset:3072
    v_mfma_f32_16x16x32_bf16 v[164:167], v[240:243], v[56:59], v[164:167]
    ds_read_b128 v[128:131], v5 offset:4096
    v_mfma_f32_16x16x32_bf16 v[168:171], v[60:63], v[60:63], v[168:171]
    s_waitcnt lgkmcnt(6)
    v_mfma_f32_16x16x32_bf16 v[148:151], v[244:247], v[60:63], v[148:151]
    ds_read_b128 v[132:135], v5 offset:5120
    v_mfma_f32_16x16x32_bf16 v[152:155], v[248:251], v[60:63], v[152:155]
    ds_read_b128 v[136:139], v5 offset:6144
    v_mfma_f32_16x16x32_bf16 v[156:159], v[252:255], v[60:63], v[156:159]
    ds_read_b128 v[140:143], v5 offset:7168
    v_mfma_f32_16x16x32_bf16 v[160:163], v[88:91], v[60:63], v[160:163]
    ds_read_b128 v[144:147], v5 offset:8192
    s_waitcnt vmcnt(4)
    v_max_u32 v15, v64, v68
    v_cmp_eq_u32 vcc, -1, v15
    v_mfma_f32_16x16x32_bf16 v[164:167], v[92:95], v[60:63], v[164:167]
    ds_read_b128 v[200:203], v5 offset:9216
    s_cbranch_vccnz P3_R6
P3_R6B:
    v_mfma_f32_16x16x32_bf16 v[168:171], v[64:67], v[64:67], v[168:171]
    s_waitcnt lgkmcnt(6)
    v_mfma_f32_16x16x32_bf16 v[148:151], v[96:99], v[64:67], v[148:151]
    ds_read_b128 v[204:207], v5 offset:10240
    v_mfma_f32_16x16x32_bf16 v[152:155], v[100:103], v[64:67], v[152:155]
    ds_read_b128 v[208:211], v5 offset:11264
    v_mfma_f32_16x16x32_bf16 v[156:159], v[104:107], v[64:67], v[156:159]
    ds_read_b128 v[212:215], v5 offset:12288
    v_mfma_f32_16x16x32_bf16 v[160:163], v[108:111], v[64:67], v[160:163]
    ds_read_b128 v[216:219], v5 offset:13312
    v_mfma_f32_16x16x32_bf16 v[164:167], v[112:115], v[64:67], v[164:167]
    ds_read_b128 v[220:223], v5 offset:14336
    v_mfma_f32_16x16x32_bf16 v[168:171], v[68:71], v[68:71], v[168:171]
    s_waitcnt lgkmcnt(6)
    v_mfma_f32_16x16x32_bf16 v[148:151], v[116:119], v[68:71], v[148:151]
    ds_read_b128 v[224:227], v5 offset:15360
    v_mfma_f32_16x16x32_bf16 v[152:155], v[120:123], v[68:71], v[152:155]
    ds_read_b128 v[228:231], v5 offset:16384
    v_mfma_f32_16x16x32_bf16 v[156:159], v[124:127], v[68:71], v[156:159]
    ds_read_b128 v[232:235], v5 offset:17408
    v_mfma_f32_16x16x32_bf16 v[160:163], v[128:131], v[68:71], v[160:163]
    ds_read_b128 v[236:239], v5 offset:18432
    s_waitcnt vmcnt(2)
    v_max_u32 v15, v72, v76
    v_cmp_eq_u32 vcc, -1, v15
    v_mfma_f32_16x16x32_bf16 v[164:167], v[132:135], v[68:71], v[164:167]
    ds_read_b128 v[240:243], v5 offset:19456
    s_cbranch_vccnz P3_R7
P3_R7B:
    v_mfma_f32_16x16x32_bf16 v[168:171], v[72:75], v[72:75], v[168:171]
    s_waitcnt lgkmcnt(6)
    v_mfma_f32_16x16x32_bf16 v[148:151], v[136:139], v[72:75], v[148:151]
    ds_read_b128 v[244:247], v5 offset:20480
    v_mfma_f32_16x16x32_bf16 v[152:155], v[140:143], v[72:75], v[152:155]
    ds_read_b128 v[248:251], v5 offset:21504
    v_mfma_f32_16x16x32_bf16 v[156:159], v[144:147], v[72:75], v[156:159]
    ds_read_b128 v[252:255], v5 offset:22528
    v_mfma_f32_16x16x32_bf16 v[160:163], v[200:203], v[72:75], v[160:163]
    ds_read_b128 v[88:91], v5 offset:23552
    v_mfma_f32_16x16x32_bf16 v[164:167], v[204:207], v[72:75], v[164:167]
    ds_read_b128 v[92:95], v5 offset:24576
    v_mfma_f32_16x16x32_bf16 v[168:171], v[76:79], v[76:79], v[168:171]
    s_waitcnt lgkmcnt(6)
    v_mfma_f32_16x16x32_bf16 v[148:151], v[208:211], v[76:79], v[148:151]
    ds_read_b128 v[96:99], v5 offset:25600
    v_mfma_f32_16x16x32_bf16 v[152:155], v[212:215], v[76:79], v[152:155]
    v_mfma_f32_16x16x32_bf16 v[156:159], v[216:219], v[76:79], v[156:159]
    v_mfma_f32_16x16x32_bf16 v[160:163], v[220:223], v[76:79], v[160:163]
    s_waitcnt vmcnt(0)
    v_max_u32 v15, v80, v84
    v_cmp_eq_u32 vcc, -1, v15
    v_mfma_f32_16x16x32_bf16 v[164:167], v[224:227], v[76:79], v[164:167]
    s_cbranch_vccnz P3_R8
P3_R8B:
    v_mfma_f32_16x16x32_bf16 v[168:171], v[80:83], v[80:83], v[168:171]
    s_waitcnt lgkmcnt(5)
    v_mfma_f32_16x16x32_bf16 v[148:151], v[228:231], v[80:83], v[148:151]
    v_mfma_f32_16x16x32_bf16 v[152:155], v[232:235], v[80:83], v[152:155]
    v_mfma_f32_16x16x32_bf16 v[156:159], v[236:239], v[80:83], v[156:159]
    v_mfma_f32_16x16x32_bf16 v[160:163], v[240:243], v[80:83], v[160:163]
    v_mfma_f32_16x16x32_bf16 v[164:167], v[244:247], v[80:83], v[164:167]
    v_mfma_f32_16x16x32_bf16 v[168:171], v[84:87], v[84:87], v[168:171]
    s_waitcnt lgkmcnt(0)
    v_mfma_f32_16x16x32_bf16 v[148:151], v[248:251], v[84:87], v[148:151]
    v_mfma_f32_16x16x32_bf16 v[152:155], v[252:255], v[84:87], v[152:155]
    v_mfma_f32_16x16x32_bf16 v[156:159], v[88:91], v[84:87], v[156:159]
    v_mfma_f32_16x16x32_bf16 v[160:163], v[92:95], v[84:87], v[160:163]
    v_mfma_f32_16x16x32_bf16 v[164:167], v[96:99], v[84:87], v[164:167]
    s_nop 1
    v_cndmask_b32 v168, v168, v169, s[30:31]
    v_cndmask_b32 v170, v170, v171, s[30:31]
    v_cndmask_b32 v168, v168, v170, s[32:33]
    ds_bpermute_b32 v9, v6, v168
    s_nop 1
    ds_bpermute_b32 v8, v7, v166
    s_waitcnt lgkmcnt(0)
    v_mul_f32 v8, 3135475257, v8
    v_mul_f32 v9, 987991609, v9
    v_fma_f32 v9, -v8, v8, v9
    v_max_f32 v9, 0, v9
    v_add_f32 v9, 925353388, v9
    v_rsq_f32 v9, v9
    v_fmac_f32 v166, v8, v190
    v_fmac_f32 v167, v8, v191
    v_mul_f32 v15, 1051597459, v9
    v_mul_f32 v166, v9, v166
    v_mul_f32 v167, v9, v167
    v_cvt_pk_bf16_f32 v16, v166, v167
    s_cmp_ge_u32 s17, 3
    s_cbranch_scc1 P3_V
    s_mov_b32 exec_lo, 0xffff0000
    s_add_u32 s22, s6, 16515072
    v_min_u32 v16, -2, v16
    buffer_store_dword v16, v194, s[8:11], s22 offen sc1
    s_branch P3_Q
P3_V:
    s_cmp_ge_u32 s17, 6
    s_cbranch_scc1 P3_Q
    s_mul_i32 s22, s43, 640
    s_add_u32 s22, s22, s6
    s_add_u32 s22, s22, 16588800
    v_mov_b32_dpp v17, v16 quad_perm:[1,0,3,2] row_mask:0xf bank_mask:0xf
    v_perm_b32 v16, v17, v16, v196
    s_nop 1
    v_mov_b32_dpp v17, v16 row_shl:2 row_mask:0xf bank_mask:0xf
    v_mov_b32_dpp v18, v16 row_shl:4 row_mask:0xf bank_mask:0xf
    v_mov_b32_dpp v19, v16 row_shl:6 row_mask:0xf bank_mask:0xf
    s_mov_b32 exec_lo, 0x03030000
    s_mov_b32 exec_hi, 0x03030303
    v_min_u32 v16, -2, v16
    buffer_store_dwordx4 v[16:19], v195, s[8:11], s22 offen sc1
P3_Q:
    s_mov_b64 exec, -1
    s_cmp_ge_u32 s17, 3
    s_cbranch_scc1 P3_E
    v_mul_f32 v17, v166, v166
    v_fmac_f32 v17, v167, v167
    v_cndmask_b32 v17, v17, 0, s[36:37]
    v_mov_b32 v18, v17
    s_lshl_b32 s22, s3, 2
    s_add_u32 s22, s22, 159872
    v_permlane32_swap_b32 v17, v18
    v_add_f32 v17, v17, v18
    v_mov_b32 v18, v17
    v_mov_b32 v19, s22
    s_nop 0
    v_permlane16_swap_b32 v17, v18
    v_add_f32 v17, v17, v18
    s_nop 1
    v_max_f32_dpp v17, v17, v17 row_ror:8 row_mask:0xf bank_mask:0xf
    s_nop 1
    v_max_f32_dpp v17, v17, v17 row_ror:4 row_mask:0xf bank_mask:0xf
    s_nop 1
    v_max_f32_dpp v17, v17, v17 row_ror:2 row_mask:0xf bank_mask:0xf
    s_nop 1
    v_max_f32_dpp v17, v17, v17 row_ror:1 row_mask:0xf bank_mask:0xf
    s_mov_b64 exec, 1
    ds_write_b32 v19, v17
    s_mov_b64 exec, -1
P3_E:
    s_waitcnt lgkmcnt(0)
    s_barrier
    v_fmac_f32 v148, v8, v172
    v_fmac_f32 v149, v8, v173
    v_fmac_f32 v150, v8, v174
    v_fmac_f32 v151, v8, v175
    v_fmac_f32 v152, v8, v176
    v_fmac_f32 v153, v8, v177
    v_fmac_f32 v154, v8, v178
    v_fmac_f32 v155, v8, v179
    v_fmac_f32 v156, v8, v180
    v_fmac_f32 v157, v8, v181
    v_fmac_f32 v158, v8, v182
    v_fmac_f32 v159, v8, v183
    v_fmac_f32 v160, v8, v184
    v_fmac_f32 v161, v8, v185
    v_fmac_f32 v162, v8, v186
    v_fmac_f32 v163, v8, v187
    v_fmac_f32 v164, v8, v188
    v_fmac_f32 v165, v8, v189
    v_mul_f32 v148, v15, v148
    v_mul_f32 v149, v15, v149
    v_mul_f32 v150, v15, v150
    v_mul_f32 v151, v15, v151
    v_mul_f32 v152, v15, v152
    v_mul_f32 v153, v15, v153
    v_mul_f32 v154, v15, v154
    v_mul_f32 v155, v15, v155
    v_cvt_pk_bf16_f32 v148, v148, v149
    v_cvt_pk_bf16_f32 v149, v150, v151
    v_cvt_pk_bf16_f32 v150, v152, v153
    v_cvt_pk_bf16_f32 v151, v154, v155
    s_nop 0
    v_permlane16_swap_b32 v148, v150
    v_permlane16_swap_b32 v149, v151
    v_min_u32 v148, -2, v148
    buffer_store_dwordx4 v[148:151], v192, s[8:11], s20 offen offset:0 sc1
    v_mul_f32 v156, v15, v156
    v_mul_f32 v157, v15, v157
    v_mul_f32 v158, v15, v158
    v_mul_f32 v159, v15, v159
    v_mul_f32 v160, v15, v160
    v_mul_f32 v161, v15, v161
    v_mul_f32 v162, v15, v162
    v_mul_f32 v163, v15, v163
    v_cvt_pk_bf16_f32 v156, v156, v157
    v_cvt_pk_bf16_f32 v157, v158, v159
    v_cvt_pk_bf16_f32 v158, v160, v161
    v_cvt_pk_bf16_f32 v159, v162, v163
    s_nop 0
    v_permlane16_swap_b32 v156, v158
    v_permlane16_swap_b32 v157, v159
    v_min_u32 v156, -2, v156
    buffer_store_dwordx4 v[156:159], v192, s[8:11], s20 offen offset:256 sc1
    v_mul_f32 v164, v15, v164
    v_mul_f32 v165, v15, v165
    v_cvt_pk_bf16_f32 v164, v164, v165
    v_min_u32 v164, -2, v164
    buffer_store_dword v164, v193, s[8:11], s21 offen sc1
    s_branch P4_BODY
P2_R0:
    s_add_u32 s46, s46, 1
    s_cmp_gt_u32 s46, 131072
    s_cbranch_scc1 P2_R0B
    s_sleep 1
    buffer_load_dwordx4 v[16:19], v5, s[8:11], s24 offen offset:0 sc1
    buffer_load_dwordx4 v[20:23], v5, s[8:11], s24 offen offset:1024 sc1
    buffer_load_dwordx4 v[24:27], v5, s[8:11], s24 offen offset:2048 sc1
    buffer_load_dwordx4 v[28:31], v5, s[8:11], s24 offen offset:3072 sc1
    buffer_load_dwordx4 v[32:35], v5, s[8:11], s25 offen offset:0 sc1
    buffer_load_dwordx4 v[36:39], v5, s[8:11], s25 offen offset:1024 sc1
    buffer_load_dwordx4 v[40:43], v5, s[8:11], s25 offen offset:2048 sc1
    buffer_load_dwordx4 v[44:47], v5, s[8:11], s25 offen offset:3072 sc1
    buffer_load_dwordx4 v[48:51], v5, s[8:11], s26 offen offset:0 sc1
    buffer_load_dwordx4 v[52:55], v5, s[8:11], s26 offen offset:1024 sc1
    buffer_load_dwordx4 v[56:59], v5, s[8:11], s26 offen offset:2048 sc1
    buffer_load_dwordx4 v[60:63], v5, s[8:11], s26 offen offset:3072 sc1
    s_waitcnt vmcnt(10)
    v_max_u32 v15, v16, v20
    v_cmp_eq_u32 vcc, -1, v15
    s_cbranch_vccnz P2_R0
    s_branch P2_R0B
P2_R1:
    s_add_u32 s46, s46, 1
    s_cmp_gt_u32 s46, 131072
    s_cbranch_scc1 P2_R1B
    s_sleep 1
    buffer_load_dwordx4 v[24:27], v5, s[8:11], s24 offen offset:2048 sc1
    buffer_load_dwordx4 v[28:31], v5, s[8:11], s24 offen offset:3072 sc1
    buffer_load_dwordx4 v[32:35], v5, s[8:11], s25 offen offset:0 sc1
    buffer_load_dwordx4 v[36:39], v5, s[8:11], s25 offen offset:1024 sc1
    buffer_load_dwordx4 v[40:43], v5, s[8:11], s25 offen offset:2048 sc1
    buffer_load_dwordx4 v[44:47], v5, s[8:11], s25 offen offset:3072 sc1
    buffer_load_dwordx4 v[48:51], v5, s[8:11], s26 offen offset:0 sc1
    buffer_load_dwordx4 v[52:55], v5, s[8:11], s26 offen offset:1024 sc1
    buffer_load_dwordx4 v[56:59], v5, s[8:11], s26 offen offset:2048 sc1
    buffer_load_dwordx4 v[60:63], v5, s[8:11], s26 offen offset:3072 sc1
    buffer_load_dwordx4 v[64:67], v5, s[8:11], s27 offen offset:0 sc1
    buffer_load_dwordx4 v[68:71], v5, s[8:11], s27 offen offset:1024 sc1
    s_waitcnt vmcnt(10)
    v_max_u32 v15, v24, v28
    v_cmp_eq_u32 vcc, -1, v15
    s_cbranch_vccnz P2_R1
    s_branch P2_R1B
P2_R2:
    s_add_u32 s46, s46, 1
    s_cmp_gt_u32 s46, 131072
    s_cbranch_scc1 P2_R2B
    s_sleep 1
    buffer_load_dwordx4 v[32:35], v5, s[8:11], s25 offen offset:0 sc1
    buffer_load_dwordx4 v[36:39], v5, s[8:11], s25 offen offset:1024 sc1
    buffer_load_dwordx4 v[40:43], v5, s[8:11], s25 offen offset:2048 sc1
    buffer_load_dwordx4 v[44:47], v5, s[8:11], s25 offen offset:3072 sc1
    buffer_load_dwordx4 v[48:51], v5, s[8:11], s26 offen offset:0 sc1
    buffer_load_dwordx4 v[52:55], v5, s[8:11], s26 offen offset:1024 sc1
    buffer_load_dwordx4 v[56:59], v5, s[8:11], s26 offen offset:2048 sc1
    buffer_load_dwordx4 v[60:63], v5, s[8:11], s26 offen offset:3072 sc1
    buffer_load_dwordx4 v[64:67], v5, s[8:11], s27 offen offset:0 sc1
    buffer_load_dwordx4 v[68:71], v5, s[8:11], s27 offen offset:1024 sc1
    buffer_load_dwordx4 v[72:75], v5, s[8:11], s27 offen offset:2048 sc1
    buffer_load_dwordx4 v[76:79], v5, s[8:11], s27 offen offset:3072 sc1
    s_waitcnt vmcnt(10)
    v_max_u32 v15, v32, v36
    v_cmp_eq_u32 vcc, -1, v15
    s_cbranch_vccnz P2_R2
    s_branch P2_R2B
P2_R3:
    s_add_u32 s46, s46, 1
    s_cmp_gt_u32 s46, 131072
    s_cbranch_scc1 P2_R3B
    s_sleep 1
    buffer_load_dwordx4 v[40:43], v5, s[8:11], s25 offen offset:2048 sc1
    buffer_load_dwordx4 v[44:47], v5, s[8:11], s25 offen offset:3072 sc1
    buffer_load_dwordx4 v[48:51], v5, s[8:11], s26 offen offset:0 sc1
    buffer_load_dwordx4 v[52:55], v5, s[8:11], s26 offen offset:1024 sc1
    buffer_load_dwordx4 v[56:59], v5, s[8:11], s26 offen offset:2048 sc1
    buffer_load_dwordx4 v[60:63], v5, s[8:11], s26 offen offset:3072 sc1
    buffer_load_dwordx4 v[64:67], v5, s[8:11], s27 offen offset:0 sc1
    buffer_load_dwordx4 v[68:71], v5, s[8:11], s27 offen offset:1024 sc1
    buffer_load_dwordx4 v[72:75], v5, s[8:11], s27 offen offset:2048 sc1
    buffer_load_dwordx4 v[76:79], v5, s[8:11], s27 offen offset:3072 sc1
    buffer_load_dwordx4 v[80:83], v5, s[8:11], s28 offen offset:0 sc1
    buffer_load_dwordx4 v[84:87], v5, s[8:11], s28 offen offset:1024 sc1
    s_waitcnt vmcnt(10)
    v_max_u32 v15, v40, v44
    v_cmp_eq_u32 vcc, -1, v15
    s_cbranch_vccnz P2_R3
    s_branch P2_R3B
P2_R4:
    s_add_u32 s46, s46, 1
    s_cmp_gt_u32 s46, 131072
    s_cbranch_scc1 P2_R4B
    s_sleep 1
    buffer_load_dwordx4 v[48:51], v5, s[8:11], s26 offen offset:0 sc1
    buffer_load_dwordx4 v[52:55], v5, s[8:11], s26 offen offset:1024 sc1
    buffer_load_dwordx4 v[56:59], v5, s[8:11], s26 offen offset:2048 sc1
    buffer_load_dwordx4 v[60:63], v5, s[8:11], s26 offen offset:3072 sc1
    buffer_load_dwordx4 v[64:67], v5, s[8:11], s27 offen offset:0 sc1
    buffer_load_dwordx4 v[68:71], v5, s[8:11], s27 offen offset:1024 sc1
    buffer_load_dwordx4 v[72:75], v5, s[8:11], s27 offen offset:2048 sc1
    buffer_load_dwordx4 v[76:79], v5, s[8:11], s27 offen offset:3072 sc1
    buffer_load_dwordx4 v[80:83], v5, s[8:11], s28 offen offset:0 sc1
    buffer_load_dwordx4 v[84:87], v5, s[8:11], s28 offen offset:1024 sc1
    s_waitcnt vmcnt(8)
    v_max_u32 v15, v48, v52
    v_cmp_eq_u32 vcc, -1, v15
    s_cbranch_vccnz P2_R4
    s_branch P2_R4B
P2_R5:
    s_add_u32 s46, s46, 1
    s_cmp_gt_u32 s46, 131072
    s_cbranch_scc1 P2_R5B
    s_sleep 1
    buffer_load_dwordx4 v[56:59], v5, s[8:11], s26 offen offset:2048 sc1
    buffer_load_dwordx4 v[60:63], v5, s[8:11], s26 offen offset:3072 sc1
    buffer_load_dwordx4 v[64:67], v5, s[8:11], s27 offen offset:0 sc1
    buffer_load_dwordx4 v[68:71], v5, s[8:11], s27 offen offset:1024 sc1
    buffer_load_dwordx4 v[72:75], v5, s[8:11], s27 offen offset:2048 sc1
    buffer_load_dwordx4 v[76:79], v5, s[8:11], s27 offen offset:3072 sc1
    buffer_load_dwordx4 v[80:83], v5, s[8:11], s28 offen offset:0 sc1
    buffer_load_dwordx4 v[84:87], v5, s[8:11], s28 offen offset:1024 sc1
    s_waitcnt vmcnt(6)
    v_max_u32 v15, v56, v60
    v_cmp_eq_u32 vcc, -1, v15
    s_cbranch_vccnz P2_R5
    s_branch P2_R5B
P2_R6:
    s_add_u32 s46, s46, 1
    s_cmp_gt_u32 s46, 131072
    s_cbranch_scc1 P2_R6B
    s_sleep 1
    buffer_load_dwordx4 v[64:67], v5, s[8:11], s27 offen offset:0 sc1
    buffer_load_dwordx4 v[68:71], v5, s[8:11], s27 offen offset:1024 sc1
    buffer_load_dwordx4 v[72:75], v5, s[8:11], s27 offen offset:2048 sc1
    buffer_load_dwordx4 v[76:79], v5, s[8:11], s27 offen offset:3072 sc1
    buffer_load_dwordx4 v[80:83], v5, s[8:11], s28 offen offset:0 sc1
    buffer_load_dwordx4 v[84:87], v5, s[8:11], s28 offen offset:1024 sc1
    s_waitcnt vmcnt(4)
    v_max_u32 v15, v64, v68
    v_cmp_eq_u32 vcc, -1, v15
    s_cbranch_vccnz P2_R6
    s_branch P2_R6B
P2_R7:
    s_add_u32 s46, s46, 1
    s_cmp_gt_u32 s46, 131072
    s_cbranch_scc1 P2_R7B
    s_sleep 1
    buffer_load_dwordx4 v[72:75], v5, s[8:11], s27 offen offset:2048 sc1
    buffer_load_dwordx4 v[76:79], v5, s[8:11], s27 offen offset:3072 sc1
    buffer_load_dwordx4 v[80:83], v5, s[8:11], s28 offen offset:0 sc1
    buffer_load_dwordx4 v[84:87], v5, s[8:11], s28 offen offset:1024 sc1
    s_waitcnt vmcnt(2)
    v_max_u32 v15, v72, v76
    v_cmp_eq_u32 vcc, -1, v15
    s_cbranch_vccnz P2_R7
    s_branch P2_R7B
P2_R8:
    s_add_u32 s46, s46, 1
    s_cmp_gt_u32 s46, 131072
    s_cbranch_scc1 P2_R8B
    s_sleep 1
    buffer_load_dwordx4 v[80:83], v5, s[8:11], s28 offen offset:0 sc1
    buffer_load_dwordx4 v[84:87], v5, s[8:11], s28 offen offset:1024 sc1
    s_waitcnt vmcnt(0)
    v_max_u32 v15, v80, v84
    v_max3_u32 v15, v82, v86, v15
    v_cmp_eq_u32 vcc, -1, v15
    s_cbranch_vccnz P2_R8
    s_branch P2_R8B
P1_R0:
    s_add_u32 s46, s46, 1
    s_cmp_gt_u32 s46, 131072
    s_cbranch_scc1 P1_R0B
    s_sleep 1
    buffer_load_dwordx4 v[128:131], v5, s[8:11], s6 offen offset:0 sc1
    buffer_load_dwordx4 v[132:135], v5, s[8:11], s24 offen offset:2048 sc1
    buffer_load_dwordx4 v[136:139], v5, s[8:11], s6 offen offset:1024 sc1
    buffer_load_dwordx4 v[140:143], v5, s[8:11], s24 offen offset:3072 sc1
    buffer_load_dwordx4 v[144:147], v5, s[8:11], s6 offen offset:2048 sc1
    buffer_load_dwordx4 v[148:151], v5, s[8:11], s25 offen offset:0 sc1
    buffer_load_dwordx4 v[152:155], v5, s[8:11], s6 offen offset:3072 sc1
    buffer_load_dwordx4 v[156:159], v5, s[8:11], s25 offen offset:1024 sc1
    buffer_load_dwordx4 v[160:163], v5, s[8:11], s7 offen offset:0 sc1
    buffer_load_dwordx4 v[164:167], v5, s[8:11], s25 offen offset:2048 sc1
    s_waitcnt vmcnt(8)
    v_max_u32 v15, v128, v132
    v_cmp_eq_u32 vcc, -1, v15
    s_cbranch_vccnz P1_R0
    s_branch P1_R0B
P1_R1:
    s_add_u32 s46, s46, 1
    s_cmp_gt_u32 s46, 131072
    s_cbranch_scc1 P1_R1B
    s_sleep 1
    buffer_load_dwordx4 v[136:139], v5, s[8:11], s6 offen offset:1024 sc1
    buffer_load_dwordx4 v[140:143], v5, s[8:11], s24 offen offset:3072 sc1
    buffer_load_dwordx4 v[144:147], v5, s[8:11], s6 offen offset:2048 sc1
    buffer_load_dwordx4 v[148:151], v5, s[8:11], s25 offen offset:0 sc1
    buffer_load_dwordx4 v[152:155], v5, s[8:11], s6 offen offset:3072 sc1
    buffer_load_dwordx4 v[156:159], v5, s[8:11], s25 offen offset:1024 sc1
    buffer_load_dwordx4 v[160:163], v5, s[8:11], s7 offen offset:0 sc1
    buffer_load_dwordx4 v[164:167], v5, s[8:11], s25 offen offset:2048 sc1
    buffer_load_dwordx4 v[168:171], v5, s[8:11], s7 offen offset:1024 sc1
    buffer_load_dwordx4 v[172:175], v5, s[8:11], s25 offen offset:3072 sc1
    s_waitcnt vmcnt(8)
    v_max_u32 v15, v136, v140
    v_cmp_eq_u32 vcc, -1, v15
    s_cbranch_vccnz P1_R1
    s_branch P1_R1B
P1_R2:
    s_add_u32 s46, s46, 1
    s_cmp_gt_u32 s46, 131072
    s_cbranch_scc1 P1_R2B
    s_sleep 1
    buffer_load_dwordx4 v[144:147], v5, s[8:11], s6 offen offset:2048 sc1
    buffer_load_dwordx4 v[148:151], v5, s[8:11], s25 offen offset:0 sc1
    buffer_load_dwordx4 v[152:155], v5, s[8:11], s6 offen offset:3072 sc1
    buffer_load_dwordx4 v[156:159], v5, s[8:11], s25 offen offset:1024 sc1
    buffer_load_dwordx4 v[160:163], v5, s[8:11], s7 offen offset:0 sc1
    buffer_load_dwordx4 v[164:167], v5, s[8:11], s25 offen offset:2048 sc1
    buffer_load_dwordx4 v[168:171], v5, s[8:11], s7 offen offset:1024 sc1
    buffer_load_dwordx4 v[172:175], v5, s[8:11], s25 offen offset:3072 sc1
    buffer_load_dwordx4 v[128:131], v5, s[8:11], s7 offen offset:2048 sc1
    buffer_load_dwordx4 v[132:135], v5, s[8:11], s26 offen offset:0 sc1
    s_waitcnt vmcnt(8)
    v_max_u32 v15, v144, v148
    v_cmp_eq_u32 vcc, -1, v15
    s_cbranch_vccnz P1_R2
    s_branch P1_R2B
P1_R3:
    s_add_u32 s46, s46, 1
    s_cmp_gt_u32 s46, 131072
    s_cbranch_scc1 P1_R3B
    s_sleep 1
    buffer_load_dwordx4 v[152:155], v5, s[8:11], s6 offen offset:3072 sc1
    buffer_load_dwordx4 v[156:159], v5, s[8:11], s25 offen offset:1024 sc1
    buffer_load_dwordx4 v[160:163], v5, s[8:11], s7 offen offset:0 sc1
    buffer_load_dwordx4 v[164:167], v5, s[8:11], s25 offen offset:2048 sc1
    buffer_load_dwordx4 v[168:171], v5, s[8:11], s7 offen offset:1024 sc1
    buffer_load_dwordx4 v[172:175], v5, s[8:11], s25 offen offset:3072 sc1
    buffer_load_dwordx4 v[128:131], v5, s[8:11], s7 offen offset:2048 sc1
    buffer_load_dwordx4 v[132:135], v5, s[8:11], s26 offen offset:0 sc1
    buffer_load_dwordx4 v[136:139], v5, s[8:11], s7 offen offset:3072 sc1
    buffer_load_dwordx4 v[140:143], v5, s[8:11], s26 offen offset:1024 sc1
    s_waitcnt vmcnt(8)
    v_max_u32 v15, v152, v156
    v_cmp_eq_u32 vcc, -1, v15
    s_cbranch_vccnz P1_R3
    s_branch P1_R3B
P1_R4:
    s_add_u32 s46, s46, 1
    s_cmp_gt_u32 s46, 131072
    s_cbranch_scc1 P1_R4B
    s_sleep 1
    buffer_load_dwordx4 v[160:163], v5, s[8:11], s7 offen offset:0 sc1
    buffer_load_dwordx4 v[164:167], v5, s[8:11], s25 offen offset:2048 sc1
    buffer_load_dwordx4 v[168:171], v5, s[8:11], s7 offen offset:1024 sc1
    buffer_load_dwordx4 v[172:175], v5, s[8:11], s25 offen offset:3072 sc1
    buffer_load_dwordx4 v[128:131], v5, s[8:11], s7 offen offset:2048 sc1
    buffer_load_dwordx4 v[132:135], v5, s[8:11], s26 offen offset:0 sc1
    buffer_load_dwordx4 v[136:139], v5, s[8:11], s7 offen offset:3072 sc1
    buffer_load_dwordx4 v[140:143], v5, s[8:11], s26 offen offset:1024 sc1
    buffer_load_dwordx4 v[144:147], v5, s[8:11], s18 offen offset:0 sc1
    buffer_load_dwordx4 v[148:151], v5, s[8:11], s26 offen offset:2048 sc1
    s_waitcnt vmcnt(8)
    v_max_u32 v15, v160, v164
    v_cmp_eq_u32 vcc, -1, v15
    s_cbranch_vccnz P1_R4
    s_branch P1_R4B
P1_R5:
    s_add_u32 s46, s46, 1
    s_cmp_gt_u32 s46, 131072
    s_cbranch_scc1 P1_R5B
    s_sleep 1
    buffer_load_dwordx4 v[168:171], v5, s[8:11], s7 offen offset:1024 sc1
    buffer_load_dwordx4 v[172:175], v5, s[8:11], s25 offen offset:3072 sc1
    buffer_load_dwordx4 v[128:131], v5, s[8:11], s7 offen offset:2048 sc1
    buffer_load_dwordx4 v[132:135], v5, s[8:11], s26 offen offset:0 sc1
    buffer_load_dwordx4 v[136:139], v5, s[8:11], s7 offen offset:3072 sc1
    buffer_load_dwordx4 v[140:143], v5, s[8:11], s26 offen offset:1024 sc1
    buffer_load_dwordx4 v[144:147], v5, s[8:11], s18 offen offset:0 sc1
    buffer_load_dwordx4 v[148:151], v5, s[8:11], s26 offen offset:2048 sc1
    buffer_load_dwordx4 v[152:155], v5, s[8:11], s18 offen offset:1024 sc1
    buffer_load_dwordx4 v[156:159], v5, s[8:11], s26 offen offset:3072 sc1
    s_waitcnt vmcnt(8)
    v_max_u32 v15, v168, v172
    v_cmp_eq_u32 vcc, -1, v15
    s_cbranch_vccnz P1_R5
    s_branch P1_R5B
P1_R6:
    s_add_u32 s46, s46, 1
    s_cmp_gt_u32 s46, 131072
    s_cbranch_scc1 P1_R6B
    s_sleep 1
    buffer_load_dwordx4 v[128:131], v5, s[8:11], s7 offen offset:2048 sc1
    buffer_load_dwordx4 v[132:135], v5, s[8:11], s26 offen offset:0 sc1
    buffer_load_dwordx4 v[136:139], v5, s[8:11], s7 offen offset:3072 sc1
    buffer_load_dwordx4 v[140:143], v5, s[8:11], s26 offen offset:1024 sc1
    buffer_load_dwordx4 v[144:147], v5, s[8:11], s18 offen offset:0 sc1
    buffer_load_dwordx4 v[148:151], v5, s[8:11], s26 offen offset:2048 sc1
    buffer_load_dwordx4 v[152:155], v5, s[8:11], s18 offen offset:1024 sc1
    buffer_load_dwordx4 v[156:159], v5, s[8:11], s26 offen offset:3072 sc1
    buffer_load_dwordx4 v[160:163], v5, s[8:11], s18 offen offset:2048 sc1
    buffer_load_dwordx4 v[164:167], v5, s[8:11], s43 offen offset:0 sc1
    s_waitcnt vmcnt(8)
    v_max_u32 v15, v128, v132
    v_cmp_eq_u32 vcc, -1, v15
    s_cbranch_vccnz P1_R6
    s_branch P1_R6B
P1_R7:
    s_add_u32 s46, s46, 1
    s_cmp_gt_u32 s46, 131072
    s_cbranch_scc1 P1_R7B
    s_sleep 1
    buffer_load_dwordx4 v[136:139], v5, s[8:11], s7 offen offset:3072 sc1
    buffer_load_dwordx4 v[140:143], v5, s[8:11], s26 offen offset:1024 sc1
    buffer_load_dwordx4 v[144:147], v5, s[8:11], s18 offen offset:0 sc1
    buffer_load_dwordx4 v[148:151], v5, s[8:11], s26 offen offset:2048 sc1
    buffer_load_dwordx4 v[152:155], v5, s[8:11], s18 offen offset:1024 sc1
    buffer_load_dwordx4 v[156:159], v5, s[8:11], s26 offen offset:3072 sc1
    buffer_load_dwordx4 v[160:163], v5, s[8:11], s18 offen offset:2048 sc1
    buffer_load_dwordx4 v[164:167], v5, s[8:11], s43 offen offset:0 sc1
    buffer_load_dwordx4 v[168:171], v5, s[8:11], s18 offen offset:3072 sc1
    buffer_load_dwordx4 v[172:175], v5, s[8:11], s43 offen offset:1024 sc1
    s_waitcnt vmcnt(8)
    v_max_u32 v15, v136, v140
    v_cmp_eq_u32 vcc, -1, v15
    s_cbranch_vccnz P1_R7
    s_branch P1_R7B
P1_R8:
    s_add_u32 s46, s46, 1
    s_cmp_gt_u32 s46, 131072
    s_cbranch_scc1 P1_R8B
    s_sleep 1
    buffer_load_dwordx4 v[144:147], v5, s[8:11], s18 offen offset:0 sc1
    buffer_load_dwordx4 v[148:151], v5, s[8:11], s26 offen offset:2048 sc1
    buffer_load_dwordx4 v[152:155], v5, s[8:11], s18 offen offset:1024 sc1
    buffer_load_dwordx4 v[156:159], v5, s[8:11], s26 offen offset:3072 sc1
    buffer_load_dwordx4 v[160:163], v5, s[8:11], s18 offen offset:2048 sc1
    buffer_load_dwordx4 v[164:167], v5, s[8:11], s43 offen offset:0 sc1
    buffer_load_dwordx4 v[168:171], v5, s[8:11], s18 offen offset:3072 sc1
    buffer_load_dwordx4 v[172:175], v5, s[8:11], s43 offen offset:1024 sc1
    buffer_load_dwordx4 v[128:131], v5, s[8:11], s19 offen offset:0 sc1
    buffer_load_dwordx4 v[132:135], v5, s[8:11], s43 offen offset:2048 sc1
    s_waitcnt vmcnt(8)
    v_max_u32 v15, v144, v148
    v_cmp_eq_u32 vcc, -1, v15
    s_cbranch_vccnz P1_R8
    s_branch P1_R8B
P1_R9:
    s_add_u32 s46, s46, 1
    s_cmp_gt_u32 s46, 131072
    s_cbranch_scc1 P1_R9B
    s_sleep 1
    buffer_load_dwordx4 v[152:155], v5, s[8:11], s18 offen offset:1024 sc1
    buffer_load_dwordx4 v[156:159], v5, s[8:11], s26 offen offset:3072 sc1
    buffer_load_dwordx4 v[160:163], v5, s[8:11], s18 offen offset:2048 sc1
    buffer_load_dwordx4 v[164:167], v5, s[8:11], s43 offen offset:0 sc1
    buffer_load_dwordx4 v[168:171], v5, s[8:11], s18 offen offset:3072 sc1
    buffer_load_dwordx4 v[172:175], v5, s[8:11], s43 offen offset:1024 sc1
    buffer_load_dwordx4 v[128:131], v5, s[8:11], s19 offen offset:0 sc1
    buffer_load_dwordx4 v[132:135], v5, s[8:11], s43 offen offset:2048 sc1
    buffer_load_dwordx4 v[136:139], v5, s[8:11], s19 offen offset:1024 sc1
    buffer_load_dwordx4 v[140:143], v5, s[8:11], s43 offen offset:3072 sc1
    s_waitcnt vmcnt(8)
    v_max_u32 v15, v152, v156
    v_cmp_eq_u32 vcc, -1, v15
    s_cbranch_vccnz P1_R9
    s_branch P1_R9B
P1_R10:
    s_add_u32 s46, s46, 1
    s_cmp_gt_u32 s46, 131072
    s_cbranch_scc1 P1_R10B
    s_sleep 1
    buffer_load_dwordx4 v[160:163], v5, s[8:11], s18 offen offset:2048 sc1
    buffer_load_dwordx4 v[164:167], v5, s[8:11], s43 offen offset:0 sc1
    buffer_load_dwordx4 v[168:171], v5, s[8:11], s18 offen offset:3072 sc1
    buffer_load_dwordx4 v[172:175], v5, s[8:11], s43 offen offset:1024 sc1
    buffer_load_dwordx4 v[128:131], v5, s[8:11], s19 offen offset:0 sc1
    buffer_load_dwordx4 v[132:135], v5, s[8:11], s43 offen offset:2048 sc1
    buffer_load_dwordx4 v[136:139], v5, s[8:11], s19 offen offset:1024 sc1
    buffer_load_dwordx4 v[140:143], v5, s[8:11], s43 offen offset:3072 sc1
    buffer_load_dwordx4 v[144:147], v5, s[8:11], s19 offen offset:2048 sc1
    buffer_load_dwordx4 v[148:151], v5, s[8:11], s47 offen offset:0 sc1
    s_waitcnt vmcnt(8)
    v_max_u32 v15, v160, v164
    v_cmp_eq_u32 vcc, -1, v15
    s_cbranch_vccnz P1_R10
    s_branch P1_R10B
P1_R11:
    s_add_u32 s46, s46, 1
    s_cmp_gt_u32 s46, 131072
    s_cbranch_scc1 P1_R11B
    s_sleep 1
    buffer_load_dwordx4 v[168:171], v5, s[8:11], s18 offen offset:3072 sc1
    buffer_load_dwordx4 v[172:175], v5, s[8:11], s43 offen offset:1024 sc1
    buffer_load_dwordx4 v[128:131], v5, s[8:11], s19 offen offset:0 sc1
    buffer_load_dwordx4 v[132:135], v5, s[8:11], s43 offen offset:2048 sc1
    buffer_load_dwordx4 v[136:139], v5, s[8:11], s19 offen offset:1024 sc1
    buffer_load_dwordx4 v[140:143], v5, s[8:11], s43 offen offset:3072 sc1
    buffer_load_dwordx4 v[144:147], v5, s[8:11], s19 offen offset:2048 sc1
    buffer_load_dwordx4 v[148:151], v5, s[8:11], s47 offen offset:0 sc1
    buffer_load_dwordx4 v[152:155], v5, s[8:11], s19 offen offset:3072 sc1
    buffer_load_dwordx4 v[156:159], v5, s[8:11], s47 offen offset:1024 sc1
    s_waitcnt vmcnt(8)
    v_max_u32 v15, v168, v172
    v_cmp_eq_u32 vcc, -1, v15
    s_cbranch_vccnz P1_R11
    s_branch P1_R11B
P1_R12:
    s_add_u32 s46, s46, 1
    s_cmp_gt_u32 s46, 131072
    s_cbranch_scc1 P1_R12B
    s_sleep 1
    buffer_load_dwordx4 v[128:131], v5, s[8:11], s19 offen offset:0 sc1
    buffer_load_dwordx4 v[132:135], v5, s[8:11], s43 offen offset:2048 sc1
    buffer_load_dwordx4 v[136:139], v5, s[8:11], s19 offen offset:1024 sc1
    buffer_load_dwordx4 v[140:143], v5, s[8:11], s43 offen offset:3072 sc1
    buffer_load_dwordx4 v[144:147], v5, s[8:11], s19 offen offset:2048 sc1
    buffer_load_dwordx4 v[148:151], v5, s[8:11], s47 offen offset:0 sc1
    buffer_load_dwordx4 v[152:155], v5, s[8:11], s19 offen offset:3072 sc1
    buffer_load_dwordx4 v[156:159], v5, s[8:11], s47 offen offset:1024 sc1
    buffer_load_dwordx4 v[160:163], v5, s[8:11], s24 offen offset:0 sc1
    buffer_load_dwordx4 v[164:167], v5, s[8:11], s47 offen offset:2048 sc1
    s_waitcnt vmcnt(8)
    v_max_u32 v15, v128, v132
    v_cmp_eq_u32 vcc, -1, v15
    s_cbranch_vccnz P1_R12
    s_branch P1_R12B
P1_R13:
    s_add_u32 s46, s46, 1
    s_cmp_gt_u32 s46, 131072
    s_cbranch_scc1 P1_R13B
    s_sleep 1
    buffer_load_dwordx4 v[136:139], v5, s[8:11], s19 offen offset:1024 sc1
    buffer_load_dwordx4 v[140:143], v5, s[8:11], s43 offen offset:3072 sc1
    buffer_load_dwordx4 v[144:147], v5, s[8:11], s19 offen offset:2048 sc1
    buffer_load_dwordx4 v[148:151], v5, s[8:11], s47 offen offset:0 sc1
    buffer_load_dwordx4 v[152:155], v5, s[8:11], s19 offen offset:3072 sc1
    buffer_load_dwordx4 v[156:159], v5, s[8:11], s47 offen offset:1024 sc1
    buffer_load_dwordx4 v[160:163], v5, s[8:11], s24 offen offset:0 sc1
    buffer_load_dwordx4 v[164:167], v5, s[8:11], s47 offen offset:2048 sc1
    buffer_load_dwordx4 v[168:171], v5, s[8:11], s24 offen offset:1024 sc1
    buffer_load_dwordx4 v[172:175], v5, s[8:11], s47 offen offset:3072 sc1
    s_waitcnt vmcnt(8)
    v_max_u32 v15, v136, v140
    v_cmp_eq_u32 vcc, -1, v15
    s_cbranch_vccnz P1_R13
    s_branch P1_R13B
P1_R14:
    s_add_u32 s46, s46, 1
    s_cmp_gt_u32 s46, 131072
    s_cbranch_scc1 P1_R14B
    s_sleep 1
    buffer_load_dwordx4 v[144:147], v5, s[8:11], s19 offen offset:2048 sc1
    buffer_load_dwordx4 v[148:151], v5, s[8:11], s47 offen offset:0 sc1
    buffer_load_dwordx4 v[152:155], v5, s[8:11], s19 offen offset:3072 sc1
    buffer_load_dwordx4 v[156:159], v5, s[8:11], s47 offen offset:1024 sc1
    buffer_load_dwordx4 v[160:163], v5, s[8:11], s24 offen offset:0 sc1
    buffer_load_dwordx4 v[164:167], v5, s[8:11], s47 offen offset:2048 sc1
    buffer_load_dwordx4 v[168:171], v5, s[8:11], s24 offen offset:1024 sc1
    buffer_load_dwordx4 v[172:175], v5, s[8:11], s47 offen offset:3072 sc1
    s_waitcnt vmcnt(6)
    v_max_u32 v15, v144, v148
    v_cmp_eq_u32 vcc, -1, v15
    s_cbranch_vccnz P1_R14
    s_branch P1_R14B
P1_R15:
    s_add_u32 s46, s46, 1
    s_cmp_gt_u32 s46, 131072
    s_cbranch_scc1 P1_R15B
    s_sleep 1
    buffer_load_dwordx4 v[152:155], v5, s[8:11], s19 offen offset:3072 sc1
    buffer_load_dwordx4 v[156:159], v5, s[8:11], s47 offen offset:1024 sc1
    buffer_load_dwordx4 v[160:163], v5, s[8:11], s24 offen offset:0 sc1
    buffer_load_dwordx4 v[164:167], v5, s[8:11], s47 offen offset:2048 sc1
    buffer_load_dwordx4 v[168:171], v5, s[8:11], s24 offen offset:1024 sc1
    buffer_load_dwordx4 v[172:175], v5, s[8:11], s47 offen offset:3072 sc1
    s_waitcnt vmcnt(4)
    v_max_u32 v15, v152, v156
    v_cmp_eq_u32 vcc, -1, v15
    s_cbranch_vccnz P1_R15
    s_branch P1_R15B
P1_R16:
    s_add_u32 s46, s46, 1
    s_cmp_gt_u32 s46, 131072
    s_cbranch_scc1 P1_R16B
    s_sleep 1
    buffer_load_dwordx4 v[160:163], v5, s[8:11], s24 offen offset:0 sc1
    buffer_load_dwordx4 v[164:167], v5, s[8:11], s47 offen offset:2048 sc1
    buffer_load_dwordx4 v[168:171], v5, s[8:11], s24 offen offset:1024 sc1
    buffer_load_dwordx4 v[172:175], v5, s[8:11], s47 offen offset:3072 sc1
    s_waitcnt vmcnt(2)
    v_max_u32 v15, v160, v164
    v_cmp_eq_u32 vcc, -1, v15
    s_cbranch_vccnz P1_R16
    s_branch P1_R16B
P1_R17:
    s_add_u32 s46, s46, 1
    s_cmp_gt_u32 s46, 131072
    s_cbranch_scc1 P1_R17B
    s_sleep 1
    buffer_load_dwordx4 v[168:171], v5, s[8:11], s24 offen offset:1024 sc1
    buffer_load_dwordx4 v[172:175], v5, s[8:11], s47 offen offset:3072 sc1
    s_waitcnt vmcnt(0)
    v_max_u32 v15, v168, v172
    v_cmp_eq_u32 vcc, -1, v15
    s_cbranch_vccnz P1_R17
    s_branch P1_R17B
P3_R0:
    s_add_u32 s46, s46, 1
    s_cmp_gt_u32 s46, 131072
    s_cbranch_scc1 P3_R0B
    s_sleep 1
    buffer_load_dwordx4 v[16:19], v5, s[8:11], s24 offen offset:0 sc1
    buffer_load_dwordx4 v[20:23], v5, s[8:11], s24 offen offset:1024 sc1
    buffer_load_dwordx4 v[24:27], v5, s[8:11], s24 offen offset:2048 sc1
    buffer_load_dwordx4 v[28:31], v5, s[8:11], s24 offen offset:3072 sc1
    buffer_load_dwordx4 v[32:35], v5, s[8:11], s25 offen offset:0 sc1
    buffer_load_dwordx4 v[36:39], v5, s[8:11], s25 offen offset:1024 sc1
    buffer_load_dwordx4 v[40:43], v5, s[8:11], s25 offen offset:2048 sc1
    buffer_load_dwordx4 v[44:47], v5, s[8:11], s25 offen offset:3072 sc1
    buffer_load_dwordx4 v[48:51], v5, s[8:11], s26 offen offset:0 sc1
    buffer_load_dwordx4 v[52:55], v5, s[8:11], s26 offen offset:1024 sc1
    buffer_load_dwordx4 v[56:59], v5, s[8:11], s26 offen offset:2048 sc1
    buffer_load_dwordx4 v[60:63], v5, s[8:11], s26 offen offset:3072 sc1
    s_waitcnt vmcnt(10)
    v_max_u32 v15, v16, v20
    v_cmp_eq_u32 vcc, -1, v15
    s_cbranch_vccnz P3_R0
    s_branch P3_R0B
P3_R1:
    s_add_u32 s46, s46, 1
    s_cmp_gt_u32 s46, 131072
    s_cbranch_scc1 P3_R1B
    s_sleep 1
    buffer_load_dwordx4 v[24:27], v5, s[8:11], s24 offen offset:2048 sc1
    buffer_load_dwordx4 v[28:31], v5, s[8:11], s24 offen offset:3072 sc1
    buffer_load_dwordx4 v[32:35], v5, s[8:11], s25 offen offset:0 sc1
    buffer_load_dwordx4 v[36:39], v5, s[8:11], s25 offen offset:1024 sc1
    buffer_load_dwordx4 v[40:43], v5, s[8:11], s25 offen offset:2048 sc1
    buffer_load_dwordx4 v[44:47], v5, s[8:11], s25 offen offset:3072 sc1
    buffer_load_dwordx4 v[48:51], v5, s[8:11], s26 offen offset:0 sc1
    buffer_load_dwordx4 v[52:55], v5, s[8:11], s26 offen offset:1024 sc1
    buffer_load_dwordx4 v[56:59], v5, s[8:11], s26 offen offset:2048 sc1
    buffer_load_dwordx4 v[60:63], v5, s[8:11], s26 offen offset:3072 sc1
    buffer_load_dwordx4 v[64:67], v5, s[8:11], s27 offen offset:0 sc1
    buffer_load_dwordx4 v[68:71], v5, s[8:11], s27 offen offset:1024 sc1
    s_waitcnt vmcnt(10)
    v_max_u32 v15, v24, v28
    v_cmp_eq_u32 vcc, -1, v15
    s_cbranch_vccnz P3_R1
    s_branch P3_R1B
P3_R2:
    s_add_u32 s46, s46, 1
    s_cmp_gt_u32 s46, 131072
    s_cbranch_scc1 P3_R2B
    s_sleep 1
    buffer_load_dwordx4 v[32:35], v5, s[8:11], s25 offen offset:0 sc1
    buffer_load_dwordx4 v[36:39], v5, s[8:11], s25 offen offset:1024 sc1
    buffer_load_dwordx4 v[40:43], v5, s[8:11], s25 offen offset:2048 sc1
    buffer_load_dwordx4 v[44:47], v5, s[8:11], s25 offen offset:3072 sc1
    buffer_load_dwordx4 v[48:51], v5, s[8:11], s26 offen offset:0 sc1
    buffer_load_dwordx4 v[52:55], v5, s[8:11], s26 offen offset:1024 sc1
    buffer_load_dwordx4 v[56:59], v5, s[8:11], s26 offen offset:2048 sc1
    buffer_load_dwordx4 v[60:63], v5, s[8:11], s26 offen offset:3072 sc1
    buffer_load_dwordx4 v[64:67], v5, s[8:11], s27 offen offset:0 sc1
    buffer_load_dwordx4 v[68:71], v5, s[8:11], s27 offen offset:1024 sc1
    buffer_load_dwordx4 v[72:75], v5, s[8:11], s27 offen offset:2048 sc1
    buffer_load_dwordx4 v[76:79], v5, s[8:11], s27 offen offset:3072 sc1
    s_waitcnt vmcnt(10)
    v_max_u32 v15, v32, v36
    v_cmp_eq_u32 vcc, -1, v15
    s_cbranch_vccnz P3_R2
    s_branch P3_R2B
P3_R3:
    s_add_u32 s46, s46, 1
    s_cmp_gt_u32 s46, 131072
    s_cbranch_scc1 P3_R3B
    s_sleep 1
    buffer_load_dwordx4 v[40:43], v5, s[8:11], s25 offen offset:2048 sc1
    buffer_load_dwordx4 v[44:47], v5, s[8:11], s25 offen offset:3072 sc1
    buffer_load_dwordx4 v[48:51], v5, s[8:11], s26 offen offset:0 sc1
    buffer_load_dwordx4 v[52:55], v5, s[8:11], s26 offen offset:1024 sc1
    buffer_load_dwordx4 v[56:59], v5, s[8:11], s26 offen offset:2048 sc1
    buffer_load_dwordx4 v[60:63], v5, s[8:11], s26 offen offset:3072 sc1
    buffer_load_dwordx4 v[64:67], v5, s[8:11], s27 offen offset:0 sc1
    buffer_load_dwordx4 v[68:71], v5, s[8:11], s27 offen offset:1024 sc1
    buffer_load_dwordx4 v[72:75], v5, s[8:11], s27 offen offset:2048 sc1
    buffer_load_dwordx4 v[76:79], v5, s[8:11], s27 offen offset:3072 sc1
    buffer_load_dwordx4 v[80:83], v5, s[8:11], s28 offen offset:0 sc1
    buffer_load_dwordx4 v[84:87], v5, s[8:11], s28 offen offset:1024 sc1
    s_waitcnt vmcnt(10)
    v_max_u32 v15, v40, v44
    v_cmp_eq_u32 vcc, -1, v15
    s_cbranch_vccnz P3_R3
    s_branch P3_R3B
P3_R4:
    s_add_u32 s46, s46, 1
    s_cmp_gt_u32 s46, 131072
    s_cbranch_scc1 P3_R4B
    s_sleep 1
    buffer_load_dwordx4 v[48:51], v5, s[8:11], s26 offen offset:0 sc1
    buffer_load_dwordx4 v[52:55], v5, s[8:11], s26 offen offset:1024 sc1
    buffer_load_dwordx4 v[56:59], v5, s[8:11], s26 offen offset:2048 sc1
    buffer_load_dwordx4 v[60:63], v5, s[8:11], s26 offen offset:3072 sc1
    buffer_load_dwordx4 v[64:67], v5, s[8:11], s27 offen offset:0 sc1
    buffer_load_dwordx4 v[68:71], v5, s[8:11], s27 offen offset:1024 sc1
    buffer_load_dwordx4 v[72:75], v5, s[8:11], s27 offen offset:2048 sc1
    buffer_load_dwordx4 v[76:79], v5, s[8:11], s27 offen offset:3072 sc1
    buffer_load_dwordx4 v[80:83], v5, s[8:11], s28 offen offset:0 sc1
    buffer_load_dwordx4 v[84:87], v5, s[8:11], s28 offen offset:1024 sc1
    s_waitcnt vmcnt(8)
    v_max_u32 v15, v48, v52
    v_cmp_eq_u32 vcc, -1, v15
    s_cbranch_vccnz P3_R4
    s_branch P3_R4B
P3_R5:
    s_add_u32 s46, s46, 1
    s_cmp_gt_u32 s46, 131072
    s_cbranch_scc1 P3_R5B
    s_sleep 1
    buffer_load_dwordx4 v[56:59], v5, s[8:11], s26 offen offset:2048 sc1
    buffer_load_dwordx4 v[60:63], v5, s[8:11], s26 offen offset:3072 sc1
    buffer_load_dwordx4 v[64:67], v5, s[8:11], s27 offen offset:0 sc1
    buffer_load_dwordx4 v[68:71], v5, s[8:11], s27 offen offset:1024 sc1
    buffer_load_dwordx4 v[72:75], v5, s[8:11], s27 offen offset:2048 sc1
    buffer_load_dwordx4 v[76:79], v5, s[8:11], s27 offen offset:3072 sc1
    buffer_load_dwordx4 v[80:83], v5, s[8:11], s28 offen offset:0 sc1
    buffer_load_dwordx4 v[84:87], v5, s[8:11], s28 offen offset:1024 sc1
    s_waitcnt vmcnt(6)
    v_max_u32 v15, v56, v60
    v_cmp_eq_u32 vcc, -1, v15
    s_cbranch_vccnz P3_R5
    s_branch P3_R5B
P3_R6:
    s_add_u32 s46, s46, 1
    s_cmp_gt_u32 s46, 131072
    s_cbranch_scc1 P3_R6B
    s_sleep 1
    buffer_load_dwordx4 v[64:67], v5, s[8:11], s27 offen offset:0 sc1
    buffer_load_dwordx4 v[68:71], v5, s[8:11], s27 offen offset:1024 sc1
    buffer_load_dwordx4 v[72:75], v5, s[8:11], s27 offen offset:2048 sc1
    buffer_load_dwordx4 v[76:79], v5, s[8:11], s27 offen offset:3072 sc1
    buffer_load_dwordx4 v[80:83], v5, s[8:11], s28 offen offset:0 sc1
    buffer_load_dwordx4 v[84:87], v5, s[8:11], s28 offen offset:1024 sc1
    s_waitcnt vmcnt(4)
    v_max_u32 v15, v64, v68
    v_cmp_eq_u32 vcc, -1, v15
    s_cbranch_vccnz P3_R6
    s_branch P3_R6B
P3_R7:
    s_add_u32 s46, s46, 1
    s_cmp_gt_u32 s46, 131072
    s_cbranch_scc1 P3_R7B
    s_sleep 1
    buffer_load_dwordx4 v[72:75], v5, s[8:11], s27 offen offset:2048 sc1
    buffer_load_dwordx4 v[76:79], v5, s[8:11], s27 offen offset:3072 sc1
    buffer_load_dwordx4 v[80:83], v5, s[8:11], s28 offen offset:0 sc1
    buffer_load_dwordx4 v[84:87], v5, s[8:11], s28 offen offset:1024 sc1
    s_waitcnt vmcnt(2)
    v_max_u32 v15, v72, v76
    v_cmp_eq_u32 vcc, -1, v15
    s_cbranch_vccnz P3_R7
    s_branch P3_R7B
P3_R8:
    s_add_u32 s46, s46, 1
    s_cmp_gt_u32 s46, 131072
    s_cbranch_scc1 P3_R8B
    s_sleep 1
    buffer_load_dwordx4 v[80:83], v5, s[8:11], s28 offen offset:0 sc1
    buffer_load_dwordx4 v[84:87], v5, s[8:11], s28 offen offset:1024 sc1
    s_waitcnt vmcnt(0)
    v_max_u32 v15, v80, v84
    v_cmp_eq_u32 vcc, -1, v15
    s_cbranch_vccnz P3_R8
    s_branch P3_R8B
P4_BODY:
    v_lshlrev_b32 v3, 4, v1
    v_and_b32 v11, 31, v1
    v_lshlrev_b32 v12, 2, v11
    v_lshlrev_b32 v13, 3, v1
    v_lshlrev_b32 v14, 5, v1
    v_lshlrev_b32 v254, 5, v11
    v_lshrrev_b32 v15, 5, v1
    v_lshl_add_u32 v254, v15, 4, v254
    s_and_b32 s18, s2, 7
    s_lshr_b32 s19, s2, 3
    s_lshr_b32 s16, s18, 1
    s_lshl_b32 s16, s16, 2
    s_and_b32 s20, s19, 3
    s_add_u32 s16, s16, s20
    s_and_b32 s17, s18, 1
    s_lshl_b32 s17, s17, 3
    s_lshr_b32 s20, s19, 2
    s_add_u32 s17, s17, s20
    s_lshl_b32 s4, s16, 4
    s_add_u32 s4, s4, s17
    s_lshl_b32 s6, s3, 10
    s_lshl_b32 s7, s4, 13
    s_add_u32 s7, s7, s6
    s_add_u32 s7, s7, 14155776
    s_lshl_b32 s28, s4, 10
    s_lshl_b32 s29, s3, 7
    s_add_u32 s28, s28, s29
    s_add_u32 s28, s28, 16252928
    s_mul_i32 s26, s45, 253952
    s_add_u32 s29, s26, 16670720
    s_add_u32 s23, s6, 16580608
    s_add_u32 s23, s23, s26
    s_lshl_b32 s21, s3, 13
    s_add_u32 s21, s21, 16515072
    s_add_u32 s21, s21, s26
    s_add_u32 s22, s21, 4096
    s_mul_i32 s40, s3, 10240
    s_add_u32 s40, s40, 16588800
    s_add_u32 s40, s40, s26
    v_min_u32 v16, 19, v11
    v_lshlrev_b32 v16, 4, v16
    v_mul_u32_u24 v15, 320, v15
    v_add_u32 v16, v16, v15
    v_add_u32 v17, 0, v16
    v_lshrrev_b32 v18, 10, v17
    v_mul_u32_u24 v18, 7168, v18
    v_add3_u32 v204, v17, v18, s6
    v_add_u32 v17, 640, v16
    v_lshrrev_b32 v18, 10, v17
    v_mul_u32_u24 v18, 7168, v18
    v_add3_u32 v205, v17, v18, s6
    v_add_u32 v17, 1280, v16
    v_lshrrev_b32 v18, 10, v17
    v_mul_u32_u24 v18, 7168, v18
    v_add3_u32 v206, v17, v18, s6
    v_add_u32 v17, 1920, v16
    v_lshrrev_b32 v18, 10, v17
    v_mul_u32_u24 v18, 7168, v18
    v_add3_u32 v207, v17, v18, s6
    v_add_u32 v17, 2560, v16
    v_lshrrev_b32 v18, 10, v17
    v_mul_u32_u24 v18, 7168, v18
    v_add3_u32 v208, v17, v18, s6
    v_add_u32 v17, 3200, v16
    v_lshrrev_b32 v18, 10, v17
    v_mul_u32_u24 v18, 7168, v18
    v_add3_u32 v209, v17, v18, s6
    v_add_u32 v17, 3840, v16
    v_lshrrev_b32 v18, 10, v17
    v_mul_u32_u24 v18, 7168, v18
    v_add3_u32 v210, v17, v18, s6
    v_add_u32 v17, 4480, v16
    v_lshrrev_b32 v18, 10, v17
    v_mul_u32_u24 v18, 7168, v18
    v_add3_u32 v211, v17, v18, s6
    s_mul_i32 s44, s3, 5
    s_lshl_b32 s27, s3, 2
    s_add_u32 s27, s27, 4
    s_cmp_lt_u32 s3, 4
    s_cselect_b32 s44, s44, s27
    s_lshl_b32 s24, s44, 11
    s_add_u32 s24, s24, 20574208
    s_lshl_b32 s19, s44, 10
    s_add_u32 s19, s19, 21164032
    s_mul_i32 s25, s17, 129024
    s_add_u32 s25, s25, s6
    s_add_u32 s25, s25, 17031168
    s_lshr_b32 s5, s4, 1
    s_mul_i32 s5, s5, 18432
    s_and_b32 s26, s4, 1
    s_lshl_b32 s26, s26, 7
    s_add_u32 s5, s5, s26
    v_mov_b32 v24, 0
    v_mov_b32 v25, 0
    v_mov_b32 v26, 0
    v_mov_b32 v27, 0
    v_mov_b32 v2, 0xdddddddd
    v_lshrrev_b32 v15, 5, v1
    v_mul_u32_u24 v4, 112, v11
    v_lshl_add_u32 v4, v15, 4, v4
    s_mul_i32 s26, s3, 3584
    s_add_u32 s26, s26, 98304
    v_add_u32 v4, s26, v4
    v_lshrrev_b32 v28, 4, v1
    s_lshl_b32 s27, s3, 2
    v_add_u32 v30, s27, v28
    v_and_b32 v29, 15, v1
    v_mul_u32_u24 v5, 112, v30
    v_add_u32 v5, 98304, v5
    v_and_b32 v16, 3, v29
    v_mul_u32_u24 v16, 7168, v16
    v_and_b32 v17, 12, v29
    v_add3_u32 v253, v5, v16, v17
    v_add_u32 v253, 64, v253
    v_lshl_add_u32 v5, v29, 2, v5
    v_lshrrev_b32 v16, 4, v30
    v_lshlrev_b32 v7, 8, v16
    v_and_b32 v16, 7, v30
    v_lshl_add_u32 v7, v16, 4, v7
    v_and_b32 v16, 8, v30
    v_add_u32 v7, v7, v16
    v_and_b32 v16, 1, v29
    v_lshl_add_u32 v7, v16, 1, v7
    v_and_b32 v16, 10, v29
    v_lshl_add_u32 v7, v16, 6, v7
    v_and_b32 v16, 4, v29
    v_add_u32 v7, v7, v16
    v_add_u32 v7, 98304, v7
    s_mov_b32 s30, 0x00120012
    s_mov_b32 s31, s30
    v_cmp_gt_u32 s[34:35], 8, v29
    v_and_b32 v29, 7, v1
    v_mov_b32 v16, 0x44444444
    v_mov_b32 v17, 0xeeeeeeee
    v_cndmask_b32 v8, v17, v16, s[34:35]
    v_add_u32 v9, 98304, v3
    v_cmp_gt_u32 s[32:33], 32, v1
    s_lshl_b32 s26, s3, 11
    v_add_u32 v31, s26, v9
    s_add_u32 s27, s27, 98304
    v_mov_b32 v6, s27
    v_lshlrev_b32 v0, 2, v29
    v_add_u32 v0, 98304, v0
    v_add_u32 v15, s6, v9
    v_mov_b32 v252, 123904
    s_mov_b32 s46, 0
    s_and_b32 s26, s2, 7
    s_mul_i32 s26, s26, 12288
    s_add_u32 s18, s29, s26
    v_lshrrev_b32 v13, 2, v1
    s_lshl_b32 s26, s3, 2
    v_add_u32 v13, s26, v13
    s_lshr_b32 s26, s4, 3
    v_mov_b32 v40, s26
    v_cmp_gt_u32 vcc, 16, v1
    s_nop 1
    v_cndmask_b32 v13, v40, v13, vcc
    v_mul_u32_u24 v13, 384, v13
    v_and_b32 v40, 3, v1
    v_lshl_add_u32 v13, v40, 7, v13
    v_mov_b32 v40, 0
    s_mov_b32 s36, 0x77777
    s_mov_b32 s37, 0
    s_mov_b32 s38, 0
    v_mov_b32 v29, 98304
    s_cmp_lt_u32 s3, 4
    s_cbranch_scc1 P4_S0
    s_waitcnt vmcnt(0)
    s_barrier
    s_barrier
    s_cmp_lg_u32 s3, 4
    s_cbranch_scc1 P4_S2
    s_and_b32 s26, s17, 7
    s_cmp_ge_u32 s26, 3
    s_cbranch_scc1 P4_S2
    ds_read_b128 v[32:35], v29 offset:61568
    s_lshr_b32 s27, s4, 3
    s_mul_i32 s27, s27, 3
    s_add_u32 s26, s26, s27
    s_lshl_b32 s26, s26, 7
    s_add_u32 s26, s26, s29
    v_mul_u32_u24 v14, 12288, v1
    s_waitcnt lgkmcnt(0)
    v_max3_f32 v32, v32, v33, v34
    v_max_f32 v32, v32, v35
    v_min_u32 v32, -2, v32
    s_mov_b64 exec, 0xff
    buffer_store_dword v32, v14, s[8:11], s26 offen sc1
    s_mov_b64 exec, -1
P4_S2:
    s_sleep 16
P4_S0:
    ds_write_b128 v15, v[24:27] offset:24576
    ds_write_b128 v29, v[24:27] offset:65280
    s_sleep 4
P4_SP:
    s_mov_b64 exec, s[36:37]
    buffer_load_dword v40, v13, s[8:11], s18 offen sc1
    s_mov_b64 exec, -1
    buffer_load_dwordx4 v[16:19], v3, s[8:11], s7 offen sc1
    buffer_load_dword v20, v12, s[8:11], s28 offen sc1
    s_add_u32 s46, s46, 1
    s_waitcnt vmcnt(2)
    v_cmp_eq_u32 s[42:43], -1, v40
    s_nop 0
    s_and_b32 s39, s42, 0xffff
    s_or_b32 s39, s39, s38
    s_cbranch_scc1 P4_SQ
    s_mov_b32 s38, 1
    buffer_load_dwordx4 v[124:127], v254, s[8:11], s23 offen sc1
    buffer_load_dwordx4 v[92:95], v3, s[8:11], s21 offen offset:0 sc1
    buffer_load_dwordx4 v[96:99], v3, s[8:11], s21 offen offset:1024 sc1
    s_add_u32 m0, s6, 0
    s_add_u32 s27, s40, 0
    buffer_load_dwordx4 v3, s[8:11], s27 offen sc1 lds
    s_add_u32 m0, s6, 8192
    s_add_u32 s27, s40, 1024
    buffer_load_dwordx4 v3, s[8:11], s27 offen sc1 lds
    buffer_load_dwordx4 v[100:103], v3, s[8:11], s21 offen offset:2048 sc1
    s_waitcnt vmcnt(6)
    s_branch P4_SR
P4_SQ:
    s_waitcnt vmcnt(0)
P4_SR:
    v_max_u32 v21, v16, v20
    v_cmp_eq_u32 vcc, -1, v21
    s_lshr_b32 s39, s42, 16
    s_or_b32 s39, s39, vcc_lo
    s_or_b32 s39, s39, vcc_hi
    s_cbranch_scc0 P4_NK
    s_sleep 2
    s_cmp_lt_u32 s46, 131072
    s_cbranch_scc1 P4_SP
P4_NK:
    ds_write_b128 v31, v[16:19] offset:0
    v_dot2_f32_bf16 v21, v16, v16, 0
    v_dot2_f32_bf16 v21, v17, v17, v21
    v_dot2_f32_bf16 v21, v18, v18, v21
    v_dot2_f32_bf16 v21, v19, v19, v21
    s_nop 2
    v_mov_b32 v23, v21
    s_nop 1
    v_permlane32_swap_b32 v21, v23
    v_add_f32 v21, v21, v23
    v_dot2_f32_bf16 v21, v20, v20, v21
    s_nop 2
    v_sqrt_f32 v21, v21
    s_lshl_b32 s26, s3, 7
    v_add3_u32 v28, v12, v29, s26
    ds_write_b32 v28, v21 offset:62464
    v_cvt_pk_bf16_f32 v22, -v21, -v21
    v_lshlrev_b32 v22, 16, v22
    v_sub_f32 v23, -v21, v22
    v_cvt_pk_bf16_f32 v22, v22, v23
    v_cndmask_b32 v24, v22, v20, s[32:33]
    v_mov_b32 v25, 0
    v_mov_b32 v26, 0
    v_mov_b32 v27, v24
    ds_write_b128 v31, v[24:27] offset:1024
    v_add_f32_dpp v33, v40, v40 quad_perm:[1,0,3,2] row_mask:0xf bank_mask:0xf
    v_lshl_add_u32 v28, v1, 4, v29
    s_nop 0
    v_add_f32_dpp v33, v33, v33 quad_perm:[2,3,0,1] row_mask:0xf bank_mask:0xf
    v_sqrt_f32 v33, v33
    s_nop 0
    v_readlane_b32 s41, v33, 16
    s_nop 0
    s_add_u32 s41, s41, 0xffff
    s_and_b32 s41, s41, 0xffff0000
    s_lshr_b32 s39, s41, 16
    s_or_b32 s39, s41, s39
    v_mov_b32 v128, s39
    v_mov_b32 v129, s39
    v_mov_b32 v130, s39
    v_mov_b32 v131, s39
    s_waitcnt lgkmcnt(0)
    s_barrier
    ds_read_b128 v[196:199], v9 offset:0
    ds_read_b128 v[200:203], v9 offset:1024
    ds_read_b128 v[238:241], v28 offset:62464
    s_cmp_lg_u32 s38, 0
    s_cbranch_scc1 P4_KD
P4_KP:
    s_mov_b64 exec, s[36:37]
    buffer_load_dword v40, v13, s[8:11], s18 offen sc1
    s_mov_b64 exec, -1
    s_add_u32 s46, s46, 1
    s_waitcnt vmcnt(0)
    v_cmp_eq_u32 vcc, -1, v40
    s_cbranch_vccz P4_KI
    s_sleep 2
    s_cmp_lt_u32 s46, 131072
    s_cbranch_scc1 P4_KP
P4_KI:
    buffer_load_dwordx4 v[124:127], v254, s[8:11], s23 offen sc1
    buffer_load_dwordx4 v[92:95], v3, s[8:11], s21 offen offset:0 sc1
    buffer_load_dwordx4 v[96:99], v3, s[8:11], s21 offen offset:1024 sc1
    s_add_u32 m0, s6, 0
    s_add_u32 s27, s40, 0
    buffer_load_dwordx4 v3, s[8:11], s27 offen sc1 lds
    s_add_u32 m0, s6, 8192
    s_add_u32 s27, s40, 1024
    buffer_load_dwordx4 v3, s[8:11], s27 offen sc1 lds
    buffer_load_dwordx4 v[100:103], v3, s[8:11], s21 offen offset:2048 sc1
P4_KD:
    v_mov_b32 v234, v40
    s_add_u32 m0, s6, 16384
    s_add_u32 s27, s40, 2048
    buffer_load_dwordx4 v3, s[8:11], s27 offen sc1 lds
    buffer_load_dwordx4 v[104:107], v3, s[8:11], s21 offen offset:3072 sc1
    s_waitcnt vmcnt(5)
    v_max3_u32 v10, v92, v93, v94
    v_max3_u32 v10, v95, v96, v10
    v_max3_u32 v10, v97, v98, v10
    v_max3_u32 v10, v99, v124, v10
    v_max3_u32 v10, v125, v126, v10
    v_max_u32 v10, v127, v10
    v_cmp_eq_u32 vcc, -1, v10
    s_cbranch_vccnz P4_RK
P4_RKB:
    v_permlane32_swap_b32 v124, v128
    v_permlane32_swap_b32 v125, v129
    v_permlane32_swap_b32 v126, v130
    v_permlane32_swap_b32 v127, v131
    s_waitcnt lgkmcnt(1)
P4_GO:
    v_mfma_f32_32x32x8_bf16 v[12:27], v[124:125], v[200:201], 0
    v_mfma_f32_32x32x8_bf16 v[28:43], v[124:125], v[202:203], 0
    ds_read_b128 v[60:63], v252
    ds_read_b128 v[64:67], v252
    ds_read_b128 v[68:71], v252
    ds_read_b128 v[72:75], v252
    s_nop 4
    v_mfma_f32_32x32x16_bf16 v[12:27], v[92:95], v[196:199], v[12:27]
    v_mfma_f32_32x32x16_bf16 v[28:43], v[96:99], v[196:199], v[28:43]
    s_setprio 3
    s_cmp_ge_u32 s3, 4
    s_cbranch_scc1 P4_C1
    s_nop 7
    v_exp_f32 v12, v12
    s_waitcnt vmcnt(3)
    ds_read_b128 v[132:135], v204 offset:0
    ds_read_b128 v[136:139], v205 offset:0
    v_exp_f32 v13, v13
    v_exp_f32 v14, v14
    v_exp_f32 v15, v15
    s_add_u32 m0, s6, 24576
    s_add_u32 s27, s40, 3072
    buffer_load_dwordx4 v3, s[8:11], s27 offen sc1 lds
    v_exp_f32 v16, v16
    v_exp_f32 v17, v17
    v_exp_f32 v18, v18
    buffer_load_dwordx4 v[108:111], v3, s[8:11], s22 offen offset:0 sc1
    v_mfma_f32_32x32x8_bf16 v[44:59], v[126:127], v[200:201], 0
    v_exp_f32 v19, v19
    v_exp_f32 v20, v20
    v_exp_f32 v21, v21
    s_waitcnt lgkmcnt(0)
    v_max_u32 v10, v132, v136
    v_cmp_eq_u32 vcc, -1, v10
    v_exp_f32 v22, v22
    v_exp_f32 v23, v23
    s_cbranch_vccnz P4_RV00
P4_RV00B:
    s_add_u32 m0, s6, 32768
    s_add_u32 s27, s40, 4096
    buffer_load_dwordx4 v3, s[8:11], s27 offen sc1 lds
    v_smfmac_f32_32x32x32_bf16 v[60:75], v[132:135], v[12:19], v2
    v_exp_f32 v24, v24
    v_exp_f32 v25, v25
    s_waitcnt vmcnt(5)
    v_max3_u32 v10, v100, v101, v102
    v_max_u32 v10, v103, v10
    v_cmp_eq_u32 vcc, -1, v10
    v_exp_f32 v26, v26
    v_exp_f32 v27, v27
    s_cbranch_vccnz P4_RK00
P4_RK00B:
    s_setprio 3
    buffer_load_dwordx4 v[112:115], v3, s[8:11], s22 offen offset:1024 sc1
    v_mfma_f32_32x32x16_bf16 v[44:59], v[100:103], v[196:199], v[44:59]
    v_exp_f32 v28, v28
    s_waitcnt vmcnt(5)
    ds_read_b128 v[140:143], v206 offset:0
    ds_read_b128 v[144:147], v207 offset:0
    v_exp_f32 v29, v29
    v_exp_f32 v30, v30
    v_exp_f32 v31, v31
    s_add_u32 m0, s6, 40960
    s_add_u32 s27, s40, 5120
    buffer_load_dwordx4 v3, s[8:11], s27 offen sc1 lds
    v_smfmac_f32_32x32x32_bf16 v[60:75], v[136:139], v[20:27], v2
    v_exp_f32 v32, v32
    v_exp_f32 v33, v33
    v_exp_f32 v34, v34
    s_add_u32 m0, s6, 49152
    s_add_u32 s27, s40, 6144
    buffer_load_dwordx4 v3, s[8:11], s27 offen sc1 lds
    v_mfma_f32_32x32x8_bf16 v[12:27], v[126:127], v[202:203], 0
    v_exp_f32 v35, v35
    v_exp_f32 v36, v36
    v_exp_f32 v37, v37
    s_waitcnt lgkmcnt(0)
    v_max_u32 v10, v140, v144
    v_cmp_eq_u32 vcc, -1, v10
    v_exp_f32 v38, v38
    v_exp_f32 v39, v39
    s_cbranch_vccnz P4_RV01
P4_RV01B:
    buffer_load_dwordx4 v[116:119], v3, s[8:11], s22 offen offset:2048 sc1
    v_smfmac_f32_32x32x32_bf16 v[60:75], v[140:143], v[28:35], v2
    v_exp_f32 v40, v40
    v_exp_f32 v41, v41
    s_waitcnt vmcnt(7)
    v_max3_u32 v10, v104, v105, v106
    v_max_u32 v10, v107, v10
    v_cmp_eq_u32 vcc, -1, v10
    v_exp_f32 v42, v42
    v_exp_f32 v43, v43
    s_cbranch_vccnz P4_RK01
P4_RK01B:
    s_setprio 3
    s_add_u32 m0, s6, 57344
    s_add_u32 s27, s40, 7168
    buffer_load_dwordx4 v3, s[8:11], s27 offen sc1 lds
    v_mfma_f32_32x32x16_bf16 v[12:27], v[104:107], v[196:199], v[12:27]
    v_exp_f32 v44, v44
    s_waitcnt vmcnt(7)
    ds_read_b128 v[148:151], v208 offset:0
    ds_read_b128 v[152:155], v209 offset:0
    v_exp_f32 v45, v45
    v_exp_f32 v46, v46
    v_exp_f32 v47, v47
    buffer_load_dwordx4 v[120:123], v3, s[8:11], s22 offen offset:3072 sc1
    v_smfmac_f32_32x32x32_bf16 v[60:75], v[144:147], v[36:43], v2
    v_exp_f32 v48, v48
    v_exp_f32 v49, v49
    v_exp_f32 v50, v50
    s_add_u32 m0, s6, 65536
    s_add_u32 s27, s40, 8192
    buffer_load_dwordx4 v3, s[8:11], s27 offen sc1 lds
    v_mfma_f32_32x32x8_bf16 v[28:43], v[128:129], v[200:201], 0
    v_exp_f32 v51, v51
    v_exp_f32 v52, v52
    v_exp_f32 v53, v53
    s_waitcnt lgkmcnt(0)
    v_max_u32 v10, v148, v152
    v_cmp_eq_u32 vcc, -1, v10
    v_exp_f32 v54, v54
    v_exp_f32 v55, v55
    s_cbranch_vccnz P4_RV02
P4_RV02B:
    s_add_u32 m0, s6, 73728
    s_add_u32 s27, s40, 9216
    buffer_load_dwordx4 v3, s[8:11], s27 offen sc1 lds
    v_smfmac_f32_32x32x32_bf16 v[60:75], v[148:151], v[44:51], v2
    v_exp_f32 v56, v56
    v_exp_f32 v57, v57
    s_waitcnt vmcnt(9)
    v_max3_u32 v10, v108, v109, v110
    v_max_u32 v10, v111, v10
    v_cmp_eq_u32 vcc, -1, v10
    v_exp_f32 v58, v58
    v_exp_f32 v59, v59
    s_cbranch_vccnz P4_RK02
P4_RK02B:
    s_setprio 2
    v_mfma_f32_32x32x16_bf16 v[28:43], v[108:111], v[196:199], v[28:43]
    v_exp_f32 v12, v12
    s_waitcnt vmcnt(8)
    ds_read_b128 v[156:159], v210 offset:0
    ds_read_b128 v[160:163], v211 offset:0
    v_exp_f32 v13, v13
    v_exp_f32 v14, v14
    v_exp_f32 v15, v15
    v_smfmac_f32_32x32x32_bf16 v[60:75], v[152:155], v[52:59], v2
    v_exp_f32 v16, v16
    v_exp_f32 v17, v17
    v_exp_f32 v18, v18
    v_mfma_f32_32x32x8_bf16 v[44:59], v[128:129], v[202:203], 0
    v_exp_f32 v19, v19
    v_exp_f32 v20, v20
    v_exp_f32 v21, v21
    s_waitcnt lgkmcnt(0)
    v_max_u32 v10, v156, v160
    v_cmp_eq_u32 vcc, -1, v10
    v_exp_f32 v22, v22
    v_exp_f32 v23, v23
    s_cbranch_vccnz P4_RV03
P4_RV03B:
    v_smfmac_f32_32x32x32_bf16 v[60:75], v[156:159], v[12:19], v2
    v_exp_f32 v24, v24
    s_cmp_eq_u32 s38, 2
    s_cbranch_scc1 P4_NV0
    v_add_f32_dpp v234, v234, v234 quad_perm:[1,0,3,2] row_mask:0xf bank_mask:0xf
    v_max3_f32 v238, v238, v239, v240
    v_max_f32 v238, v238, v241
    v_add_f32_dpp v234, v234, v234 quad_perm:[2,3,0,1] row_mask:0xf bank_mask:0xf
    v_mov_b32 v235, s41
    v_mov_b32 v237, 1119879168
    v_max_f32_dpp v234, v234, v234 row_ror:4 row_mask:0xf bank_mask:0xf
    s_nop 1
    v_max_f32_dpp v234, v234, v234 row_ror:8 row_mask:0xf bank_mask:0xf
    v_sqrt_f32 v234, v234
    s_nop 0
    v_readlane_b32 s39, v234, 0
    s_nop 1
    v_add_f32 v236, s39, v235
    v_sub_f32 v235, s39, v235
    v_mul_f32 v235, 0x40400000, v235
    v_max_f32 v236, v236, v235
    v_mul_f32 v236, v236, v238
    v_cmp_nge_f32 vcc, v237, v236
    s_nop 0
    s_cmp_lg_u64 vcc, 0
    s_cselect_b32 s39, 1, 2
    v_mov_b32 v11, s39
P4_NV0:
    v_exp_f32 v25, v25
    s_waitcnt vmcnt(7)
    v_max3_u32 v10, v112, v113, v114
    v_max_u32 v10, v115, v10
    v_cmp_eq_u32 vcc, -1, v10
    v_exp_f32 v26, v26
    v_exp_f32 v27, v27
    s_cbranch_vccnz P4_RK03
P4_RK03B:
    s_setprio 2
    v_mfma_f32_32x32x16_bf16 v[44:59], v[112:115], v[196:199], v[44:59]
    v_exp_f32 v28, v28
    s_waitcnt vmcnt(5)
    ds_read_b128 v[164:167], v204 offset:40960
    ds_read_b128 v[168:171], v205 offset:40960
    v_exp_f32 v29, v29
    v_exp_f32 v30, v30
    v_exp_f32 v31, v31
    v_smfmac_f32_32x32x32_bf16 v[60:75], v[160:163], v[20:27], v2
    v_exp_f32 v32, v32
    v_exp_f32 v33, v33
    v_exp_f32 v34, v34
    v_mfma_f32_32x32x8_bf16 v[12:27], v[130:131], v[200:201], 0
    v_exp_f32 v35, v35
    v_exp_f32 v36, v36
    v_exp_f32 v37, v37
    s_waitcnt lgkmcnt(0)
    v_max_u32 v10, v164, v168
    v_cmp_eq_u32 vcc, -1, v10
    v_exp_f32 v38, v38
    v_exp_f32 v39, v39
    s_cbranch_vccnz P4_RV04
P4_RV04B:
    v_smfmac_f32_32x32x32_bf16 v[60:75], v[164:167], v[28:35], v2
    v_exp_f32 v40, v40
    v_exp_f32 v41, v41
    s_waitcnt vmcnt(4)
    v_max3_u32 v10, v116, v117, v118
    v_max_u32 v10, v119, v10
    v_cmp_eq_u32 vcc, -1, v10
    v_exp_f32 v42, v42
    v_exp_f32 v43, v43
    s_cbranch_vccnz P4_RK04
P4_RK04B:
    s_setprio 2
    v_mfma_f32_32x32x16_bf16 v[12:27], v[116:119], v[196:199], v[12:27]
    v_exp_f32 v44, v44
    s_waitcnt vmcnt(3)
    ds_read_b128 v[172:175], v206 offset:40960
    ds_read_b128 v[176:179], v207 offset:40960
    v_exp_f32 v45, v45
    v_exp_f32 v46, v46
    v_exp_f32 v47, v47
    v_smfmac_f32_32x32x32_bf16 v[60:75], v[168:171], v[36:43], v2
    v_exp_f32 v48, v48
    v_exp_f32 v49, v49
    v_exp_f32 v50, v50
    ds_read_b128 v[76:79], v252
    ds_read_b128 v[80:83], v252
    ds_read_b128 v[84:87], v252
    ds_read_b128 v[88:91], v252
    v_mfma_f32_32x32x8_bf16 v[28:43], v[130:131], v[202:203], 0
    v_exp_f32 v51, v51
    v_exp_f32 v52, v52
    v_exp_f32 v53, v53
    s_waitcnt lgkmcnt(0)
    v_max_u32 v10, v172, v176
    v_cmp_eq_u32 vcc, -1, v10
    v_exp_f32 v54, v54
    v_exp_f32 v55, v55
    s_cbranch_vccnz P4_RV05
P4_RV05B:
    ds_read_b128 v[200:203], v9 offset:3072
    v_smfmac_f32_32x32x32_bf16 v[60:75], v[172:175], v[44:51], v2
    v_exp_f32 v56, v56
    v_exp_f32 v57, v57
    s_waitcnt vmcnt(2)
    v_max3_u32 v10, v120, v121, v122
    v_max_u32 v10, v123, v10
    v_cmp_eq_u32 vcc, -1, v10
    v_exp_f32 v58, v58
    v_exp_f32 v59, v59
    s_cbranch_vccnz P4_RK05
P4_RK05B:
    s_setprio 1
    v_mfma_f32_32x32x16_bf16 v[28:43], v[120:123], v[196:199], v[28:43]
    v_exp_f32 v12, v12
    s_waitcnt vmcnt(1)
    ds_read_b128 v[180:183], v208 offset:40960
    ds_read_b128 v[184:187], v209 offset:40960
    v_exp_f32 v13, v13
    v_exp_f32 v14, v14
    v_exp_f32 v15, v15
    ds_read_b128 v[196:199], v9 offset:2048
    v_smfmac_f32_32x32x32_bf16 v[60:75], v[176:179], v[52:59], v2
    v_exp_f32 v16, v16
    v_exp_f32 v17, v17
    v_exp_f32 v18, v18
    s_waitcnt lgkmcnt(1)
    v_mfma_f32_32x32x8_bf16 v[44:59], v[124:125], v[200:201], 0
    v_exp_f32 v19, v19
    v_exp_f32 v20, v20
    v_exp_f32 v21, v21
    s_waitcnt lgkmcnt(0)
    v_max_u32 v10, v180, v184
    v_cmp_eq_u32 vcc, -1, v10
    v_exp_f32 v22, v22
    v_exp_f32 v23, v23
    s_cbranch_vccnz P4_RV06
P4_RV06B:
    v_smfmac_f32_32x32x32_bf16 v[60:75], v[180:183], v[12:19], v2
    v_exp_f32 v24, v24
    v_exp_f32 v25, v25
    v_exp_f32 v26, v26
    v_exp_f32 v27, v27
    s_setprio 1
    s_waitcnt lgkmcnt(0)
    v_mfma_f32_32x32x16_bf16 v[44:59], v[92:95], v[196:199], v[44:59]
    v_exp_f32 v28, v28
    s_waitcnt vmcnt(0)
    ds_read_b128 v[188:191], v210 offset:40960
    ds_read_b128 v[192:195], v211 offset:40960
    v_exp_f32 v29, v29
    v_exp_f32 v30, v30
    v_exp_f32 v31, v31
    v_smfmac_f32_32x32x32_bf16 v[60:75], v[184:187], v[20:27], v2
    v_exp_f32 v32, v32
    v_exp_f32 v33, v33
    v_exp_f32 v34, v34
    v_mfma_f32_32x32x8_bf16 v[12:27], v[124:125], v[202:203], 0
    v_exp_f32 v35, v35
    v_exp_f32 v36, v36
    v_exp_f32 v37, v37
    s_waitcnt lgkmcnt(0)
    v_max_u32 v10, v188, v192
    v_cmp_eq_u32 vcc, -1, v10
    v_exp_f32 v38, v38
    v_exp_f32 v39, v39
    s_cbranch_vccnz P4_RV07
P4_RV07B:
    v_smfmac_f32_32x32x32_bf16 v[60:75], v[188:191], v[28:35], v2
    v_exp_f32 v40, v40
    v_exp_f32 v41, v41
    v_exp_f32 v42, v42
    v_exp_f32 v43, v43
    s_setprio 1
    v_mfma_f32_32x32x16_bf16 v[12:27], v[96:99], v[196:199], v[12:27]
    v_exp_f32 v44, v44
    v_exp_f32 v45, v45
    v_exp_f32 v46, v46
    v_exp_f32 v47, v47
    v_smfmac_f32_32x32x32_bf16 v[60:75], v[192:195], v[36:43], v2
    v_exp_f32 v48, v48
    v_exp_f32 v49, v49
    v_exp_f32 v50, v50
    s_add_u32 s46, s24, 0
    buffer_load_dwordx4 v[228:231], v3, s[8:11], s46 offen offset:0
    buffer_load_dwordx4 v[232:235], v3, s[8:11], s46 offen offset:1024
    v_mfma_f32_32x32x8_bf16 v[28:43], v[126:127], v[200:201], 0
    v_exp_f32 v51, v51
    v_exp_f32 v52, v52
    v_exp_f32 v53, v53
    v_exp_f32 v54, v54
    v_exp_f32 v55, v55
    v_smfmac_f32_32x32x32_bf16 v[76:91], v[132:135], v[44:51], v2
    v_exp_f32 v56, v56
    v_exp_f32 v57, v57
    v_exp_f32 v58, v58
    v_exp_f32 v59, v59
    s_setprio 0
    ds_write_b128 v4, v[60:63] offset:32768
    v_mfma_f32_32x32x16_bf16 v[28:43], v[100:103], v[196:199], v[28:43]
    v_exp_f32 v12, v12
    v_exp_f32 v13, v13
    v_exp_f32 v14, v14
    v_exp_f32 v15, v15
    v_smfmac_f32_32x32x32_bf16 v[76:91], v[136:139], v[52:59], v2
    v_exp_f32 v16, v16
    v_exp_f32 v17, v17
    v_exp_f32 v18, v18
    s_add_u32 s46, s24, 2048
    buffer_load_dwordx4 v[236:239], v3, s[8:11], s46 offen offset:0
    buffer_load_dwordx4 v[240:243], v3, s[8:11], s46 offen offset:1024
    ds_write_b128 v4, v[64:67] offset:32800
    v_mfma_f32_32x32x8_bf16 v[44:59], v[126:127], v[202:203], 0
    v_exp_f32 v19, v19
    v_exp_f32 v20, v20
    v_exp_f32 v21, v21
    v_exp_f32 v22, v22
    v_exp_f32 v23, v23
    ds_write_b128 v4, v[68:71] offset:32832
    s_mov_b64 exec, 1
    ds_write_b32 v6, v11 offset:25856
    s_mov_b64 exec, -1
    v_smfmac_f32_32x32x32_bf16 v[76:91], v[140:143], v[12:19], v2
    v_exp_f32 v24, v24
    v_exp_f32 v25, v25
    v_exp_f32 v26, v26
    v_exp_f32 v27, v27
    s_setprio 0
    v_mfma_f32_32x32x16_bf16 v[44:59], v[104:107], v[196:199], v[44:59]
    v_exp_f32 v28, v28
    v_exp_f32 v29, v29
    v_exp_f32 v30, v30
    v_exp_f32 v31, v31
    v_smfmac_f32_32x32x32_bf16 v[76:91], v[144:147], v[20:27], v2
    v_exp_f32 v32, v32
    v_exp_f32 v33, v33
    v_exp_f32 v34, v34
    s_add_u32 s46, s24, 4096
    buffer_load_dwordx4 v[244:247], v3, s[8:11], s46 offen offset:0
    buffer_load_dwordx4 v[248:251], v3, s[8:11], s46 offen offset:1024
    v_mfma_f32_32x32x8_bf16 v[12:27], v[128:129], v[200:201], 0
    v_exp_f32 v35, v35
    v_exp_f32 v36, v36
    v_exp_f32 v37, v37
    v_exp_f32 v38, v38
    v_exp_f32 v39, v39
    s_cmp_lg_u32 s45, 0
    s_cbranch_scc1 P4_MK02
    v_mov_b32 v72, -1
    v_mov_b32 v73, -1
    v_mov_b32 v74, -1
    v_mov_b32 v75, -1
    v_lshrrev_b32 v254, 3, v1
    v_and_b32 v255, 7, v1
    v_lshlrev_b32 v255, 4, v255
    v_lshl_add_u32 v254, v254, 8, v255
    s_lshl_b32 s42, s3, 11
    s_add_u32 s42, s42, s5
    s_add_u32 s43, s42, 11796480
    s_add_u32 s42, s42, 7077888
    buffer_store_dwordx4 v[72:75], v254, s[8:11], s42 offen offset:0 sc1
P4_MK02:
    v_smfmac_f32_32x32x32_bf16 v[76:91], v[148:151], v[28:35], v2
    v_exp_f32 v40, v40
    v_exp_f32 v41, v41
    v_exp_f32 v42, v42
    v_exp_f32 v43, v43
    s_setprio 0
    v_mfma_f32_32x32x16_bf16 v[12:27], v[108:111], v[196:199], v[12:27]
    v_exp_f32 v44, v44
    v_exp_f32 v45, v45
    v_exp_f32 v46, v46
    v_exp_f32 v47, v47
    ds_read_b32 v10, v0 offset:25856
    ds_read2st64_b32 v[68:69], v253 offset0:128 offset1:142
    ds_read2st64_b32 v[60:61], v5 offset0:128 offset1:142
    ds_read2st64_b32 v[62:63], v5 offset0:156 offset1:170
    ds_read2st64_b32 v[64:65], v5 offset0:184 offset1:198
    ds_read2st64_b32 v[66:67], v5 offset0:212 offset1:226
    v_smfmac_f32_32x32x32_bf16 v[76:91], v[152:155], v[36:43], v2
    v_exp_f32 v48, v48
    v_exp_f32 v49, v49
    v_exp_f32 v50, v50
    v_mfma_f32_32x32x8_bf16 v[28:43], v[128:129], v[202:203], 0
    v_exp_f32 v51, v51
    v_exp_f32 v52, v52
    v_exp_f32 v53, v53
    v_exp_f32 v54, v54
    v_exp_f32 v55, v55
    v_smfmac_f32_32x32x32_bf16 v[76:91], v[156:159], v[44:51], v2
    v_exp_f32 v56, v56
    v_exp_f32 v57, v57
    v_exp_f32 v58, v58
    v_exp_f32 v59, v59
    s_setprio 2
    s_waitcnt lgkmcnt(0)
    v_cmp_eq_u32 vcc, 0, v10
    s_cbranch_vccnz P4_RT0
P4_BK0:
    v_cmp_eq_u32 vcc, 1, v10
    s_cbranch_vccnz P4_FB
    v_mfma_f32_32x32x16_bf16 v[28:43], v[112:115], v[196:199], v[28:43]
    v_exp_f32 v12, v12
    v_add_f32 v68, v68, v69
    v_add_f32 v60, v60, v61
    v_add_f32 v62, v62, v63
    v_exp_f32 v13, v13
    v_add_f32_dpp v68, v68, v68 quad_perm:[1,0,3,2] row_mask:0xf bank_mask:0xf
    v_add_f32 v64, v64, v65
    v_add_f32 v66, v66, v67
    v_exp_f32 v14, v14
    v_exp_f32 v15, v15
    v_smfmac_f32_32x32x32_bf16 v[76:91], v[160:163], v[52:59], v2
    v_add_f32_dpp v68, v68, v68 quad_perm:[2,3,0,1] row_mask:0xf bank_mask:0xf
    v_add_f32 v60, v60, v62
    v_add_f32 v64, v64, v66
    v_exp_f32 v16, v16
    v_add_f32 v60, v60, v64
    v_exp_f32 v17, v17
    v_exp_f32 v18, v18
    v_mfma_f32_32x32x8_bf16 v[44:59], v[130:131], v[200:201], 0
    v_rcp_f32 v62, v68
    v_exp_f32 v19, v19
    v_exp_f32 v20, v20
    v_mul_f32_dpp v60, v62, v60 row_newbcast:8 row_mask:0xf bank_mask:0xf
    v_mul_f32_dpp v68, v62, v68 row_newbcast:8 row_mask:0xf bank_mask:0xf
    v_cvt_pk_bf16_f32 v60, v60, v68
    v_exp_f32 v21, v21
    v_exp_f32 v22, v22
    v_exp_f32 v23, v23
    ds_write_b16 v7, v60 offset:16384
    s_mov_b64 exec, s[30:31]
    ds_write_b16_d16_hi v7, v60 offset:24574
    s_mov_b64 exec, 1
    ds_write_b32 v6, v2 offset:26112
    s_mov_b64 exec, -1
    s_cmp_lg_u32 s45, 0
    s_cbranch_scc1 P4_MK04
    buffer_store_dwordx4 v[72:75], v254, s[8:11], s43 offen offset:0 sc1
P4_MK04:
    v_smfmac_f32_32x32x32_bf16 v[76:91], v[164:167], v[12:19], v2
    v_exp_f32 v24, v24
    v_exp_f32 v25, v25
    v_exp_f32 v26, v26
    v_exp_f32 v27, v27
    s_setprio 1
    ds_read_b128 v[204:207], v252
    ds_read_b128 v[208:211], v252
    ds_read_b128 v[212:215], v252
    ds_read_b128 v[216:219], v252
    ds_read_b128 v[220:223], v252
    v_mfma_f32_32x32x16_bf16 v[44:59], v[116:119], v[196:199], v[44:59]
    v_exp_f32 v28, v28
    v_exp_f32 v29, v29
    v_exp_f32 v30, v30
    v_exp_f32 v31, v31
    v_smfmac_f32_32x32x32_bf16 v[76:91], v[168:171], v[20:27], v2
    v_exp_f32 v32, v32
    v_exp_f32 v33, v33
    v_exp_f32 v34, v34
    ds_read_b128 v[60:63], v252
    ds_read_b128 v[64:67], v252
    ds_read_b128 v[68:71], v252
    v_mfma_f32_32x32x8_bf16 v[12:27], v[130:131], v[202:203], 0
    v_exp_f32 v35, v35
    v_exp_f32 v36, v36
    v_exp_f32 v37, v37
    v_exp_f32 v38, v38
    v_exp_f32 v39, v39
    ds_read_b128 v[200:203], v9 offset:5120
    v_smfmac_f32_32x32x32_bf16 v[76:91], v[172:175], v[28:35], v2
    v_exp_f32 v40, v40
    v_exp_f32 v41, v41
    v_exp_f32 v42, v42
    v_exp_f32 v43, v43
    s_setprio 0
    ds_read_b32 v10, v0 offset:26112
    ds_read_b128 v[224:227], v9 offset:16384
    v_mfma_f32_32x32x16_bf16 v[12:27], v[120:123], v[196:199], v[12:27]
    v_exp_f32 v44, v44
    v_exp_f32 v45, v45
    v_exp_f32 v46, v46
    v_exp_f32 v47, v47
    ds_read_b128 v[196:199], v9 offset:4096
    v_smfmac_f32_32x32x32_bf16 v[76:91], v[176:179], v[36:43], v2
    v_exp_f32 v48, v48
    v_exp_f32 v49, v49
    v_exp_f32 v50, v50
    s_waitcnt lgkmcnt(1)
    v_cmp_eq_u32 vcc, 0, v10
    s_cbranch_vccnz P4_RT1
P4_BK1:
    s_waitcnt vmcnt(4)
    v_mfma_f32_32x32x8_bf16 v[28:43], v[124:125], v[200:201], 0
    v_exp_f32 v51, v51
    v_exp_f32 v52, v52
    v_exp_f32 v53, v53
    v_exp_f32 v54, v54
    v_smfmac_f32_16x16x64_bf16 v[204:207], v[224:227], v[228:235], v8
    v_exp_f32 v55, v55
    s_add_u32 s46, s24, 6144
    buffer_load_dwordx4 v[228:231], v3, s[8:11], s46 offen offset:0
    s_cmp_lg_u32 s45, 0
    s_cbranch_scc1 P4_MK06
    buffer_store_dwordx4 v[72:75], v3, s[8:11], s7 offen offset:0 sc1
P4_MK06:
    v_smfmac_f32_32x32x32_bf16 v[76:91], v[180:183], v[44:51], v2
    v_exp_f32 v56, v56
    v_exp_f32 v57, v57
    v_exp_f32 v58, v58
    v_exp_f32 v59, v59
    s_setprio 3
    s_waitcnt lgkmcnt(0)
    buffer_load_dwordx4 v[232:235], v3, s[8:11], s46 offen offset:1024
    v_mfma_f32_32x32x16_bf16 v[28:43], v[92:95], v[196:199], v[28:43]
    v_exp_f32 v12, v12
    v_exp_f32 v13, v13
    v_exp_f32 v14, v14
    v_exp_f32 v15, v15
    v_smfmac_f32_32x32x32_bf16 v[76:91], v[184:187], v[52:59], v2
    v_exp_f32 v16, v16
    v_exp_f32 v17, v17
    v_exp_f32 v18, v18
    s_waitcnt vmcnt(4)
    v_mfma_f32_32x32x8_bf16 v[44:59], v[124:125], v[202:203], 0
    v_exp_f32 v19, v19
    v_exp_f32 v20, v20
    v_exp_f32 v21, v21
    v_exp_f32 v22, v22
    v_smfmac_f32_16x16x64_bf16 v[208:211], v[224:227], v[236:243], v8
    v_exp_f32 v23, v23
    s_add_u32 s46, s24, 8192
    buffer_load_dwordx4 v[236:239], v3, s[8:11], s46 offen offset:0
    s_cmp_lg_u32 s45, 0
    s_cbranch_scc1 P4_MK07
    s_cmp_ge_u32 s3, 2
    s_cbranch_scc1 P4_MK07Q
    s_mul_i32 s42, s3, 4718592
    s_add_u32 s42, s42, s5
    s_add_u32 s42, s42, 7094272
    buffer_store_dwordx4 v[72:75], v254, s[8:11], s42 offen offset:0 sc1
P4_MK07Q:
    s_cmp_lg_u32 s3, 2
    s_cbranch_scc1 P4_MK07
    s_sub_u32 s42, s28, 256
    buffer_store_dwordx4 v[72:75], v3, s[8:11], s42 offen offset:0 sc1
P4_MK07:
    v_smfmac_f32_32x32x32_bf16 v[76:91], v[188:191], v[12:19], v2
    v_exp_f32 v24, v24
    v_exp_f32 v25, v25
    v_exp_f32 v26, v26
    v_exp_f32 v27, v27
    s_setprio 2
    buffer_load_dwordx4 v[240:243], v3, s[8:11], s46 offen offset:1024
    v_mfma_f32_32x32x16_bf16 v[44:59], v[96:99], v[196:199], v[44:59]
    v_exp_f32 v28, v28
    v_exp_f32 v29, v29
    v_exp_f32 v30, v30
    v_exp_f32 v31, v31
    v_smfmac_f32_32x32x32_bf16 v[76:91], v[192:195], v[20:27], v2
    v_exp_f32 v32, v32
    v_exp_f32 v33, v33
    v_exp_f32 v34, v34
    s_cmp_lg_u32 s45, 0
    s_cbranch_scc1 P4_NP016
    s_add_u32 m0, s6, 0
    s_add_u32 s27, s25, 0
    buffer_load_dwordx4 v3, s[8:11], s27 offen lds
P4_NP016:
    v_mfma_f32_32x32x8_bf16 v[12:27], v[126:127], v[200:201], 0
    v_exp_f32 v35, v35
    v_exp_f32 v36, v36
    v_exp_f32 v37, v37
    v_exp_f32 v38, v38
    v_exp_f32 v39, v39
    v_smfmac_f32_32x32x32_bf16 v[60:75], v[132:135], v[28:35], v2
    v_exp_f32 v40, v40
    v_exp_f32 v41, v41
    v_exp_f32 v42, v42
    v_exp_f32 v43, v43
    s_setprio 1
    ds_write_b128 v4, v[76:79] offset:32768
    v_mfma_f32_32x32x16_bf16 v[12:27], v[100:103], v[196:199], v[12:27]
    v_exp_f32 v44, v44
    v_exp_f32 v45, v45
    v_exp_f32 v46, v46
    v_exp_f32 v47, v47
    v_smfmac_f32_32x32x32_bf16 v[60:75], v[136:139], v[36:43], v2
    v_exp_f32 v48, v48
    v_exp_f32 v49, v49
    v_exp_f32 v50, v50
    ds_write_b128 v4, v[80:83] offset:32800
    s_waitcnt vmcnt(4)
    v_mfma_f32_32x32x8_bf16 v[28:43], v[126:127], v[202:203], 0
    v_exp_f32 v51, v51
    v_exp_f32 v52, v52
    v_exp_f32 v53, v53
    v_exp_f32 v54, v54
    v_smfmac_f32_16x16x64_bf16 v[212:215], v[224:227], v[244:251], v8
    v_exp_f32 v55, v55
    ds_write_b128 v4, v[84:87] offset:32832
    s_mov_b64 exec, 1
    ds_write_b32 v6, v2 offset:25888
    s_mov_b64 exec, -1
    s_add_u32 s46, s24, 73728
    buffer_load_dwordx4 v[244:247], v3, s[8:11], s46 offen offset:0
    v_smfmac_f32_32x32x32_bf16 v[60:75], v[140:143], v[44:51], v2
    v_exp_f32 v56, v56
    v_exp_f32 v57, v57
    v_exp_f32 v58, v58
    v_exp_f32 v59, v59
    s_setprio 0
    buffer_load_dwordx4 v[248:251], v3, s[8:11], s46 offen offset:1024
    v_mfma_f32_32x32x16_bf16 v[28:43], v[104:107], v[196:199], v[28:43]
    v_exp_f32 v12, v12
    v_exp_f32 v13, v13
    v_exp_f32 v14, v14
    v_exp_f32 v15, v15
    v_smfmac_f32_32x32x32_bf16 v[60:75], v[144:147], v[52:59], v2
    v_exp_f32 v16, v16
    v_exp_f32 v17, v17
    v_exp_f32 v18, v18
    s_waitcnt vmcnt(4)
    v_mfma_f32_32x32x8_bf16 v[44:59], v[128:129], v[200:201], 0
    v_exp_f32 v19, v19
    v_exp_f32 v20, v20
    v_exp_f32 v21, v21
    v_exp_f32 v22, v22
    v_smfmac_f32_16x16x64_bf16 v[216:219], v[224:227], v[228:235], v8
    v_exp_f32 v23, v23
    s_add_u32 s46, s24, 75776
    buffer_load_dwordx4 v[228:231], v3, s[8:11], s46 offen offset:0
    v_smfmac_f32_32x32x32_bf16 v[60:75], v[148:151], v[12:19], v2
    v_exp_f32 v24, v24
    v_exp_f32 v25, v25
    v_exp_f32 v26, v26
    v_exp_f32 v27, v27
    s_setprio 3
    buffer_load_dwordx4 v[232:235], v3, s[8:11], s46 offen offset:1024
    v_mfma_f32_32x32x16_bf16 v[44:59], v[108:111], v[196:199], v[44:59]
    v_exp_f32 v28, v28
    v_exp_f32 v29, v29
    v_exp_f32 v30, v30
    v_exp_f32 v31, v31
    ds_read_b32 v10, v0 offset:25888
    ds_read2st64_b32 v[84:85], v253 offset0:128 offset1:142
    ds_read2st64_b32 v[76:77], v5 offset0:128 offset1:142
    ds_read2st64_b32 v[78:79], v5 offset0:156 offset1:170
    ds_read2st64_b32 v[80:81], v5 offset0:184 offset1:198
    ds_read2st64_b32 v[82:83], v5 offset0:212 offset1:226
    v_smfmac_f32_32x32x32_bf16 v[60:75], v[152:155], v[20:27], v2
    v_exp_f32 v32, v32
    v_exp_f32 v33, v33
    v_exp_f32 v34, v34
    s_cmp_lg_u32 s45, 0
    s_cbranch_scc1 P4_NP019
    s_add_u32 m0, s6, 8192
    s_add_u32 s27, s25, 7168
    buffer_load_dwordx4 v3, s[8:11], s27 offen lds
P4_NP019:
    v_mfma_f32_32x32x8_bf16 v[12:27], v[128:129], v[202:203], 0
    v_exp_f32 v35, v35
    v_exp_f32 v36, v36
    v_exp_f32 v37, v37
    v_exp_f32 v38, v38
    v_exp_f32 v39, v39
    v_smfmac_f32_32x32x32_bf16 v[60:75], v[156:159], v[28:35], v2
    v_exp_f32 v40, v40
    v_exp_f32 v41, v41
    v_exp_f32 v42, v42
    v_exp_f32 v43, v43
    s_setprio 2
    s_waitcnt lgkmcnt(0)
    v_cmp_eq_u32 vcc, 0, v10
    s_cbranch_vccnz P4_RT2
P4_BK2:
    v_mfma_f32_32x32x16_bf16 v[12:27], v[112:115], v[196:199], v[12:27]
    v_exp_f32 v44, v44
    v_add_f32 v84, v84, v85
    v_add_f32 v76, v76, v77
    v_add_f32 v78, v78, v79
    v_exp_f32 v45, v45
    v_add_f32_dpp v84, v84, v84 quad_perm:[1,0,3,2] row_mask:0xf bank_mask:0xf
    v_add_f32 v80, v80, v81
    v_add_f32 v82, v82, v83
    v_exp_f32 v46, v46
    v_exp_f32 v47, v47
    v_smfmac_f32_32x32x32_bf16 v[60:75], v[160:163], v[36:43], v2
    v_add_f32_dpp v84, v84, v84 quad_perm:[2,3,0,1] row_mask:0xf bank_mask:0xf
    v_add_f32 v76, v76, v78
    v_add_f32 v80, v80, v82
    v_exp_f32 v48, v48
    v_add_f32 v76, v76, v80
    v_exp_f32 v49, v49
    v_exp_f32 v50, v50
    s_waitcnt vmcnt(4)
    v_mfma_f32_32x32x8_bf16 v[28:43], v[130:131], v[200:201], 0
    v_rcp_f32 v78, v84
    v_exp_f32 v51, v51
    v_exp_f32 v52, v52
    v_mul_f32_dpp v76, v78, v76 row_newbcast:8 row_mask:0xf bank_mask:0xf
    v_mul_f32_dpp v84, v78, v84 row_newbcast:8 row_mask:0xf bank_mask:0xf
    v_cvt_pk_bf16_f32 v76, v76, v84
    v_exp_f32 v53, v53
    v_exp_f32 v54, v54
    v_smfmac_f32_16x16x64_bf16 v[220:223], v[224:227], v[236:243], v8
    v_exp_f32 v55, v55
    ds_write_b16 v7, v76 offset:17408
    s_mov_b64 exec, s[30:31]
    ds_write_b16_d16_hi v7, v76 offset:24702
    s_mov_b64 exec, 1
    ds_write_b32 v6, v2 offset:26144
    s_mov_b64 exec, -1
    s_add_u32 s46, s24, 77824
    buffer_load_dwordx4 v[236:239], v3, s[8:11], s46 offen offset:0
    v_smfmac_f32_32x32x32_bf16 v[60:75], v[164:167], v[44:51], v2
    v_exp_f32 v56, v56
    v_exp_f32 v57, v57
    v_exp_f32 v58, v58
    v_exp_f32 v59, v59
    s_setprio 1
    buffer_load_dwordx4 v[240:243], v3, s[8:11], s46 offen offset:1024
    v_mfma_f32_32x32x16_bf16 v[28:43], v[116:119], v[196:199], v[28:43]
    v_exp_f32 v12, v12
    v_exp_f32 v13, v13
    v_exp_f32 v14, v14
    v_exp_f32 v15, v15
    v_smfmac_f32_32x32x32_bf16 v[60:75], v[168:171], v[52:59], v2
    v_exp_f32 v16, v16
    v_exp_f32 v17, v17
    v_exp_f32 v18, v18
    ds_read_b128 v[76:79], v252
    ds_read_b128 v[80:83], v252
    ds_read_b128 v[84:87], v252
    v_mfma_f32_32x32x8_bf16 v[44:59], v[130:131], v[202:203], 0
    v_exp_f32 v19, v19
    v_exp_f32 v20, v20
    v_exp_f32 v21, v21
    v_exp_f32 v22, v22
    v_exp_f32 v23, v23
    ds_read_b128 v[200:203], v9 offset:7168
    v_smfmac_f32_32x32x32_bf16 v[60:75], v[172:175], v[12:19], v2
    v_exp_f32 v24, v24
    v_exp_f32 v25, v25
    v_exp_f32 v26, v26
    v_exp_f32 v27, v27
    s_setprio 0
    ds_read_b32 v10, v0 offset:26144
    ds_read_b128 v[224:227], v9 offset:17408
    v_mfma_f32_32x32x16_bf16 v[44:59], v[120:123], v[196:199], v[44:59]
    v_exp_f32 v28, v28
    v_exp_f32 v29, v29
    v_exp_f32 v30, v30
    v_exp_f32 v31, v31
    ds_read_b128 v[196:199], v9 offset:6144
    v_smfmac_f32_32x32x32_bf16 v[60:75], v[176:179], v[20:27], v2
    v_exp_f32 v32, v32
    v_exp_f32 v33, v33
    v_exp_f32 v34, v34
    s_waitcnt lgkmcnt(1)
    v_cmp_eq_u32 vcc, 0, v10
    s_cbranch_vccnz P4_RT3
P4_BK3:
    s_waitcnt vmcnt(4)
    s_cmp_lg_u32 s45, 0
    s_cbranch_scc1 P4_NP022
    s_add_u32 m0, s6, 16384
    s_add_u32 s27, s25, 14336
    buffer_load_dwordx4 v3, s[8:11], s27 offen lds
P4_NP022:
    v_mfma_f32_32x32x8_bf16 v[12:27], v[124:125], v[200:201], 0
    v_exp_f32 v35, v35
    v_exp_f32 v36, v36
    v_exp_f32 v37, v37
    v_exp_f32 v38, v38
    v_smfmac_f32_16x16x64_bf16 v[204:207], v[224:227], v[244:251], v8
    v_exp_f32 v39, v39
    s_add_u32 s46, s24, 79872
    buffer_load_dwordx4 v[244:247], v3, s[8:11], s46 offen offset:0
    v_smfmac_f32_32x32x32_bf16 v[60:75], v[180:183], v[28:35], v2
    v_exp_f32 v40, v40
    v_exp_f32 v41, v41
    v_exp_f32 v42, v42
    v_exp_f32 v43, v43
    s_setprio 3
    s_waitcnt lgkmcnt(0)
    buffer_load_dwordx4 v[248:251], v3, s[8:11], s46 offen offset:1024
    v_mfma_f32_32x32x16_bf16 v[12:27], v[92:95], v[196:199], v[12:27]
    v_exp_f32 v44, v44
    v_exp_f32 v45, v45
    v_exp_f32 v46, v46
    v_exp_f32 v47, v47
    v_smfmac_f32_32x32x32_bf16 v[60:75], v[184:187], v[36:43], v2
    v_exp_f32 v48, v48
    v_exp_f32 v49, v49
    v_exp_f32 v50, v50
    s_waitcnt vmcnt(4)
    v_mfma_f32_32x32x8_bf16 v[28:43], v[124:125], v[202:203], 0
    v_exp_f32 v51, v51
    v_exp_f32 v52, v52
    v_exp_f32 v53, v53
    v_exp_f32 v54, v54
    v_smfmac_f32_16x16x64_bf16 v[208:211], v[224:227], v[228:235], v8
    v_exp_f32 v55, v55
    s_add_u32 s46, s24, 81920
    buffer_load_dwordx4 v[228:231], v3, s[8:11], s46 offen offset:0
    v_smfmac_f32_32x32x32_bf16 v[60:75], v[188:191], v[44:51], v2
    v_exp_f32 v56, v56
    v_exp_f32 v57, v57
    v_exp_f32 v58, v58
    v_exp_f32 v59, v59
    s_setprio 2
    buffer_load_dwordx4 v[232:235], v3, s[8:11], s46 offen offset:1024
    v_mfma_f32_32x32x16_bf16 v[28:43], v[96:99], v[196:199], v[28:43]
    v_exp_f32 v12, v12
    v_exp_f32 v13, v13
    v_exp_f32 v14, v14
    v_exp_f32 v15, v15
    v_smfmac_f32_32x32x32_bf16 v[60:75], v[192:195], v[52:59], v2
    v_exp_f32 v16, v16
    v_exp_f32 v17, v17
    v_exp_f32 v18, v18
    v_mfma_f32_32x32x8_bf16 v[44:59], v[126:127], v[200:201], 0
    v_exp_f32 v19, v19
    v_exp_f32 v20, v20
    v_exp_f32 v21, v21
    v_exp_f32 v22, v22
    v_exp_f32 v23, v23
    v_smfmac_f32_32x32x32_bf16 v[76:91], v[132:135], v[12:19], v2
    v_exp_f32 v24, v24
    v_exp_f32 v25, v25
    v_exp_f32 v26, v26
    v_exp_f32 v27, v27
    s_setprio 1
    ds_write_b128 v4, v[60:63] offset:32768
    v_mfma_f32_32x32x16_bf16 v[44:59], v[100:103], v[196:199], v[44:59]
    v_exp_f32 v28, v28
    v_exp_f32 v29, v29
    v_exp_f32 v30, v30
    v_exp_f32 v31, v31
    v_smfmac_f32_32x32x32_bf16 v[76:91], v[136:139], v[20:27], v2
    v_exp_f32 v32, v32
    v_exp_f32 v33, v33
    v_exp_f32 v34, v34
    ds_write_b128 v4, v[64:67] offset:32800
    s_waitcnt vmcnt(4)
    s_cmp_lg_u32 s45, 0
    s_cbranch_scc1 P4_NP025
    s_add_u32 m0, s6, 24576
    s_add_u32 s27, s25, 21504
    buffer_load_dwordx4 v3, s[8:11], s27 offen lds
P4_NP025:
    v_mfma_f32_32x32x8_bf16 v[12:27], v[126:127], v[202:203], 0
    v_exp_f32 v35, v35
    v_exp_f32 v36, v36
    v_exp_f32 v37, v37
    v_exp_f32 v38, v38
    v_smfmac_f32_16x16x64_bf16 v[212:215], v[224:227], v[236:243], v8
    v_exp_f32 v39, v39
    ds_write_b128 v4, v[68:71] offset:32832
    s_mov_b64 exec, 1
    ds_write_b32 v6, v2 offset:25920
    s_mov_b64 exec, -1
    s_add_u32 s46, s24, 147456
    buffer_load_dwordx4 v[236:239], v3, s[8:11], s46 offen offset:0
    v_smfmac_f32_32x32x32_bf16 v[76:91], v[140:143], v[28:35], v2
    v_exp_f32 v40, v40
    v_exp_f32 v41, v41
    v_exp_f32 v42, v42
    v_exp_f32 v43, v43
    s_setprio 0
    buffer_load_dwordx4 v[240:243], v3, s[8:11], s46 offen offset:1024
    v_mfma_f32_32x32x16_bf16 v[12:27], v[104:107], v[196:199], v[12:27]
    v_exp_f32 v44, v44
    v_exp_f32 v45, v45
    v_exp_f32 v46, v46
    v_exp_f32 v47, v47
    v_smfmac_f32_32x32x32_bf16 v[76:91], v[144:147], v[36:43], v2
    v_exp_f32 v48, v48
    v_exp_f32 v49, v49
    v_exp_f32 v50, v50
    s_waitcnt vmcnt(4)
    v_mfma_f32_32x32x8_bf16 v[28:43], v[128:129], v[200:201], 0
    v_exp_f32 v51, v51
    v_exp_f32 v52, v52
    v_exp_f32 v53, v53
    v_exp_f32 v54, v54
    v_smfmac_f32_16x16x64_bf16 v[216:219], v[224:227], v[244:251], v8
    v_exp_f32 v55, v55
    s_add_u32 s46, s24, 149504
    buffer_load_dwordx4 v[244:247], v3, s[8:11], s46 offen offset:0
    v_smfmac_f32_32x32x32_bf16 v[76:91], v[148:151], v[44:51], v2
    v_exp_f32 v56, v56
    v_exp_f32 v57, v57
    v_exp_f32 v58, v58
    v_exp_f32 v59, v59
    s_setprio 3
    buffer_load_dwordx4 v[248:251], v3, s[8:11], s46 offen offset:1024
    v_mfma_f32_32x32x16_bf16 v[28:43], v[108:111], v[196:199], v[28:43]
    v_exp_f32 v12, v12
    v_exp_f32 v13, v13
    v_exp_f32 v14, v14
    v_exp_f32 v15, v15
    ds_read_b32 v10, v0 offset:25920
    ds_read2st64_b32 v[68:69], v253 offset0:128 offset1:142
    ds_read2st64_b32 v[60:61], v5 offset0:128 offset1:142
    ds_read2st64_b32 v[62:63], v5 offset0:156 offset1:170
    ds_read2st64_b32 v[64:65], v5 offset0:184 offset1:198
    ds_read2st64_b32 v[66:67], v5 offset0:212 offset1:226
    v_smfmac_f32_32x32x32_bf16 v[76:91], v[152:155], v[52:59], v2
    v_exp_f32 v16, v16
    v_exp_f32 v17, v17
    v_exp_f32 v18, v18
    v_mfma_f32_32x32x8_bf16 v[44:59], v[128:129], v[202:203], 0
    v_exp_f32 v19, v19
    v_exp_f32 v20, v20
    v_exp_f32 v21, v21
    v_exp_f32 v22, v22
    v_exp_f32 v23, v23
    v_smfmac_f32_32x32x32_bf16 v[76:91], v[156:159], v[12:19], v2
    v_exp_f32 v24, v24
    v_exp_f32 v25, v25
    v_exp_f32 v26, v26
    v_exp_f32 v27, v27
    s_setprio 2
    s_waitcnt lgkmcnt(0)
    v_cmp_eq_u32 vcc, 0, v10
    s_cbranch_vccnz P4_RT4
P4_BK4:
    v_mfma_f32_32x32x16_bf16 v[44:59], v[112:115], v[196:199], v[44:59]
    v_exp_f32 v28, v28
    v_add_f32 v68, v68, v69
    v_add_f32 v60, v60, v61
    v_add_f32 v62, v62, v63
    v_exp_f32 v29, v29
    v_add_f32_dpp v68, v68, v68 quad_perm:[1,0,3,2] row_mask:0xf bank_mask:0xf
    v_add_f32 v64, v64, v65
    v_add_f32 v66, v66, v67
    v_exp_f32 v30, v30
    v_exp_f32 v31, v31
    v_smfmac_f32_32x32x32_bf16 v[76:91], v[160:163], v[20:27], v2
    v_add_f32_dpp v68, v68, v68 quad_perm:[2,3,0,1] row_mask:0xf bank_mask:0xf
    v_add_f32 v60, v60, v62
    v_add_f32 v64, v64, v66
    v_exp_f32 v32, v32
    v_add_f32 v60, v60, v64
    v_exp_f32 v33, v33
    v_exp_f32 v34, v34
    s_waitcnt vmcnt(4)
    s_cmp_lg_u32 s45, 0
    s_cbranch_scc1 P4_NP028
    s_add_u32 m0, s6, 32768
    s_add_u32 s27, s25, 28672
    buffer_load_dwordx4 v3, s[8:11], s27 offen lds
P4_NP028:
    v_mfma_f32_32x32x8_bf16 v[12:27], v[130:131], v[200:201], 0
    v_rcp_f32 v62, v68
    v_exp_f32 v35, v35
    v_exp_f32 v36, v36
    v_mul_f32_dpp v60, v62, v60 row_newbcast:8 row_mask:0xf bank_mask:0xf
    v_mul_f32_dpp v68, v62, v68 row_newbcast:8 row_mask:0xf bank_mask:0xf
    v_cvt_pk_bf16_f32 v60, v60, v68
    v_exp_f32 v37, v37
    v_exp_f32 v38, v38
    v_smfmac_f32_16x16x64_bf16 v[220:223], v[224:227], v[228:235], v8
    v_exp_f32 v39, v39
    ds_write_b16 v7, v60 offset:18432
    s_mov_b64 exec, s[30:31]
    ds_write_b16_d16_hi v7, v60 offset:24578
    s_mov_b64 exec, 1
    ds_write_b32 v6, v2 offset:26176
    s_mov_b64 exec, -1
    s_add_u32 s46, s24, 151552
    buffer_load_dwordx4 v[228:231], v3, s[8:11], s46 offen offset:0
    v_smfmac_f32_32x32x32_bf16 v[76:91], v[164:167], v[28:35], v2
    v_exp_f32 v40, v40
    v_exp_f32 v41, v41
    v_exp_f32 v42, v42
    v_exp_f32 v43, v43
    s_setprio 1
    buffer_load_dwordx4 v[232:235], v3, s[8:11], s46 offen offset:1024
    v_mfma_f32_32x32x16_bf16 v[12:27], v[116:119], v[196:199], v[12:27]
    v_exp_f32 v44, v44
    v_exp_f32 v45, v45
    v_exp_f32 v46, v46
    v_exp_f32 v47, v47
    v_smfmac_f32_32x32x32_bf16 v[76:91], v[168:171], v[36:43], v2
    v_exp_f32 v48, v48
    v_exp_f32 v49, v49
    v_exp_f32 v50, v50
    ds_read_b128 v[60:63], v252
    ds_read_b128 v[64:67], v252
    ds_read_b128 v[68:71], v252
    v_mfma_f32_32x32x8_bf16 v[28:43], v[130:131], v[202:203], 0
    v_exp_f32 v51, v51
    v_exp_f32 v52, v52
    v_exp_f32 v53, v53
    v_exp_f32 v54, v54
    v_exp_f32 v55, v55
    ds_read_b128 v[200:203], v9 offset:9216
    v_smfmac_f32_32x32x32_bf16 v[76:91], v[172:175], v[44:51], v2
    v_exp_f32 v56, v56
    v_exp_f32 v57, v57
    v_exp_f32 v58, v58
    v_exp_f32 v59, v59
    s_setprio 0
    ds_read_b32 v10, v0 offset:26176
    ds_read_b128 v[224:227], v9 offset:18432
    v_mfma_f32_32x32x16_bf16 v[28:43], v[120:123], v[196:199], v[28:43]
    v_exp_f32 v12, v12
    v_exp_f32 v13, v13
    v_exp_f32 v14, v14
    v_exp_f32 v15, v15
    ds_read_b128 v[196:199], v9 offset:8192
    v_smfmac_f32_32x32x32_bf16 v[76:91], v[176:179], v[52:59], v2
    v_exp_f32 v16, v16
    v_exp_f32 v17, v17
    v_exp_f32 v18, v18
    s_waitcnt lgkmcnt(1)
    v_cmp_eq_u32 vcc, 0, v10
    s_cbranch_vccnz P4_RT5
P4_BK5:
    s_waitcnt vmcnt(4)
    v_mfma_f32_32x32x8_bf16 v[44:59], v[124:125], v[200:201], 0
    v_exp_f32 v19, v19
    v_exp_f32 v20, v20
    v_exp_f32 v21, v21
    v_exp_f32 v22, v22
    v_smfmac_f32_16x16x64_bf16 v[204:207], v[224:227], v[236:243], v8
    v_exp_f32 v23, v23
    s_add_u32 s46, s24, 153600
    buffer_load_dwordx4 v[236:239], v3, s[8:11], s46 offen offset:0
    v_smfmac_f32_32x32x32_bf16 v[76:91], v[180:183], v[12:19], v2
    v_exp_f32 v24, v24
    v_exp_f32 v25, v25
    v_exp_f32 v26, v26
    v_exp_f32 v27, v27
    s_setprio 3
    s_waitcnt lgkmcnt(0)
    buffer_load_dwordx4 v[240:243], v3, s[8:11], s46 offen offset:1024
    v_mfma_f32_32x32x16_bf16 v[44:59], v[92:95], v[196:199], v[44:59]
    v_exp_f32 v28, v28
    v_exp_f32 v29, v29
    v_exp_f32 v30, v30
    v_exp_f32 v31, v31
    v_smfmac_f32_32x32x32_bf16 v[76:91], v[184:187], v[20:27], v2
    v_exp_f32 v32, v32
    v_exp_f32 v33, v33
    v_exp_f32 v34, v34
    s_waitcnt vmcnt(4)
    s_cmp_lg_u32 s45, 0
    s_cbranch_scc1 P4_NP031
    s_add_u32 m0, s6, 40960
    s_add_u32 s27, s25, 35840
    buffer_load_dwordx4 v3, s[8:11], s27 offen lds
P4_NP031:
    v_mfma_f32_32x32x8_bf16 v[12:27], v[124:125], v[202:203], 0
    v_exp_f32 v35, v35
    v_exp_f32 v36, v36
    v_exp_f32 v37, v37
    v_exp_f32 v38, v38
    v_smfmac_f32_16x16x64_bf16 v[208:211], v[224:227], v[244:251], v8
    v_exp_f32 v39, v39
    s_add_u32 s46, s24, 155648
    buffer_load_dwordx4 v[244:247], v3, s[8:11], s46 offen offset:0
    v_smfmac_f32_32x32x32_bf16 v[76:91], v[188:191], v[28:35], v2
    v_exp_f32 v40, v40
    v_exp_f32 v41, v41
    v_exp_f32 v42, v42
    v_exp_f32 v43, v43
    s_setprio 2
    buffer_load_dwordx4 v[248:251], v3, s[8:11], s46 offen offset:1024
    v_mfma_f32_32x32x16_bf16 v[12:27], v[96:99], v[196:199], v[12:27]
    v_exp_f32 v44, v44
    v_exp_f32 v45, v45
    v_exp_f32 v46, v46
    v_exp_f32 v47, v47
    v_smfmac_f32_32x32x32_bf16 v[76:91], v[192:195], v[36:43], v2
    v_exp_f32 v48, v48
    v_exp_f32 v49, v49
    v_exp_f32 v50, v50
    v_mfma_f32_32x32x8_bf16 v[28:43], v[126:127], v[200:201], 0
    v_exp_f32 v51, v51
    v_exp_f32 v52, v52
    v_exp_f32 v53, v53
    v_exp_f32 v54, v54
    v_exp_f32 v55, v55
    v_smfmac_f32_32x32x32_bf16 v[60:75], v[132:135], v[44:51], v2
    v_exp_f32 v56, v56
    v_exp_f32 v57, v57
    v_exp_f32 v58, v58
    v_exp_f32 v59, v59
    s_setprio 1
    ds_write_b128 v4, v[76:79] offset:32768
    v_mfma_f32_32x32x16_bf16 v[28:43], v[100:103], v[196:199], v[28:43]
    v_exp_f32 v12, v12
    v_exp_f32 v13, v13
    v_exp_f32 v14, v14
    v_exp_f32 v15, v15
    v_smfmac_f32_32x32x32_bf16 v[60:75], v[136:139], v[52:59], v2
    v_exp_f32 v16, v16
    v_exp_f32 v17, v17
    v_exp_f32 v18, v18
    ds_write_b128 v4, v[80:83] offset:32800
    s_waitcnt vmcnt(4)
    v_mfma_f32_32x32x8_bf16 v[44:59], v[126:127], v[202:203], 0
    v_exp_f32 v19, v19
    v_exp_f32 v20, v20
    v_exp_f32 v21, v21
    v_exp_f32 v22, v22
    v_smfmac_f32_16x16x64_bf16 v[212:215], v[224:227], v[228:235], v8
    v_exp_f32 v23, v23
    ds_write_b128 v4, v[84:87] offset:32832
    s_mov_b64 exec, 1
    ds_write_b32 v6, v2 offset:25952
    s_mov_b64 exec, -1
    s_add_u32 s46, s24, 221184
    buffer_load_dwordx4 v[228:231], v3, s[8:11], s46 offen offset:0
    v_smfmac_f32_32x32x32_bf16 v[60:75], v[140:143], v[12:19], v2
    v_exp_f32 v24, v24
    v_exp_f32 v25, v25
    v_exp_f32 v26, v26
    v_exp_f32 v27, v27
    s_setprio 0
    buffer_load_dwordx4 v[232:235], v3, s[8:11], s46 offen offset:1024
    v_mfma_f32_32x32x16_bf16 v[44:59], v[104:107], v[196:199], v[44:59]
    v_exp_f32 v28, v28
    v_exp_f32 v29, v29
    v_exp_f32 v30, v30
    v_exp_f32 v31, v31
    v_smfmac_f32_32x32x32_bf16 v[60:75], v[144:147], v[20:27], v2
    v_exp_f32 v32, v32
    v_exp_f32 v33, v33
    v_exp_f32 v34, v34
    s_waitcnt vmcnt(4)
    s_cmp_lg_u32 s45, 0
    s_cbranch_scc1 P4_NP034
    s_add_u32 m0, s6, 49152
    s_add_u32 s27, s25, 43008
    buffer_load_dwordx4 v3, s[8:11], s27 offen lds
P4_NP034:
    v_mfma_f32_32x32x8_bf16 v[12:27], v[128:129], v[200:201], 0
    v_exp_f32 v35, v35
    v_exp_f32 v36, v36
    v_exp_f32 v37, v37
    v_exp_f32 v38, v38
    v_smfmac_f32_16x16x64_bf16 v[216:219], v[224:227], v[236:243], v8
    v_exp_f32 v39, v39
    s_add_u32 s46, s24, 223232
    buffer_load_dwordx4 v[236:239], v3, s[8:11], s46 offen offset:0
    v_smfmac_f32_32x32x32_bf16 v[60:75], v[148:151], v[28:35], v2
    v_exp_f32 v40, v40
    v_exp_f32 v41, v41
    v_exp_f32 v42, v42
    v_exp_f32 v43, v43
    s_setprio 3
    buffer_load_dwordx4 v[240:243], v3, s[8:11], s46 offen offset:1024
    v_mfma_f32_32x32x16_bf16 v[12:27], v[108:111], v[196:199], v[12:27]
    v_exp_f32 v44, v44
    v_exp_f32 v45, v45
    v_exp_f32 v46, v46
    v_exp_f32 v47, v47
    ds_read_b32 v10, v0 offset:25952
    ds_read2st64_b32 v[84:85], v253 offset0:128 offset1:142
    ds_read2st64_b32 v[76:77], v5 offset0:128 offset1:142
    ds_read2st64_b32 v[78:79], v5 offset0:156 offset1:170
    ds_read2st64_b32 v[80:81], v5 offset0:184 offset1:198
    ds_read2st64_b32 v[82:83], v5 offset0:212 offset1:226
    v_smfmac_f32_32x32x32_bf16 v[60:75], v[152:155], v[36:43], v2
    v_exp_f32 v48, v48
    v_exp_f32 v49, v49
    v_exp_f32 v50, v50
    v_mfma_f32_32x32x8_bf16 v[28:43], v[128:129], v[202:203], 0
    v_exp_f32 v51, v51
    v_exp_f32 v52, v52
    v_exp_f32 v53, v53
    v_exp_f32 v54, v54
    v_exp_f32 v55, v55
    v_smfmac_f32_32x32x32_bf16 v[60:75], v[156:159], v[44:51], v2
    v_exp_f32 v56, v56
    v_exp_f32 v57, v57
    v_exp_f32 v58, v58
    v_exp_f32 v59, v59
    s_setprio 2
    s_waitcnt lgkmcnt(0)
    v_cmp_eq_u32 vcc, 0, v10
    s_cbranch_vccnz P4_RT6
P4_BK6:
    v_mfma_f32_32x32x16_bf16 v[28:43], v[112:115], v[196:199], v[28:43]
    v_exp_f32 v12, v12
    v_add_f32 v84, v84, v85
    v_add_f32 v76, v76, v77
    v_add_f32 v78, v78, v79
    v_exp_f32 v13, v13
    v_add_f32_dpp v84, v84, v84 quad_perm:[1,0,3,2] row_mask:0xf bank_mask:0xf
    v_add_f32 v80, v80, v81
    v_add_f32 v82, v82, v83
    v_exp_f32 v14, v14
    v_exp_f32 v15, v15
    v_smfmac_f32_32x32x32_bf16 v[60:75], v[160:163], v[52:59], v2
    v_add_f32_dpp v84, v84, v84 quad_perm:[2,3,0,1] row_mask:0xf bank_mask:0xf
    v_add_f32 v76, v76, v78
    v_add_f32 v80, v80, v82
    v_exp_f32 v16, v16
    v_add_f32 v76, v76, v80
    v_exp_f32 v17, v17
    v_exp_f32 v18, v18
    s_waitcnt vmcnt(4)
    v_mfma_f32_32x32x8_bf16 v[44:59], v[130:131], v[200:201], 0
    v_rcp_f32 v78, v84
    v_exp_f32 v19, v19
    v_exp_f32 v20, v20
    v_mul_f32_dpp v76, v78, v76 row_newbcast:8 row_mask:0xf bank_mask:0xf
    v_mul_f32_dpp v84, v78, v84 row_newbcast:8 row_mask:0xf bank_mask:0xf
    v_cvt_pk_bf16_f32 v76, v76, v84
    v_exp_f32 v21, v21
    v_exp_f32 v22, v22
    v_smfmac_f32_16x16x64_bf16 v[220:223], v[224:227], v[244:251], v8
    v_exp_f32 v23, v23
    ds_write_b16 v7, v76 offset:19456
    s_mov_b64 exec, s[30:31]
    ds_write_b16_d16_hi v7, v76 offset:24706
    s_mov_b64 exec, 1
    ds_write_b32 v6, v2 offset:26208
    s_mov_b64 exec, -1
    s_add_u32 s46, s24, 225280
    buffer_load_dwordx4 v[244:247], v3, s[8:11], s46 offen offset:0
    v_smfmac_f32_32x32x32_bf16 v[60:75], v[164:167], v[12:19], v2
    v_exp_f32 v24, v24
    v_exp_f32 v25, v25
    v_exp_f32 v26, v26
    v_exp_f32 v27, v27
    s_setprio 1
    buffer_load_dwordx4 v[248:251], v3, s[8:11], s46 offen offset:1024
    v_mfma_f32_32x32x16_bf16 v[44:59], v[116:119], v[196:199], v[44:59]
    v_exp_f32 v28, v28
    v_exp_f32 v29, v29
    v_exp_f32 v30, v30
    v_exp_f32 v31, v31
    v_smfmac_f32_32x32x32_bf16 v[60:75], v[168:171], v[20:27], v2
    v_exp_f32 v32, v32
    v_exp_f32 v33, v33
    v_exp_f32 v34, v34
    ds_read_b128 v[76:79], v252
    ds_read_b128 v[80:83], v252
    ds_read_b128 v[84:87], v252
    s_cmp_lg_u32 s45, 0
    s_cbranch_scc1 P4_NP037
    s_add_u32 m0, s6, 57344
    s_add_u32 s27, s25, 50176
    buffer_load_dwordx4 v3, s[8:11], s27 offen lds
P4_NP037:
    v_mfma_f32_32x32x8_bf16 v[12:27], v[130:131], v[202:203], 0
    v_exp_f32 v35, v35
    v_exp_f32 v36, v36
    v_exp_f32 v37, v37
    v_exp_f32 v38, v38
    v_exp_f32 v39, v39
    ds_read_b128 v[200:203], v9 offset:11264
    v_smfmac_f32_32x32x32_bf16 v[60:75], v[172:175], v[28:35], v2
    v_exp_f32 v40, v40
    v_exp_f32 v41, v41
    v_exp_f32 v42, v42
    v_exp_f32 v43, v43
    s_setprio 0
    ds_read_b32 v10, v0 offset:26208
    ds_read_b128 v[224:227], v9 offset:19456
    v_mfma_f32_32x32x16_bf16 v[12:27], v[120:123], v[196:199], v[12:27]
    v_exp_f32 v44, v44
    v_exp_f32 v45, v45
    v_exp_f32 v46, v46
    v_exp_f32 v47, v47
    ds_read_b128 v[196:199], v9 offset:10240
    v_smfmac_f32_32x32x32_bf16 v[60:75], v[176:179], v[36:43], v2
    v_exp_f32 v48, v48
    v_exp_f32 v49, v49
    v_exp_f32 v50, v50
    s_waitcnt lgkmcnt(1)
    v_cmp_eq_u32 vcc, 0, v10
    s_cbranch_vccnz P4_RT7
P4_BK7:
    s_waitcnt vmcnt(4)
    v_mfma_f32_32x32x8_bf16 v[28:43], v[124:125], v[200:201], 0
    v_exp_f32 v51, v51
    v_exp_f32 v52, v52
    v_exp_f32 v53, v53
    v_exp_f32 v54, v54
    v_smfmac_f32_16x16x64_bf16 v[204:207], v[224:227], v[228:235], v8
    v_exp_f32 v55, v55
    s_add_u32 s46, s24, 227328
    buffer_load_dwordx4 v[228:231], v3, s[8:11], s46 offen offset:0
    v_smfmac_f32_32x32x32_bf16 v[60:75], v[180:183], v[44:51], v2
    v_exp_f32 v56, v56
    v_exp_f32 v57, v57
    v_exp_f32 v58, v58
    v_exp_f32 v59, v59
    s_setprio 3
    s_waitcnt lgkmcnt(0)
    buffer_load_dwordx4 v[232:235], v3, s[8:11], s46 offen offset:1024
    v_mfma_f32_32x32x16_bf16 v[28:43], v[92:95], v[196:199], v[28:43]
    v_exp_f32 v12, v12
    v_exp_f32 v13, v13
    v_exp_f32 v14, v14
    v_exp_f32 v15, v15
    v_smfmac_f32_32x32x32_bf16 v[60:75], v[184:187], v[52:59], v2
    v_exp_f32 v16, v16
    v_exp_f32 v17, v17
    v_exp_f32 v18, v18
    s_waitcnt vmcnt(4)
    v_mfma_f32_32x32x8_bf16 v[44:59], v[124:125], v[202:203], 0
    v_exp_f32 v19, v19
    v_exp_f32 v20, v20
    v_exp_f32 v21, v21
    v_exp_f32 v22, v22
    v_smfmac_f32_16x16x64_bf16 v[208:211], v[224:227], v[236:243], v8
    v_exp_f32 v23, v23
    s_add_u32 s46, s24, 229376
    buffer_load_dwordx4 v[236:239], v3, s[8:11], s46 offen offset:0
    v_smfmac_f32_32x32x32_bf16 v[60:75], v[188:191], v[12:19], v2
    v_exp_f32 v24, v24
    v_exp_f32 v25, v25
    v_exp_f32 v26, v26
    v_exp_f32 v27, v27
    s_setprio 2
    buffer_load_dwordx4 v[240:243], v3, s[8:11], s46 offen offset:1024
    v_mfma_f32_32x32x16_bf16 v[44:59], v[96:99], v[196:199], v[44:59]
    v_exp_f32 v28, v28
    v_exp_f32 v29, v29
    v_exp_f32 v30, v30
    v_exp_f32 v31, v31
    v_smfmac_f32_32x32x32_bf16 v[60:75], v[192:195], v[20:27], v2
    v_exp_f32 v32, v32
    v_exp_f32 v33, v33
    v_exp_f32 v34, v34
    s_cmp_lg_u32 s45, 0
    s_cbranch_scc1 P4_NP040
    s_add_u32 m0, s6, 65536
    s_add_u32 s27, s25, 57344
    buffer_load_dwordx4 v3, s[8:11], s27 offen lds
P4_NP040:
    v_mfma_f32_32x32x8_bf16 v[12:27], v[126:127], v[200:201], 0
    v_exp_f32 v35, v35
    v_exp_f32 v36, v36
    v_exp_f32 v37, v37
    v_exp_f32 v38, v38
    v_exp_f32 v39, v39
    v_smfmac_f32_32x32x32_bf16 v[76:91], v[132:135], v[28:35], v2
    v_exp_f32 v40, v40
    v_exp_f32 v41, v41
    v_exp_f32 v42, v42
    v_exp_f32 v43, v43
    s_setprio 1
    ds_write_b128 v4, v[60:63] offset:32768
    v_mfma_f32_32x32x16_bf16 v[12:27], v[100:103], v[196:199], v[12:27]
    v_exp_f32 v44, v44
    v_exp_f32 v45, v45
    v_exp_f32 v46, v46
    v_exp_f32 v47, v47
    v_smfmac_f32_32x32x32_bf16 v[76:91], v[136:139], v[36:43], v2
    v_exp_f32 v48, v48
    v_exp_f32 v49, v49
    v_exp_f32 v50, v50
    ds_write_b128 v4, v[64:67] offset:32800
    s_waitcnt vmcnt(4)
    v_mfma_f32_32x32x8_bf16 v[28:43], v[126:127], v[202:203], 0
    v_exp_f32 v51, v51
    v_exp_f32 v52, v52
    v_exp_f32 v53, v53
    v_exp_f32 v54, v54
    v_smfmac_f32_16x16x64_bf16 v[212:215], v[224:227], v[244:251], v8
    v_exp_f32 v55, v55
    ds_write_b128 v4, v[68:71] offset:32832
    s_mov_b64 exec, 1
    ds_write_b32 v6, v2 offset:25984
    s_mov_b64 exec, -1
    s_add_u32 s46, s24, 294912
    buffer_load_dwordx4 v[244:247], v3, s[8:11], s46 offen offset:0
    v_smfmac_f32_32x32x32_bf16 v[76:91], v[140:143], v[44:51], v2
    v_exp_f32 v56, v56
    v_exp_f32 v57, v57
    v_exp_f32 v58, v58
    v_exp_f32 v59, v59
    s_setprio 0
    buffer_load_dwordx4 v[248:251], v3, s[8:11], s46 offen offset:1024
    v_mfma_f32_32x32x16_bf16 v[28:43], v[104:107], v[196:199], v[28:43]
    v_exp_f32 v12, v12
    v_exp_f32 v13, v13
    v_exp_f32 v14, v14
    v_exp_f32 v15, v15
    v_smfmac_f32_32x32x32_bf16 v[76:91], v[144:147], v[52:59], v2
    v_exp_f32 v16, v16
    v_exp_f32 v17, v17
    v_exp_f32 v18, v18
    s_waitcnt vmcnt(4)
    v_mfma_f32_32x32x8_bf16 v[44:59], v[128:129], v[200:201], 0
    v_exp_f32 v19, v19
    v_exp_f32 v20, v20
    v_exp_f32 v21, v21
    v_exp_f32 v22, v22
    v_smfmac_f32_16x16x64_bf16 v[216:219], v[224:227], v[228:235], v8
    v_exp_f32 v23, v23
    s_add_u32 s46, s24, 296960
    buffer_load_dwordx4 v[228:231], v3, s[8:11], s46 offen offset:0
    v_smfmac_f32_32x32x32_bf16 v[76:91], v[148:151], v[12:19], v2
    v_exp_f32 v24, v24
    v_exp_f32 v25, v25
    v_exp_f32 v26, v26
    v_exp_f32 v27, v27
    s_setprio 3
    buffer_load_dwordx4 v[232:235], v3, s[8:11], s46 offen offset:1024
    v_mfma_f32_32x32x16_bf16 v[44:59], v[108:111], v[196:199], v[44:59]
    v_exp_f32 v28, v28
    v_exp_f32 v29, v29
    v_exp_f32 v30, v30
    v_exp_f32 v31, v31
    ds_read_b32 v10, v0 offset:25984
    ds_read2st64_b32 v[68:69], v253 offset0:128 offset1:142
    ds_read2st64_b32 v[60:61], v5 offset0:128 offset1:142
    ds_read2st64_b32 v[62:63], v5 offset0:156 offset1:170
    ds_read2st64_b32 v[64:65], v5 offset0:184 offset1:198
    ds_read2st64_b32 v[66:67], v5 offset0:212 offset1:226
    v_smfmac_f32_32x32x32_bf16 v[76:91], v[152:155], v[20:27], v2
    v_exp_f32 v32, v32
    v_exp_f32 v33, v33
    v_exp_f32 v34, v34
    s_cmp_lg_u32 s45, 0
    s_cbranch_scc1 P4_NP043
    s_add_u32 m0, s6, 73728
    s_add_u32 s27, s25, 64512
    buffer_load_dwordx4 v3, s[8:11], s27 offen lds
P4_NP043:
    v_mfma_f32_32x32x8_bf16 v[12:27], v[128:129], v[202:203], 0
    v_exp_f32 v35, v35
    v_exp_f32 v36, v36
    v_exp_f32 v37, v37
    v_exp_f32 v38, v38
    v_exp_f32 v39, v39
    v_smfmac_f32_32x32x32_bf16 v[76:91], v[156:159], v[28:35], v2
    v_exp_f32 v40, v40
    v_exp_f32 v41, v41
    v_exp_f32 v42, v42
    v_exp_f32 v43, v43
    s_setprio 2
    s_waitcnt lgkmcnt(0)
    v_cmp_eq_u32 vcc, 0, v10
    s_cbranch_vccnz P4_RT8
P4_BK8:
    v_mfma_f32_32x32x16_bf16 v[12:27], v[112:115], v[196:199], v[12:27]
    v_exp_f32 v44, v44
    v_add_f32 v68, v68, v69
    v_add_f32 v60, v60, v61
    v_add_f32 v62, v62, v63
    v_exp_f32 v45, v45
    v_add_f32_dpp v68, v68, v68 quad_perm:[1,0,3,2] row_mask:0xf bank_mask:0xf
    v_add_f32 v64, v64, v65
    v_add_f32 v66, v66, v67
    v_exp_f32 v46, v46
    v_exp_f32 v47, v47
    v_smfmac_f32_32x32x32_bf16 v[76:91], v[160:163], v[36:43], v2
    v_add_f32_dpp v68, v68, v68 quad_perm:[2,3,0,1] row_mask:0xf bank_mask:0xf
    v_add_f32 v60, v60, v62
    v_add_f32 v64, v64, v66
    v_exp_f32 v48, v48
    v_add_f32 v60, v60, v64
    v_exp_f32 v49, v49
    v_exp_f32 v50, v50
    s_waitcnt vmcnt(4)
    v_mfma_f32_32x32x8_bf16 v[28:43], v[130:131], v[200:201], 0
    v_rcp_f32 v62, v68
    v_exp_f32 v51, v51
    v_exp_f32 v52, v52
    v_mul_f32_dpp v60, v62, v60 row_newbcast:8 row_mask:0xf bank_mask:0xf
    v_mul_f32_dpp v68, v62, v68 row_newbcast:8 row_mask:0xf bank_mask:0xf
    v_cvt_pk_bf16_f32 v60, v60, v68
    v_exp_f32 v53, v53
    v_exp_f32 v54, v54
    v_smfmac_f32_16x16x64_bf16 v[220:223], v[224:227], v[236:243], v8
    v_exp_f32 v55, v55
    ds_write_b16 v7, v60 offset:20480
    s_mov_b64 exec, s[30:31]
    ds_write_b16_d16_hi v7, v60 offset:25086
    s_mov_b64 exec, 1
    ds_write_b32 v6, v2 offset:26240
    s_mov_b64 exec, -1
    s_add_u32 s46, s24, 299008
    buffer_load_dwordx4 v[236:239], v3, s[8:11], s46 offen offset:0
    v_smfmac_f32_32x32x32_bf16 v[76:91], v[164:167], v[44:51], v2
    v_exp_f32 v56, v56
    v_exp_f32 v57, v57
    v_exp_f32 v58, v58
    v_exp_f32 v59, v59
    s_setprio 1
    buffer_load_dwordx4 v[240:243], v3, s[8:11], s46 offen offset:1024
    v_mfma_f32_32x32x16_bf16 v[28:43], v[116:119], v[196:199], v[28:43]
    v_exp_f32 v12, v12
    v_exp_f32 v13, v13
    v_exp_f32 v14, v14
    v_exp_f32 v15, v15
    v_smfmac_f32_32x32x32_bf16 v[76:91], v[168:171], v[52:59], v2
    v_exp_f32 v16, v16
    v_exp_f32 v17, v17
    v_exp_f32 v18, v18
    ds_read_b128 v[60:63], v252
    ds_read_b128 v[64:67], v252
    ds_read_b128 v[68:71], v252
    v_mfma_f32_32x32x8_bf16 v[44:59], v[130:131], v[202:203], 0
    v_exp_f32 v19, v19
    v_exp_f32 v20, v20
    v_exp_f32 v21, v21
    v_exp_f32 v22, v22
    v_exp_f32 v23, v23
    ds_read_b128 v[200:203], v9 offset:13312
    v_smfmac_f32_32x32x32_bf16 v[76:91], v[172:175], v[12:19], v2
    v_exp_f32 v24, v24
    v_exp_f32 v25, v25
    v_exp_f32 v26, v26
    v_exp_f32 v27, v27
    s_setprio 0
    ds_read_b32 v10, v0 offset:26240
    ds_read_b128 v[224:227], v9 offset:20480
    v_mfma_f32_32x32x16_bf16 v[44:59], v[120:123], v[196:199], v[44:59]
    v_exp_f32 v28, v28
    v_exp_f32 v29, v29
    v_exp_f32 v30, v30
    v_exp_f32 v31, v31
    ds_read_b128 v[196:199], v9 offset:12288
    v_smfmac_f32_32x32x32_bf16 v[76:91], v[176:179], v[20:27], v2
    v_exp_f32 v32, v32
    v_exp_f32 v33, v33
    v_exp_f32 v34, v34
    s_waitcnt lgkmcnt(1)
    v_cmp_eq_u32 vcc, 0, v10
    s_cbranch_vccnz P4_RT9
P4_BK9:
    s_waitcnt vmcnt(4)
    s_cmp_lg_u32 s45, 0
    s_cbranch_scc1 P4_NP046
    s_add_u32 m0, s6, 81920
    s_add_u32 s27, s25, 71680
    buffer_load_dwordx4 v3, s[8:11], s27 offen lds
P4_NP046:
    v_mfma_f32_32x32x8_bf16 v[12:27], v[124:125], v[200:201], 0
    v_exp_f32 v35, v35
    v_exp_f32 v36, v36
    v_exp_f32 v37, v37
    v_exp_f32 v38, v38
    v_smfmac_f32_16x16x64_bf16 v[204:207], v[224:227], v[244:251], v8
    v_exp_f32 v39, v39
    s_add_u32 s46, s24, 301056
    buffer_load_dwordx4 v[244:247], v3, s[8:11], s46 offen offset:0
    v_smfmac_f32_32x32x32_bf16 v[76:91], v[180:183], v[28:35], v2
    v_exp_f32 v40, v40
    v_exp_f32 v41, v41
    v_exp_f32 v42, v42
    v_exp_f32 v43, v43
    s_setprio 3
    s_waitcnt lgkmcnt(0)
    buffer_load_dwordx4 v[248:251], v3, s[8:11], s46 offen offset:1024
    v_mfma_f32_32x32x16_bf16 v[12:27], v[92:95], v[196:199], v[12:27]
    v_exp_f32 v44, v44
    v_exp_f32 v45, v45
    v_exp_f32 v46, v46
    v_exp_f32 v47, v47
    v_smfmac_f32_32x32x32_bf16 v[76:91], v[184:187], v[36:43], v2
    v_exp_f32 v48, v48
    v_exp_f32 v49, v49
    v_exp_f32 v50, v50
    s_waitcnt vmcnt(4)
    v_mfma_f32_32x32x8_bf16 v[28:43], v[124:125], v[202:203], 0
    v_exp_f32 v51, v51
    v_exp_f32 v52, v52
    v_exp_f32 v53, v53
    v_exp_f32 v54, v54
    v_smfmac_f32_16x16x64_bf16 v[208:211], v[224:227], v[228:235], v8
    v_exp_f32 v55, v55
    s_add_u32 s46, s24, 303104
    buffer_load_dwordx4 v[228:231], v3, s[8:11], s46 offen offset:0
    v_smfmac_f32_32x32x32_bf16 v[76:91], v[188:191], v[44:51], v2
    v_exp_f32 v56, v56
    v_exp_f32 v57, v57
    v_exp_f32 v58, v58
    v_exp_f32 v59, v59
    s_setprio 2
    buffer_load_dwordx4 v[232:235], v3, s[8:11], s46 offen offset:1024
    v_mfma_f32_32x32x16_bf16 v[28:43], v[96:99], v[196:199], v[28:43]
    v_exp_f32 v12, v12
    v_exp_f32 v13, v13
    v_exp_f32 v14, v14
    v_exp_f32 v15, v15
    v_smfmac_f32_32x32x32_bf16 v[76:91], v[192:195], v[52:59], v2
    v_exp_f32 v16, v16
    v_exp_f32 v17, v17
    v_exp_f32 v18, v18
    v_mfma_f32_32x32x8_bf16 v[44:59], v[126:127], v[200:201], 0
    v_exp_f32 v19, v19
    v_exp_f32 v20, v20
    v_exp_f32 v21, v21
    v_exp_f32 v22, v22
    v_exp_f32 v23, v23
    v_smfmac_f32_32x32x32_bf16 v[60:75], v[132:135], v[12:19], v2
    v_exp_f32 v24, v24
    v_exp_f32 v25, v25
    v_exp_f32 v26, v26
    v_exp_f32 v27, v27
    s_setprio 1
    ds_write_b128 v4, v[76:79] offset:32768
    v_mfma_f32_32x32x16_bf16 v[44:59], v[100:103], v[196:199], v[44:59]
    v_exp_f32 v28, v28
    v_exp_f32 v29, v29
    v_exp_f32 v30, v30
    v_exp_f32 v31, v31
    v_smfmac_f32_32x32x32_bf16 v[60:75], v[136:139], v[20:27], v2
    v_exp_f32 v32, v32
    v_exp_f32 v33, v33
    v_exp_f32 v34, v34
    ds_write_b128 v4, v[80:83] offset:32800
    s_waitcnt vmcnt(4)
    s_cmp_lg_u32 s45, 0
    s_cbranch_scc1 P4_NP049
    s_add_u32 m0, s6, 90112
    s_add_u32 s27, s25, 78848
    buffer_load_dwordx4 v3, s[8:11], s27 offen lds
P4_NP049:
    v_mfma_f32_32x32x8_bf16 v[12:27], v[126:127], v[202:203], 0
    v_exp_f32 v35, v35
    v_exp_f32 v36, v36
    v_exp_f32 v37, v37
    v_exp_f32 v38, v38
    v_smfmac_f32_16x16x64_bf16 v[212:215], v[224:227], v[236:243], v8
    v_exp_f32 v39, v39
    ds_write_b128 v4, v[84:87] offset:32832
    s_mov_b64 exec, 1
    ds_write_b32 v6, v2 offset:26016
    s_mov_b64 exec, -1
    s_add_u32 s46, s24, 368640
    buffer_load_dwordx4 v[236:239], v3, s[8:11], s46 offen offset:0
    v_smfmac_f32_32x32x32_bf16 v[60:75], v[140:143], v[28:35], v2
    v_exp_f32 v40, v40
    v_exp_f32 v41, v41
    v_exp_f32 v42, v42
    v_exp_f32 v43, v43
    s_setprio 0
    buffer_load_dwordx4 v[240:243], v3, s[8:11], s46 offen offset:1024
    v_mfma_f32_32x32x16_bf16 v[12:27], v[104:107], v[196:199], v[12:27]
    v_exp_f32 v44, v44
    v_exp_f32 v45, v45
    v_exp_f32 v46, v46
    v_exp_f32 v47, v47
    v_smfmac_f32_32x32x32_bf16 v[60:75], v[144:147], v[36:43], v2
    v_exp_f32 v48, v48
    v_exp_f32 v49, v49
    v_exp_f32 v50, v50
    s_waitcnt vmcnt(4)
    v_mfma_f32_32x32x8_bf16 v[28:43], v[128:129], v[200:201], 0
    v_exp_f32 v51, v51
    v_exp_f32 v52, v52
    v_exp_f32 v53, v53
    v_exp_f32 v54, v54
    v_smfmac_f32_16x16x64_bf16 v[216:219], v[224:227], v[244:251], v8
    v_exp_f32 v55, v55
    s_add_u32 s46, s24, 370688
    buffer_load_dwordx4 v[244:247], v3, s[8:11], s46 offen offset:0
    v_smfmac_f32_32x32x32_bf16 v[60:75], v[148:151], v[44:51], v2
    v_exp_f32 v56, v56
    v_exp_f32 v57, v57
    v_exp_f32 v58, v58
    v_exp_f32 v59, v59
    s_setprio 3
    buffer_load_dwordx4 v[248:251], v3, s[8:11], s46 offen offset:1024
    v_mfma_f32_32x32x16_bf16 v[28:43], v[108:111], v[196:199], v[28:43]
    v_exp_f32 v12, v12
    v_exp_f32 v13, v13
    v_exp_f32 v14, v14
    v_exp_f32 v15, v15
    ds_read_b32 v10, v0 offset:26016
    ds_read2st64_b32 v[84:85], v253 offset0:128 offset1:142
    ds_read2st64_b32 v[76:77], v5 offset0:128 offset1:142
    ds_read2st64_b32 v[78:79], v5 offset0:156 offset1:170
    ds_read2st64_b32 v[80:81], v5 offset0:184 offset1:198
    ds_read2st64_b32 v[82:83], v5 offset0:212 offset1:226
    v_smfmac_f32_32x32x32_bf16 v[60:75], v[152:155], v[52:59], v2
    v_exp_f32 v16, v16
    v_exp_f32 v17, v17
    v_exp_f32 v18, v18
    v_mfma_f32_32x32x8_bf16 v[44:59], v[128:129], v[202:203], 0
    v_exp_f32 v19, v19
    v_exp_f32 v20, v20
    v_exp_f32 v21, v21
    v_exp_f32 v22, v22
    v_exp_f32 v23, v23
    v_smfmac_f32_32x32x32_bf16 v[60:75], v[156:159], v[12:19], v2
    v_exp_f32 v24, v24
    v_exp_f32 v25, v25
    v_exp_f32 v26, v26
    v_exp_f32 v27, v27
    s_setprio 2
    s_waitcnt lgkmcnt(0)
    v_cmp_eq_u32 vcc, 0, v10
    s_cbranch_vccnz P4_RT10
P4_BK10:
    v_mfma_f32_32x32x16_bf16 v[44:59], v[112:115], v[196:199], v[44:59]
    v_exp_f32 v28, v28
    v_add_f32 v84, v84, v85
    v_add_f32 v76, v76, v77
    v_add_f32 v78, v78, v79
    v_exp_f32 v29, v29
    v_add_f32_dpp v84, v84, v84 quad_perm:[1,0,3,2] row_mask:0xf bank_mask:0xf
    v_add_f32 v80, v80, v81
    v_add_f32 v82, v82, v83
    v_exp_f32 v30, v30
    v_exp_f32 v31, v31
    v_smfmac_f32_32x32x32_bf16 v[60:75], v[160:163], v[20:27], v2
    v_add_f32_dpp v84, v84, v84 quad_perm:[2,3,0,1] row_mask:0xf bank_mask:0xf
    v_add_f32 v76, v76, v78
    v_add_f32 v80, v80, v82
    v_exp_f32 v32, v32
    v_add_f32 v76, v76, v80
    v_exp_f32 v33, v33
    v_exp_f32 v34, v34
    s_waitcnt vmcnt(4)
    v_mfma_f32_32x32x8_bf16 v[12:27], v[130:131], v[200:201], 0
    v_rcp_f32 v78, v84
    v_exp_f32 v35, v35
    v_exp_f32 v36, v36
    v_mul_f32_dpp v76, v78, v76 row_newbcast:8 row_mask:0xf bank_mask:0xf
    v_mul_f32_dpp v84, v78, v84 row_newbcast:8 row_mask:0xf bank_mask:0xf
    v_cvt_pk_bf16_f32 v76, v76, v84
    v_exp_f32 v37, v37
    v_exp_f32 v38, v38
    v_smfmac_f32_16x16x64_bf16 v[220:223], v[224:227], v[228:235], v8
    v_exp_f32 v39, v39
    ds_write_b16 v7, v76 offset:21504
    s_mov_b64 exec, s[30:31]
    ds_write_b16_d16_hi v7, v76 offset:25214
    s_mov_b64 exec, 1
    ds_write_b32 v6, v2 offset:26272
    s_mov_b64 exec, -1
    s_add_u32 s46, s24, 372736
    buffer_load_dwordx4 v[228:231], v3, s[8:11], s46 offen offset:0
    v_smfmac_f32_32x32x32_bf16 v[60:75], v[164:167], v[28:35], v2
    v_exp_f32 v40, v40
    v_exp_f32 v41, v41
    v_exp_f32 v42, v42
    v_exp_f32 v43, v43
    s_setprio 1
    buffer_load_dwordx4 v[232:235], v3, s[8:11], s46 offen offset:1024
    v_mfma_f32_32x32x16_bf16 v[12:27], v[116:119], v[196:199], v[12:27]
    v_exp_f32 v44, v44
    v_exp_f32 v45, v45
    v_exp_f32 v46, v46
    v_exp_f32 v47, v47
    v_smfmac_f32_32x32x32_bf16 v[60:75], v[168:171], v[36:43], v2
    v_exp_f32 v48, v48
    v_exp_f32 v49, v49
    v_exp_f32 v50, v50
    ds_read_b128 v[76:79], v252
    ds_read_b128 v[80:83], v252
    ds_read_b128 v[84:87], v252
    v_mfma_f32_32x32x8_bf16 v[28:43], v[130:131], v[202:203], 0
    v_exp_f32 v51, v51
    v_exp_f32 v52, v52
    v_exp_f32 v53, v53
    v_exp_f32 v54, v54
    v_exp_f32 v55, v55
    ds_read_b128 v[200:203], v9 offset:15360
    v_smfmac_f32_32x32x32_bf16 v[60:75], v[172:175], v[44:51], v2
    v_exp_f32 v56, v56
    v_exp_f32 v57, v57
    v_exp_f32 v58, v58
    v_exp_f32 v59, v59
    s_setprio 0
    ds_read_b32 v10, v0 offset:26272
    ds_read_b128 v[224:227], v9 offset:21504
    v_mfma_f32_32x32x16_bf16 v[28:43], v[120:123], v[196:199], v[28:43]
    v_exp_f32 v12, v12
    v_exp_f32 v13, v13
    v_exp_f32 v14, v14
    v_exp_f32 v15, v15
    ds_read_b128 v[196:199], v9 offset:14336
    v_smfmac_f32_32x32x32_bf16 v[60:75], v[176:179], v[52:59], v2
    v_exp_f32 v16, v16
    v_exp_f32 v17, v17
    v_exp_f32 v18, v18
    s_waitcnt lgkmcnt(1)
    v_cmp_eq_u32 vcc, 0, v10
    s_cbranch_vccnz P4_RT11
P4_BK11:
    s_waitcnt vmcnt(4)
    v_mfma_f32_32x32x8_bf16 v[44:59], v[124:125], v[200:201], 0
    v_exp_f32 v19, v19
    v_exp_f32 v20, v20
    v_exp_f32 v21, v21
    v_exp_f32 v22, v22
    v_smfmac_f32_16x16x64_bf16 v[204:207], v[224:227], v[236:243], v8
    v_exp_f32 v23, v23
    s_add_u32 s46, s24, 374784
    buffer_load_dwordx4 v[236:239], v3, s[8:11], s46 offen offset:0
    buffer_load_dwordx4 v[240:243], v3, s[8:11], s46 offen offset:1024
    v_smfmac_f32_32x32x32_bf16 v[60:75], v[180:183], v[12:19], v2
    v_exp_f32 v24, v24
    v_exp_f32 v25, v25
    v_exp_f32 v26, v26
    v_exp_f32 v27, v27
    s_setprio 3
    s_waitcnt lgkmcnt(0)
    v_mfma_f32_32x32x16_bf16 v[44:59], v[92:95], v[196:199], v[44:59]
    v_exp_f32 v28, v28
    v_exp_f32 v29, v29
    v_exp_f32 v30, v30
    v_exp_f32 v31, v31
    v_smfmac_f32_32x32x32_bf16 v[60:75], v[184:187], v[20:27], v2
    v_exp_f32 v32, v32
    v_exp_f32 v33, v33
    v_exp_f32 v34, v34
    s_waitcnt vmcnt(4)
    v_mfma_f32_32x32x8_bf16 v[12:27], v[124:125], v[202:203], 0
    v_exp_f32 v35, v35
    v_exp_f32 v36, v36
    v_exp_f32 v37, v37
    v_exp_f32 v38, v38
    v_smfmac_f32_16x16x64_bf16 v[208:211], v[224:227], v[244:251], v8
    v_exp_f32 v39, v39
    s_add_u32 s46, s24, 376832
    buffer_load_dwordx4 v[244:247], v3, s[8:11], s46 offen offset:0
    buffer_load_dwordx4 v[248:251], v3, s[8:11], s46 offen offset:1024
    v_smfmac_f32_32x32x32_bf16 v[60:75], v[188:191], v[28:35], v2
    v_exp_f32 v40, v40
    v_exp_f32 v41, v41
    v_exp_f32 v42, v42
    v_exp_f32 v43, v43
    s_setprio 2
    v_mfma_f32_32x32x16_bf16 v[12:27], v[96:99], v[196:199], v[12:27]
    v_exp_f32 v44, v44
    v_exp_f32 v45, v45
    v_exp_f32 v46, v46
    v_exp_f32 v47, v47
    s_add_u32 s46, s24, 442368
    buffer_load_dwordx4 v[92:95], v3, s[8:11], s46 offen offset:0
    buffer_load_dwordx4 v[96:99], v3, s[8:11], s46 offen offset:1024
    v_smfmac_f32_32x32x32_bf16 v[60:75], v[192:195], v[36:43], v2
    v_exp_f32 v48, v48
    v_exp_f32 v49, v49
    v_exp_f32 v50, v50
    s_waitcnt vmcnt(6)
    v_mfma_f32_32x32x8_bf16 v[28:43], v[126:127], v[200:201], 0
    v_exp_f32 v51, v51
    v_exp_f32 v52, v52
    v_exp_f32 v53, v53
    v_exp_f32 v54, v54
    v_smfmac_f32_16x16x64_bf16 v[212:215], v[224:227], v[228:235], v8
    v_exp_f32 v55, v55
    s_add_u32 s46, s24, 444416
    buffer_load_dwordx4 v[228:231], v3, s[8:11], s46 offen offset:0
    buffer_load_dwordx4 v[232:235], v3, s[8:11], s46 offen offset:1024
    v_smfmac_f32_32x32x32_bf16 v[76:91], v[132:135], v[44:51], v2
    v_exp_f32 v56, v56
    v_exp_f32 v57, v57
    v_exp_f32 v58, v58
    v_exp_f32 v59, v59
    s_setprio 1
    ds_write_b128 v4, v[60:63] offset:32768
    v_mfma_f32_32x32x16_bf16 v[28:43], v[100:103], v[196:199], v[28:43]
    v_exp_f32 v12, v12
    v_exp_f32 v13, v13
    v_exp_f32 v14, v14
    v_exp_f32 v15, v15
    v_smfmac_f32_32x32x32_bf16 v[76:91], v[136:139], v[52:59], v2
    v_exp_f32 v16, v16
    v_exp_f32 v17, v17
    v_exp_f32 v18, v18
    ds_write_b128 v4, v[64:67] offset:32800
    s_waitcnt vmcnt(6)
    v_mfma_f32_32x32x8_bf16 v[44:59], v[126:127], v[202:203], 0
    v_exp_f32 v19, v19
    v_exp_f32 v20, v20
    v_exp_f32 v21, v21
    v_exp_f32 v22, v22
    v_smfmac_f32_16x16x64_bf16 v[216:219], v[224:227], v[236:243], v8
    v_exp_f32 v23, v23
    ds_write_b128 v4, v[68:71] offset:32832
    s_mov_b64 exec, 1
    ds_write_b32 v6, v2 offset:26048
    s_mov_b64 exec, -1
    s_add_u32 s46, s24, 446464
    buffer_load_dwordx4 v[236:239], v3, s[8:11], s46 offen offset:0
    buffer_load_dwordx4 v[240:243], v3, s[8:11], s46 offen offset:1024
    v_smfmac_f32_32x32x32_bf16 v[76:91], v[140:143], v[12:19], v2
    v_exp_f32 v24, v24
    v_exp_f32 v25, v25
    v_exp_f32 v26, v26
    v_exp_f32 v27, v27
    s_setprio 0
    v_mfma_f32_32x32x16_bf16 v[44:59], v[104:107], v[196:199], v[44:59]
    v_exp_f32 v28, v28
    v_exp_f32 v29, v29
    v_exp_f32 v30, v30
    v_exp_f32 v31, v31
    s_add_u32 s46, s24, 448512
    buffer_load_dwordx4 v[100:103], v3, s[8:11], s46 offen offset:0
    buffer_load_dwordx4 v[104:107], v3, s[8:11], s46 offen offset:1024
    v_smfmac_f32_32x32x32_bf16 v[76:91], v[144:147], v[20:27], v2
    v_exp_f32 v32, v32
    v_exp_f32 v33, v33
    v_exp_f32 v34, v34
    s_waitcnt vmcnt(8)
    v_mfma_f32_32x32x8_bf16 v[12:27], v[128:129], v[200:201], 0
    v_exp_f32 v35, v35
    v_exp_f32 v36, v36
    v_exp_f32 v37, v37
    v_exp_f32 v38, v38
    v_smfmac_f32_16x16x64_bf16 v[220:223], v[224:227], v[244:251], v8
    v_exp_f32 v39, v39
    s_add_u32 s46, s24, 450560
    buffer_load_dwordx4 v[244:247], v3, s[8:11], s46 offen offset:0
    buffer_load_dwordx4 v[248:251], v3, s[8:11], s46 offen offset:1024
    v_smfmac_f32_32x32x32_bf16 v[76:91], v[148:151], v[28:35], v2
    v_exp_f32 v40, v40
    v_exp_f32 v41, v41
    v_exp_f32 v42, v42
    v_exp_f32 v43, v43
    s_setprio 3
    v_mfma_f32_32x32x16_bf16 v[12:27], v[108:111], v[196:199], v[12:27]
    v_exp_f32 v44, v44
    v_exp_f32 v45, v45
    v_exp_f32 v46, v46
    v_exp_f32 v47, v47
    ds_read_b32 v10, v0 offset:26048
    ds_read2st64_b32 v[68:69], v253 offset0:128 offset1:142
    ds_read2st64_b32 v[60:61], v5 offset0:128 offset1:142
    ds_read2st64_b32 v[62:63], v5 offset0:156 offset1:170
    ds_read2st64_b32 v[64:65], v5 offset0:184 offset1:198
    ds_read2st64_b32 v[66:67], v5 offset0:212 offset1:226
    s_add_u32 s46, s24, 516096
    buffer_load_dwordx4 v[140:143], v3, s[8:11], s46 offen offset:0
    buffer_load_dwordx4 v[144:147], v3, s[8:11], s46 offen offset:1024
    v_smfmac_f32_32x32x32_bf16 v[76:91], v[152:155], v[36:43], v2
    v_exp_f32 v48, v48
    v_exp_f32 v49, v49
    v_exp_f32 v50, v50
    v_mfma_f32_32x32x8_bf16 v[28:43], v[128:129], v[202:203], 0
    v_exp_f32 v51, v51
    v_exp_f32 v52, v52
    v_exp_f32 v53, v53
    v_exp_f32 v54, v54
    v_exp_f32 v55, v55
    v_smfmac_f32_32x32x32_bf16 v[76:91], v[156:159], v[44:51], v2
    v_exp_f32 v56, v56
    v_exp_f32 v57, v57
    v_exp_f32 v58, v58
    v_exp_f32 v59, v59
    s_setprio 2
    s_waitcnt lgkmcnt(0)
    v_cmp_eq_u32 vcc, 0, v10
    s_cbranch_vccnz P4_RT12
P4_BK12:
    v_mfma_f32_32x32x16_bf16 v[28:43], v[112:115], v[196:199], v[28:43]
    v_exp_f32 v12, v12
    v_add_f32 v68, v68, v69
    v_add_f32 v60, v60, v61
    v_add_f32 v62, v62, v63
    v_exp_f32 v13, v13
    v_add_f32_dpp v68, v68, v68 quad_perm:[1,0,3,2] row_mask:0xf bank_mask:0xf
    v_add_f32 v64, v64, v65
    v_add_f32 v66, v66, v67
    v_exp_f32 v14, v14
    v_exp_f32 v15, v15
    s_add_u32 s46, s24, 518144
    buffer_load_dwordx4 v[108:111], v3, s[8:11], s46 offen offset:0
    buffer_load_dwordx4 v[112:115], v3, s[8:11], s46 offen offset:1024
    v_smfmac_f32_32x32x32_bf16 v[76:91], v[160:163], v[52:59], v2
    v_add_f32_dpp v68, v68, v68 quad_perm:[2,3,0,1] row_mask:0xf bank_mask:0xf
    v_add_f32 v60, v60, v62
    v_add_f32 v64, v64, v66
    v_exp_f32 v16, v16
    v_add_f32 v60, v60, v64
    v_exp_f32 v17, v17
    v_exp_f32 v18, v18
    v_mfma_f32_32x32x8_bf16 v[44:59], v[130:131], v[200:201], 0
    v_rcp_f32 v62, v68
    v_exp_f32 v19, v19
    v_exp_f32 v20, v20
    v_mul_f32_dpp v60, v62, v60 row_newbcast:8 row_mask:0xf bank_mask:0xf
    v_mul_f32_dpp v68, v62, v68 row_newbcast:8 row_mask:0xf bank_mask:0xf
    v_cvt_pk_bf16_f32 v60, v60, v68
    v_exp_f32 v21, v21
    v_exp_f32 v22, v22
    v_exp_f32 v23, v23
    ds_write_b16 v7, v60 offset:22528
    s_mov_b64 exec, s[30:31]
    ds_write_b16_d16_hi v7, v60 offset:25090
    s_mov_b64 exec, 1
    ds_write_b32 v6, v2 offset:26304
    s_mov_b64 exec, -1
    s_add_u32 s46, s24, 520192
    buffer_load_dwordx4 v[148:151], v3, s[8:11], s46 offen offset:0
    buffer_load_dwordx4 v[152:155], v3, s[8:11], s46 offen offset:1024
    v_smfmac_f32_32x32x32_bf16 v[76:91], v[164:167], v[12:19], v2
    v_exp_f32 v24, v24
    v_exp_f32 v25, v25
    v_exp_f32 v26, v26
    v_exp_f32 v27, v27
    s_setprio 1
    v_mfma_f32_32x32x16_bf16 v[44:59], v[116:119], v[196:199], v[44:59]
    v_exp_f32 v28, v28
    v_exp_f32 v29, v29
    v_exp_f32 v30, v30
    v_exp_f32 v31, v31
    s_add_u32 s46, s24, 522240
    buffer_load_dwordx4 v[156:159], v3, s[8:11], s46 offen offset:0
    buffer_load_dwordx4 v[160:163], v3, s[8:11], s46 offen offset:1024
    v_smfmac_f32_32x32x32_bf16 v[76:91], v[168:171], v[20:27], v2
    v_exp_f32 v32, v32
    v_exp_f32 v33, v33
    v_exp_f32 v34, v34
    v_mfma_f32_32x32x8_bf16 v[12:27], v[130:131], v[202:203], 0
    v_exp_f32 v35, v35
    v_exp_f32 v36, v36
    v_exp_f32 v37, v37
    v_exp_f32 v38, v38
    v_exp_f32 v39, v39
    v_smfmac_f32_32x32x32_bf16 v[76:91], v[172:175], v[28:35], v2
    v_exp_f32 v40, v40
    v_exp_f32 v41, v41
    v_and_b32 v254, 7, v1
    v_lshlrev_b32 v254, 4, v254
    v_bfe_u32 v255, v1, 3, 1
    v_lshl_add_u32 v254, v255, 9, v254
    v_lshrrev_b32 v255, 5, v1
    v_lshl_add_u32 v254, v255, 8, v254
    v_bfe_u32 v255, v1, 4, 1
    v_lshl_add_u32 v11, v255, 3, v254
    v_lshl_add_u32 v254, v255, 10, v254
    s_lshl_b32 s29, s44, 9
    s_add_u32 s28, s5, s29
    s_mul_i32 s29, s45, 2359296
    s_add_u32 s29, s29, s28
    s_add_u32 s29, s29, 9437184
    buffer_load_dwordx2 v[132:133], v11, s[8:11], s29 offen offset:0 sc1
    buffer_load_dwordx2 v[134:135], v11, s[8:11], s29 offen offset:1024 sc1
    buffer_load_dwordx2 v[136:137], v11, s[8:11], s29 offen offset:2048 sc1
    v_exp_f32 v42, v42
    v_exp_f32 v43, v43
    s_setprio 0
    ds_read_b32 v10, v0 offset:26304
    ds_read_b128 v[224:227], v9 offset:22528
    v_mfma_f32_32x32x16_bf16 v[12:27], v[120:123], v[196:199], v[12:27]
    v_exp_f32 v44, v44
    v_exp_f32 v45, v45
    v_exp_f32 v46, v46
    v_exp_f32 v47, v47
    s_add_u32 s46, s24, 524288
    buffer_load_dwordx4 v[116:119], v3, s[8:11], s46 offen offset:0
    buffer_load_dwordx4 v[120:123], v3, s[8:11], s46 offen offset:1024
    v_smfmac_f32_32x32x32_bf16 v[76:91], v[176:179], v[36:43], v2
    v_exp_f32 v48, v48
    v_exp_f32 v49, v49
    v_exp_f32 v50, v50
    s_waitcnt lgkmcnt(0)
    v_cmp_eq_u32 vcc, 0, v10
    s_cbranch_vccnz P4_RT13
P4_BK13:
    s_waitcnt vmcnt(21)
    v_exp_f32 v51, v51
    v_exp_f32 v52, v52
    v_exp_f32 v53, v53
    v_exp_f32 v54, v54
    v_smfmac_f32_16x16x64_bf16 v[204:207], v[224:227], v[92:99], v8
    v_exp_f32 v55, v55
    s_add_u32 s46, s19, 0
    buffer_load_dwordx4 v[92:95], v3, s[8:11], s46 offen offset:0
    s_add_u32 s46, s19, 36864
    buffer_load_dwordx4 v[96:99], v3, s[8:11], s46 offen offset:0
    s_waitcnt vmcnt(21)
    v_smfmac_f32_32x32x32_bf16 v[76:91], v[180:183], v[44:51], v2
    v_exp_f32 v56, v56
    v_exp_f32 v57, v57
    v_exp_f32 v58, v58
    v_smfmac_f32_16x16x64_bf16 v[208:211], v[224:227], v[228:235], v8
    v_exp_f32 v59, v59
    s_setprio 3
    v_exp_f32 v12, v12
    v_exp_f32 v13, v13
    v_exp_f32 v14, v14
    v_exp_f32 v15, v15
    v_smfmac_f32_32x32x32_bf16 v[76:91], v[184:187], v[52:59], v2
    v_exp_f32 v16, v16
    v_exp_f32 v17, v17
    v_exp_f32 v18, v18
    s_waitcnt vmcnt(19)
    v_exp_f32 v19, v19
    v_exp_f32 v20, v20
    v_exp_f32 v21, v21
    v_exp_f32 v22, v22
    v_smfmac_f32_16x16x64_bf16 v[212:215], v[224:227], v[236:243], v8
    v_exp_f32 v23, v23
    s_waitcnt vmcnt(17)
    v_smfmac_f32_32x32x32_bf16 v[76:91], v[188:191], v[12:19], v2
    v_exp_f32 v24, v24
    v_exp_f32 v25, v25
    v_exp_f32 v26, v26
    v_smfmac_f32_16x16x64_bf16 v[216:219], v[224:227], v[100:107], v8
    v_exp_f32 v27, v27
    s_setprio 2
    s_nop 0
    v_smfmac_f32_32x32x32_bf16 v[76:91], v[192:195], v[20:27], v2
    s_waitcnt vmcnt(15)
    v_smfmac_f32_16x16x64_bf16 v[220:223], v[224:227], v[244:251], v8
    s_nop 9
    ds_write_b128 v4, v[76:79] offset:32768
    ds_write_b128 v4, v[80:83] offset:32800
    ds_write_b128 v4, v[84:87] offset:32832
    s_add_u32 s46, s19, 1024
    buffer_load_dwordx4 v[52:55], v3, s[8:11], s46 offen offset:0
    s_add_u32 s46, s19, 37888
    buffer_load_dwordx4 v[56:59], v3, s[8:11], s46 offen offset:0
    s_add_u32 s46, s19, 2048
    buffer_load_dwordx4 v[44:47], v3, s[8:11], s46 offen offset:0
    s_add_u32 s46, s19, 38912
    buffer_load_dwordx4 v[48:51], v3, s[8:11], s46 offen offset:0
    v_and_b32 v68, 7, v1
    v_bfe_u32 v69, v1, 4, 1
    v_lshlrev_b32 v69, 2, v69
    v_sub_u32 v68, v68, v69
    v_and_b32 v69, 1, v68
    v_lshlrev_b32 v69, 4, v69
    v_mov_b32 v70, 0x3f80
    v_lshlrev_b32 v69, v69, v70
    v_lshrrev_b32 v68, 1, v68
    v_cmp_eq_u32 s[36:37], 0, v68
    v_cmp_eq_u32 s[38:39], 1, v68
    s_waitcnt lgkmcnt(0)
    s_barrier
    ds_read2st64_b32 v[84:85], v253 offset0:128 offset1:142
    ds_read2st64_b32 v[76:77], v5 offset0:128 offset1:142
    ds_read2st64_b32 v[78:79], v5 offset0:156 offset1:170
    ds_read2st64_b32 v[80:81], v5 offset0:184 offset1:198
    ds_read2st64_b32 v[82:83], v5 offset0:212 offset1:226
    s_add_u32 s46, s19, 3072
    buffer_load_dwordx4 v[36:39], v3, s[8:11], s46 offen offset:0
    s_add_u32 s46, s19, 39936
    buffer_load_dwordx4 v[40:43], v3, s[8:11], s46 offen offset:0
    s_add_u32 s46, s19, 4096
    buffer_load_dwordx4 v[28:31], v3, s[8:11], s46 offen offset:0
    s_add_u32 s46, s19, 40960
    buffer_load_dwordx4 v[32:35], v3, s[8:11], s46 offen offset:0
    v_cndmask_b32 v70, 0, v69, s[36:37]
    v_cndmask_b32 v71, 0, v69, s[38:39]
    s_waitcnt lgkmcnt(0)
    v_add_f32 v84, v84, v85
    v_add_f32 v76, v76, v77
    v_add_f32 v78, v78, v79
    v_add_f32_dpp v84, v84, v84 quad_perm:[1,0,3,2] row_mask:0xf bank_mask:0xf
    v_add_f32 v80, v80, v81
    v_add_f32 v82, v82, v83
    v_add_f32_dpp v84, v84, v84 quad_perm:[2,3,0,1] row_mask:0xf bank_mask:0xf
    v_add_f32 v76, v76, v78
    v_add_f32 v80, v80, v82
    v_add_f32 v76, v76, v80
    v_rcp_f32 v78, v84
    s_nop 1
    v_mul_f32_dpp v76, v78, v76 row_newbcast:8 row_mask:0xf bank_mask:0xf
    v_mul_f32_dpp v84, v78, v84 row_newbcast:8 row_mask:0xf bank_mask:0xf
    v_cvt_pk_bf16_f32 v76, v76, v84
    ds_write_b16 v7, v76 offset:23552
    s_mov_b64 exec, s[30:31]
    ds_write_b16_d16_hi v7, v76 offset:25218
    s_mov_b64 exec, -1
    s_mov_b32 s29, 0xffff0000
    v_cndmask_b32 v64, 0, v70, s[34:35]
    v_cndmask_b32 v65, 0, v71, s[34:35]
    v_cndmask_b32 v66, v70, 0, s[34:35]
    v_cndmask_b32 v67, v71, 0, s[34:35]
    s_waitcnt lgkmcnt(0)
    s_barrier
    ds_read_b128 v[224:227], v9 offset:23552
    ds_read_b128 v[60:63], v9 offset:24576
    s_waitcnt vmcnt(12)
    v_lshlrev_b32 v12, 16, v132
    v_and_b32 v13, s29, v132
    v_lshlrev_b32 v14, 16, v133
    v_and_b32 v15, s29, v133
    v_lshlrev_b32 v16, 16, v134
    v_and_b32 v17, s29, v134
    v_lshlrev_b32 v18, 16, v135
    v_and_b32 v19, s29, v135
    v_lshlrev_b32 v20, 16, v136
    v_and_b32 v21, s29, v136
    v_lshlrev_b32 v22, 16, v137
    v_and_b32 v23, s29, v137
    s_waitcnt lgkmcnt(0)
    s_waitcnt vmcnt(8)
    v_smfmac_f32_16x16x64_bf16 v[204:207], v[224:227], v[140:147], v8
    v_smfmac_f32_16x16x64_bf16 v[208:211], v[224:227], v[108:115], v8
    v_smfmac_f32_16x16x64_bf16 v[212:215], v[224:227], v[148:155], v8
    v_smfmac_f32_16x16x64_bf16 v[216:219], v[224:227], v[156:163], v8
    v_smfmac_f32_16x16x64_bf16 v[220:223], v[224:227], v[116:123], v8
    v_smfmac_f32_16x16x64_bf16 v[204:207], v[60:63], v[92:99], v8
    s_waitcnt vmcnt(6)
    v_smfmac_f32_16x16x64_bf16 v[208:211], v[60:63], v[52:59], v8
    s_waitcnt vmcnt(4)
    v_smfmac_f32_16x16x64_bf16 v[212:215], v[60:63], v[44:51], v8
    s_waitcnt vmcnt(2)
    v_smfmac_f32_16x16x64_bf16 v[216:219], v[60:63], v[36:43], v8
    s_waitcnt vmcnt(0)
    v_smfmac_f32_16x16x64_bf16 v[220:223], v[60:63], v[28:35], v8
    v_cvt_pk_bf16_f32 v204, v204, v205
    v_cvt_pk_bf16_f32 v205, v206, v207
    v_cvt_pk_bf16_f32 v206, v208, v209
    v_cvt_pk_bf16_f32 v207, v210, v211
    s_nop 1
    v_mfma_f32_16x16x32_bf16 v[12:15], v[204:207], v[64:67], v[12:15]
    v_cvt_pk_bf16_f32 v212, v212, v213
    v_cvt_pk_bf16_f32 v213, v214, v215
    v_cvt_pk_bf16_f32 v214, v216, v217
    v_cvt_pk_bf16_f32 v215, v218, v219
    s_nop 1
    v_mfma_f32_16x16x32_bf16 v[16:19], v[212:215], v[64:67], v[16:19]
    v_cvt_pk_bf16_f32 v220, v220, v221
    v_cvt_pk_bf16_f32 v221, v222, v223
    s_nop 1
    v_mfma_f32_16x16x16_bf16 v[20:23], v[220:221], v[64:65], v[20:23]
    v_cvt_pk_bf16_f32 v132, v12, v13
    v_cvt_pk_bf16_f32 v133, v14, v15
    s_nop 0
    v_cvt_pk_bf16_f32 v134, v16, v17
    v_cvt_pk_bf16_f32 v135, v18, v19
    s_nop 2
    v_cvt_pk_bf16_f32 v136, v20, v21
    v_cndmask_b32 v136, 0, v136, s[34:35]
    v_cvt_pk_bf16_f32 v137, v22, v23
    v_cndmask_b32 v137, 0, v137, s[34:35]
    v_permlane16_swap_b32 v132, v134
    v_permlane16_swap_b32 v133, v135
    s_cmp_eq_u32 s45, 0
    s_cbranch_scc1 P4_MID0
    v_and_b32 v14, 7, v1
    v_mul_u32_u24 v14, 1152, v14
    v_lshrrev_b32 v15, 4, v1
    v_lshl_add_u32 v16, v15, 3, v14
    v_bfe_u32 v15, v1, 3, 2
    v_lshl_add_u32 v14, v15, 5, v14
    v_lshrrev_b32 v15, 5, v1
    v_lshl_add_u32 v14, v15, 4, v14
    s_mul_i32 s28, s4, 9216
    s_lshl_b32 s29, s44, 5
    s_add_u32 s28, s28, s29
    buffer_store_dwordx4 v[132:135], v14, s[12:15], s28 offen
    s_mov_b64 exec, s[34:35]
    buffer_store_dwordx2 v[136:137], v16, s[12:15], s28 offen offset:128
    s_endpgm
P4_MID0:
    s_mov_b32 s26, 0x3f803f80
    s_add_u32 s27, s28, 4718592
    v_dot2_f32_bf16 v12, v132, s26, 0
    v_dot2_f32_bf16 v13, v132, v132, 0
    v_dot2_f32_bf16 v12, v133, s26, v12
    v_dot2_f32_bf16 v13, v133, v133, v13
    v_dot2_f32_bf16 v12, v134, s26, v12
    v_dot2_f32_bf16 v13, v134, v134, v13
    v_dot2_f32_bf16 v12, v135, s26, v12
    v_dot2_f32_bf16 v13, v135, v135, v13
    v_dot2_f32_bf16 v12, v136, s26, v12
    v_dot2_f32_bf16 v13, v136, v136, v13
    v_dot2_f32_bf16 v12, v137, s26, v12
    v_dot2_f32_bf16 v13, v137, v137, v13
    v_and_b32 v16, 7, v1
    v_lshlrev_b32 v16, 6, v16
    v_add_u32 v16, 98304, v16
    v_permlane32_swap_b32 v12, v13
    s_lshl_b32 s26, s3, 3
    v_add_f32 v12, v12, v13
    v_lshrrev_b32 v17, 5, v1
    v_lshl_add_u32 v17, v17, 2, v16
    v_add_f32_dpp v12, v12, v12 row_ror:8 row_mask:0xf bank_mask:0xf
    v_add_u32 v17, s26, v17
    v_mov_b32 v13, v12
    s_nop 1
    v_permlane16_swap_b32 v12, v13
    v_add_f32 v12, v12, v13
    s_mov_b32 exec_lo, 0xff
    s_mov_b32 exec_hi, 0xff
    ds_write_b32 v17, v12 offset:61952
    s_mov_b64 exec, -1
    buffer_store_dwordx4 v[132:135], v254, s[8:11], s27 offen sc1
    s_mov_b64 exec, s[34:35]
    buffer_store_dwordx2 v[136:137], v11, s[8:11], s27 offen offset:2048 sc1
    s_mov_b64 exec, -1
    s_waitcnt lgkmcnt(0)
    s_barrier
    ds_read_b128 v[20:23], v16 offset:61952
    ds_read_b128 v[24:27], v16 offset:61968
    ds_read_b128 v[28:31], v16 offset:61984
    ds_read_b128 v[32:35], v16 offset:62000
    v_lshlrev_b32 v44, 16, v132
    v_and_b32 v45, s29, v132
    v_lshlrev_b32 v46, 16, v133
    v_and_b32 v47, s29, v133
    v_lshlrev_b32 v48, 16, v134
    v_and_b32 v49, s29, v134
    v_lshlrev_b32 v50, 16, v135
    v_and_b32 v51, s29, v135
    v_lshlrev_b32 v52, 16, v136
    v_and_b32 v53, s29, v136
    v_lshlrev_b32 v54, 16, v137
    v_and_b32 v55, s29, v137
    s_waitcnt lgkmcnt(0)
    v_add_f32 v20, v20, v22
    v_add_f32 v21, v21, v23
    v_add_f32 v24, v24, v26
    v_add_f32 v25, v25, v27
    v_add_f32 v28, v28, v30
    v_add_f32 v29, v29, v31
    v_add_f32 v32, v32, v34
    v_add_f32 v33, v33, v35
    v_add_f32 v20, v20, v24
    v_add_f32 v21, v21, v25
    v_add_f32 v28, v28, v32
    v_add_f32 v29, v29, v33
    v_add_f32 v20, v20, v28
    v_add_f32 v21, v21, v29
    v_mul_f32 v20, 3135475257, v20
    v_mul_f32 v21, 987991609, v21
    v_fma_f32 v21, -v20, v20, v21
    v_max_f32 v21, 0, v21
    v_add_f32 v21, 925353388, v21
    v_rsq_f32 v21, v21
    s_add_u32 s27, s28, 2359296
    v_mul_f32 v20, v20, v21
    v_fma_f32 v44, v44, v21, v20
    v_fma_f32 v45, v45, v21, v20
    v_cvt_pk_bf16_f32 v36, v44, v45
    v_fma_f32 v46, v46, v21, v20
    v_fma_f32 v47, v47, v21, v20
    v_cvt_pk_bf16_f32 v37, v46, v47
    v_fma_f32 v48, v48, v21, v20
    v_fma_f32 v49, v49, v21, v20
    v_cvt_pk_bf16_f32 v38, v48, v49
    v_fma_f32 v50, v50, v21, v20
    v_fma_f32 v51, v51, v21, v20
    v_cvt_pk_bf16_f32 v39, v50, v51
    v_min_u32 v36, -2, v36
    s_waitcnt vmcnt(0)
    buffer_store_dwordx4 v[36:39], v254, s[8:11], s27 offen sc1
    v_fma_f32 v52, v52, v21, v20
    v_fma_f32 v53, v53, v21, v20
    v_cvt_pk_bf16_f32 v40, v52, v53
    v_fma_f32 v54, v54, v21, v20
    v_fma_f32 v55, v55, v21, v20
    v_cvt_pk_bf16_f32 v41, v54, v55
    v_permlane16_swap_b32 v40, v42
    s_nop 0
    v_permlane16_swap_b32 v41, v43
    v_min_u32 v40, -2, v40
    s_mov_b32 exec_lo, 0xff
    s_mov_b32 exec_hi, 0xff
    buffer_store_dwordx4 v[40:43], v254, s[8:11], s27 offen offset:2048 sc1
    s_mov_b64 exec, -1
    s_setprio 0
    s_mov_b32 s45, 1
    s_branch MID
P4_C1:
    s_nop 7
    v_exp_f32 v12, v12
    s_waitcnt vmcnt(3)
    ds_read_b128 v[132:135], v204 offset:0
    ds_read_b128 v[136:139], v205 offset:0
    v_exp_f32 v13, v13
    v_exp_f32 v14, v14
    v_exp_f32 v15, v15
    s_add_u32 m0, s6, 24576
    s_add_u32 s27, s40, 3072
    buffer_load_dwordx4 v3, s[8:11], s27 offen sc1 lds
    v_exp_f32 v16, v16
    v_exp_f32 v17, v17
    v_exp_f32 v18, v18
    buffer_load_dwordx4 v[108:111], v3, s[8:11], s22 offen offset:0 sc1
    v_mfma_f32_32x32x8_bf16 v[44:59], v[126:127], v[200:201], 0
    v_exp_f32 v19, v19
    v_exp_f32 v20, v20
    v_exp_f32 v21, v21
    s_waitcnt lgkmcnt(0)
    v_max_u32 v10, v132, v136
    v_cmp_eq_u32 vcc, -1, v10
    v_exp_f32 v22, v22
    v_exp_f32 v23, v23
    s_cbranch_vccnz P4_RV10
P4_RV10B:
    s_add_u32 m0, s6, 32768
    s_add_u32 s27, s40, 4096
    buffer_load_dwordx4 v3, s[8:11], s27 offen sc1 lds
    v_smfmac_f32_32x32x32_bf16 v[60:75], v[132:135], v[12:19], v2
    v_exp_f32 v24, v24
    v_exp_f32 v25, v25
    s_waitcnt vmcnt(5)
    v_max3_u32 v10, v100, v101, v102
    v_max_u32 v10, v103, v10
    v_cmp_eq_u32 vcc, -1, v10
    v_exp_f32 v26, v26
    v_exp_f32 v27, v27
    s_cbranch_vccnz P4_RK10
P4_RK10B:
    s_setprio 3
    buffer_load_dwordx4 v[112:115], v3, s[8:11], s22 offen offset:1024 sc1
    v_mfma_f32_32x32x16_bf16 v[44:59], v[100:103], v[196:199], v[44:59]
    v_exp_f32 v28, v28
    s_waitcnt vmcnt(5)
    ds_read_b128 v[140:143], v206 offset:0
    ds_read_b128 v[144:147], v207 offset:0
    v_exp_f32 v29, v29
    v_exp_f32 v30, v30
    v_exp_f32 v31, v31
    s_add_u32 m0, s6, 40960
    s_add_u32 s27, s40, 5120
    buffer_load_dwordx4 v3, s[8:11], s27 offen sc1 lds
    v_smfmac_f32_32x32x32_bf16 v[60:75], v[136:139], v[20:27], v2
    v_exp_f32 v32, v32
    v_exp_f32 v33, v33
    v_exp_f32 v34, v34
    s_add_u32 m0, s6, 49152
    s_add_u32 s27, s40, 6144
    buffer_load_dwordx4 v3, s[8:11], s27 offen sc1 lds
    v_mfma_f32_32x32x8_bf16 v[12:27], v[126:127], v[202:203], 0
    v_exp_f32 v35, v35
    v_exp_f32 v36, v36
    v_exp_f32 v37, v37
    s_waitcnt lgkmcnt(0)
    v_max_u32 v10, v140, v144
    v_cmp_eq_u32 vcc, -1, v10
    v_exp_f32 v38, v38
    v_exp_f32 v39, v39
    s_cbranch_vccnz P4_RV11
P4_RV11B:
    buffer_load_dwordx4 v[116:119], v3, s[8:11], s22 offen offset:2048 sc1
    v_smfmac_f32_32x32x32_bf16 v[60:75], v[140:143], v[28:35], v2
    v_exp_f32 v40, v40
    v_exp_f32 v41, v41
    s_waitcnt vmcnt(7)
    v_max3_u32 v10, v104, v105, v106
    v_max_u32 v10, v107, v10
    v_cmp_eq_u32 vcc, -1, v10
    v_exp_f32 v42, v42
    v_exp_f32 v43, v43
    s_cbranch_vccnz P4_RK11
P4_RK11B:
    s_setprio 3
    s_add_u32 m0, s6, 57344
    s_add_u32 s27, s40, 7168
    buffer_load_dwordx4 v3, s[8:11], s27 offen sc1 lds
    v_mfma_f32_32x32x16_bf16 v[12:27], v[104:107], v[196:199], v[12:27]
    v_exp_f32 v44, v44
    s_waitcnt vmcnt(7)
    ds_read_b128 v[148:151], v208 offset:0
    ds_read_b128 v[152:155], v209 offset:0
    v_exp_f32 v45, v45
    v_exp_f32 v46, v46
    v_exp_f32 v47, v47
    buffer_load_dwordx4 v[120:123], v3, s[8:11], s22 offen offset:3072 sc1
    v_smfmac_f32_32x32x32_bf16 v[60:75], v[144:147], v[36:43], v2
    v_exp_f32 v48, v48
    v_exp_f32 v49, v49
    v_exp_f32 v50, v50
    s_add_u32 m0, s6, 65536
    s_add_u32 s27, s40, 8192
    buffer_load_dwordx4 v3, s[8:11], s27 offen sc1 lds
    v_mfma_f32_32x32x8_bf16 v[28:43], v[128:129], v[200:201], 0
    v_exp_f32 v51, v51
    v_exp_f32 v52, v52
    v_exp_f32 v53, v53
    s_waitcnt lgkmcnt(0)
    v_max_u32 v10, v148, v152
    v_cmp_eq_u32 vcc, -1, v10
    v_exp_f32 v54, v54
    v_exp_f32 v55, v55
    s_cbranch_vccnz P4_RV12
P4_RV12B:
    s_add_u32 m0, s6, 73728
    s_add_u32 s27, s40, 9216
    buffer_load_dwordx4 v3, s[8:11], s27 offen sc1 lds
    v_smfmac_f32_32x32x32_bf16 v[60:75], v[148:151], v[44:51], v2
    v_exp_f32 v56, v56
    v_exp_f32 v57, v57
    s_waitcnt vmcnt(9)
    v_max3_u32 v10, v108, v109, v110
    v_max_u32 v10, v111, v10
    v_cmp_eq_u32 vcc, -1, v10
    v_exp_f32 v58, v58
    v_exp_f32 v59, v59
    s_cbranch_vccnz P4_RK12
P4_RK12B:
    s_setprio 2
    v_mfma_f32_32x32x16_bf16 v[28:43], v[108:111], v[196:199], v[28:43]
    v_exp_f32 v12, v12
    s_waitcnt vmcnt(8)
    ds_read_b128 v[156:159], v210 offset:0
    ds_read_b128 v[160:163], v211 offset:0
    v_exp_f32 v13, v13
    v_exp_f32 v14, v14
    v_exp_f32 v15, v15
    v_smfmac_f32_32x32x32_bf16 v[60:75], v[152:155], v[52:59], v2
    v_exp_f32 v16, v16
    v_exp_f32 v17, v17
    v_exp_f32 v18, v18
    v_mfma_f32_32x32x8_bf16 v[44:59], v[128:129], v[202:203], 0
    v_exp_f32 v19, v19
    v_exp_f32 v20, v20
    v_exp_f32 v21, v21
    s_waitcnt lgkmcnt(0)
    v_max_u32 v10, v156, v160
    v_cmp_eq_u32 vcc, -1, v10
    v_exp_f32 v22, v22
    v_exp_f32 v23, v23
    s_cbranch_vccnz P4_RV13
P4_RV13B:
    v_smfmac_f32_32x32x32_bf16 v[60:75], v[156:159], v[12:19], v2
    v_exp_f32 v24, v24
    s_cmp_eq_u32 s38, 2
    s_cbranch_scc1 P4_NV1
    v_add_f32_dpp v234, v234, v234 quad_perm:[1,0,3,2] row_mask:0xf bank_mask:0xf
    v_max3_f32 v238, v238, v239, v240
    v_max_f32 v238, v238, v241
    v_add_f32_dpp v234, v234, v234 quad_perm:[2,3,0,1] row_mask:0xf bank_mask:0xf
    v_mov_b32 v235, s41
    v_mov_b32 v237, 1119879168
    v_max_f32_dpp v234, v234, v234 row_ror:4 row_mask:0xf bank_mask:0xf
    s_nop 1
    v_max_f32_dpp v234, v234, v234 row_ror:8 row_mask:0xf bank_mask:0xf
    v_sqrt_f32 v234, v234
    s_nop 0
    v_readlane_b32 s39, v234, 0
    s_nop 1
    v_add_f32 v236, s39, v235
    v_sub_f32 v235, s39, v235
    v_mul_f32 v235, 0x40400000, v235
    v_max_f32 v236, v236, v235
    v_mul_f32 v236, v236, v238
    v_cmp_nge_f32 vcc, v237, v236
    s_nop 0
    s_cmp_lg_u64 vcc, 0
    s_cselect_b32 s39, 1, 2
    v_mov_b32 v11, s39
P4_NV1:
    v_exp_f32 v25, v25
    s_waitcnt vmcnt(7)
    v_max3_u32 v10, v112, v113, v114
    v_max_u32 v10, v115, v10
    v_cmp_eq_u32 vcc, -1, v10
    v_exp_f32 v26, v26
    v_exp_f32 v27, v27
    s_cbranch_vccnz P4_RK13
P4_RK13B:
    s_setprio 2
    v_mfma_f32_32x32x16_bf16 v[44:59], v[112:115], v[196:199], v[44:59]
    v_exp_f32 v28, v28
    s_waitcnt vmcnt(5)
    ds_read_b128 v[164:167], v204 offset:40960
    ds_read_b128 v[168:171], v205 offset:40960
    v_exp_f32 v29, v29
    v_exp_f32 v30, v30
    v_exp_f32 v31, v31
    v_smfmac_f32_32x32x32_bf16 v[60:75], v[160:163], v[20:27], v2
    v_exp_f32 v32, v32
    v_exp_f32 v33, v33
    v_exp_f32 v34, v34
    v_mfma_f32_32x32x8_bf16 v[12:27], v[130:131], v[200:201], 0
    v_exp_f32 v35, v35
    v_exp_f32 v36, v36
    v_exp_f32 v37, v37
    s_waitcnt lgkmcnt(0)
    v_max_u32 v10, v164, v168
    v_cmp_eq_u32 vcc, -1, v10
    v_exp_f32 v38, v38
    v_exp_f32 v39, v39
    s_cbranch_vccnz P4_RV14
P4_RV14B:
    v_smfmac_f32_32x32x32_bf16 v[60:75], v[164:167], v[28:35], v2
    v_exp_f32 v40, v40
    v_exp_f32 v41, v41
    s_waitcnt vmcnt(4)
    v_max3_u32 v10, v116, v117, v118
    v_max_u32 v10, v119, v10
    v_cmp_eq_u32 vcc, -1, v10
    v_exp_f32 v42, v42
    v_exp_f32 v43, v43
    s_cbranch_vccnz P4_RK14
P4_RK14B:
    s_setprio 2
    v_mfma_f32_32x32x16_bf16 v[12:27], v[116:119], v[196:199], v[12:27]
    v_exp_f32 v44, v44
    s_waitcnt vmcnt(3)
    ds_read_b128 v[172:175], v206 offset:40960
    ds_read_b128 v[176:179], v207 offset:40960
    v_exp_f32 v45, v45
    v_exp_f32 v46, v46
    v_exp_f32 v47, v47
    v_smfmac_f32_32x32x32_bf16 v[60:75], v[168:171], v[36:43], v2
    v_exp_f32 v48, v48
    v_exp_f32 v49, v49
    v_exp_f32 v50, v50
    ds_read_b128 v[76:79], v252
    ds_read_b128 v[80:83], v252
    ds_read_b128 v[84:87], v252
    ds_read_b128 v[88:91], v252
    v_mfma_f32_32x32x8_bf16 v[28:43], v[130:131], v[202:203], 0
    v_exp_f32 v51, v51
    v_exp_f32 v52, v52
    v_exp_f32 v53, v53
    s_waitcnt lgkmcnt(0)
    v_max_u32 v10, v172, v176
    v_cmp_eq_u32 vcc, -1, v10
    v_exp_f32 v54, v54
    v_exp_f32 v55, v55
    s_cbranch_vccnz P4_RV15
P4_RV15B:
    ds_read_b128 v[200:203], v9 offset:3072
    v_smfmac_f32_32x32x32_bf16 v[60:75], v[172:175], v[44:51], v2
    v_exp_f32 v56, v56
    v_exp_f32 v57, v57
    s_waitcnt vmcnt(2)
    v_max3_u32 v10, v120, v121, v122
    v_max_u32 v10, v123, v10
    v_cmp_eq_u32 vcc, -1, v10
    v_exp_f32 v58, v58
    v_exp_f32 v59, v59
    s_cbranch_vccnz P4_RK15
P4_RK15B:
    s_setprio 1
    v_mfma_f32_32x32x16_bf16 v[28:43], v[120:123], v[196:199], v[28:43]
    v_exp_f32 v12, v12
    s_waitcnt vmcnt(1)
    ds_read_b128 v[180:183], v208 offset:40960
    ds_read_b128 v[184:187], v209 offset:40960
    v_exp_f32 v13, v13
    v_exp_f32 v14, v14
    v_exp_f32 v15, v15
    ds_read_b128 v[196:199], v9 offset:2048
    v_smfmac_f32_32x32x32_bf16 v[60:75], v[176:179], v[52:59], v2
    v_exp_f32 v16, v16
    v_exp_f32 v17, v17
    v_exp_f32 v18, v18
    s_waitcnt lgkmcnt(1)
    v_mfma_f32_32x32x8_bf16 v[44:59], v[124:125], v[200:201], 0
    v_exp_f32 v19, v19
    v_exp_f32 v20, v20
    v_exp_f32 v21, v21
    s_waitcnt lgkmcnt(0)
    v_max_u32 v10, v180, v184
    v_cmp_eq_u32 vcc, -1, v10
    v_exp_f32 v22, v22
    v_exp_f32 v23, v23
    s_cbranch_vccnz P4_RV16
P4_RV16B:
    v_smfmac_f32_32x32x32_bf16 v[60:75], v[180:183], v[12:19], v2
    v_exp_f32 v24, v24
    v_exp_f32 v25, v25
    v_exp_f32 v26, v26
    v_exp_f32 v27, v27
    s_setprio 1
    s_waitcnt lgkmcnt(0)
    v_mfma_f32_32x32x16_bf16 v[44:59], v[92:95], v[196:199], v[44:59]
    v_exp_f32 v28, v28
    s_waitcnt vmcnt(0)
    ds_read_b128 v[188:191], v210 offset:40960
    ds_read_b128 v[192:195], v211 offset:40960
    v_exp_f32 v29, v29
    v_exp_f32 v30, v30
    v_exp_f32 v31, v31
    v_smfmac_f32_32x32x32_bf16 v[60:75], v[184:187], v[20:27], v2
    v_exp_f32 v32, v32
    v_exp_f32 v33, v33
    v_exp_f32 v34, v34
    v_mfma_f32_32x32x8_bf16 v[12:27], v[124:125], v[202:203], 0
    v_exp_f32 v35, v35
    v_exp_f32 v36, v36
    v_exp_f32 v37, v37
    s_waitcnt lgkmcnt(0)
    v_max_u32 v10, v188, v192
    v_cmp_eq_u32 vcc, -1, v10
    v_exp_f32 v38, v38
    v_exp_f32 v39, v39
    s_cbranch_vccnz P4_RV17
P4_RV17B:
    v_smfmac_f32_32x32x32_bf16 v[60:75], v[188:191], v[28:35], v2
    v_exp_f32 v40, v40
    v_exp_f32 v41, v41
    v_exp_f32 v42, v42
    v_exp_f32 v43, v43
    s_setprio 1
    v_mfma_f32_32x32x16_bf16 v[12:27], v[96:99], v[196:199], v[12:27]
    v_exp_f32 v44, v44
    v_exp_f32 v45, v45
    v_exp_f32 v46, v46
    v_exp_f32 v47, v47
    v_smfmac_f32_32x32x32_bf16 v[60:75], v[192:195], v[36:43], v2
    v_exp_f32 v48, v48
    v_exp_f32 v49, v49
    v_exp_f32 v50, v50
    s_add_u32 s46, s24, 0
    buffer_load_dwordx4 v[228:231], v3, s[8:11], s46 offen offset:0
    buffer_load_dwordx4 v[232:235], v3, s[8:11], s46 offen offset:1024
    v_mfma_f32_32x32x8_bf16 v[28:43], v[126:127], v[200:201], 0
    v_exp_f32 v51, v51
    v_exp_f32 v52, v52
    v_exp_f32 v53, v53
    v_exp_f32 v54, v54
    v_exp_f32 v55, v55
    v_smfmac_f32_32x32x32_bf16 v[76:91], v[132:135], v[44:51], v2
    v_exp_f32 v56, v56
    v_exp_f32 v57, v57
    v_exp_f32 v58, v58
    v_exp_f32 v59, v59
    s_setprio 0
    ds_write_b128 v4, v[60:63] offset:32768
    v_mfma_f32_32x32x16_bf16 v[28:43], v[100:103], v[196:199], v[28:43]
    v_exp_f32 v12, v12
    v_exp_f32 v13, v13
    v_exp_f32 v14, v14
    v_exp_f32 v15, v15
    v_smfmac_f32_32x32x32_bf16 v[76:91], v[136:139], v[52:59], v2
    v_exp_f32 v16, v16
    v_exp_f32 v17, v17
    v_exp_f32 v18, v18
    s_add_u32 s46, s24, 2048
    buffer_load_dwordx4 v[236:239], v3, s[8:11], s46 offen offset:0
    buffer_load_dwordx4 v[240:243], v3, s[8:11], s46 offen offset:1024
    ds_write_b128 v4, v[64:67] offset:32800
    v_mfma_f32_32x32x8_bf16 v[44:59], v[126:127], v[202:203], 0
    v_exp_f32 v19, v19
    v_exp_f32 v20, v20
    v_exp_f32 v21, v21
    v_exp_f32 v22, v22
    v_exp_f32 v23, v23
    ds_write_b128 v4, v[68:71] offset:32832
    s_mov_b64 exec, 1
    ds_write_b32 v6, v11 offset:25856
    s_mov_b64 exec, -1
    v_smfmac_f32_32x32x32_bf16 v[76:91], v[140:143], v[12:19], v2
    v_exp_f32 v24, v24
    v_exp_f32 v25, v25
    v_exp_f32 v26, v26
    v_exp_f32 v27, v27
    s_setprio 0
    v_mfma_f32_32x32x16_bf16 v[44:59], v[104:107], v[196:199], v[44:59]
    v_exp_f32 v28, v28
    v_exp_f32 v29, v29
    v_exp_f32 v30, v30
    v_exp_f32 v31, v31
    s_cmp_lg_u32 s45, 0
    s_cbranch_scc1 P4_MK12
    v_mov_b32 v72, -1
    v_mov_b32 v73, -1
    v_mov_b32 v74, -1
    v_mov_b32 v75, -1
    v_lshrrev_b32 v254, 3, v1
    v_and_b32 v255, 7, v1
    v_lshlrev_b32 v255, 4, v255
    v_lshl_add_u32 v254, v254, 8, v255
    s_lshl_b32 s42, s3, 11
    s_add_u32 s42, s42, s5
    s_add_u32 s43, s42, 11796480
    s_add_u32 s42, s42, 7077888
    buffer_store_dwordx4 v[72:75], v254, s[8:11], s42 offen offset:0 sc1
P4_MK12:
    v_smfmac_f32_32x32x32_bf16 v[76:91], v[144:147], v[20:27], v2
    v_exp_f32 v32, v32
    v_exp_f32 v33, v33
    v_exp_f32 v34, v34
    s_add_u32 s46, s24, 4096
    buffer_load_dwordx4 v[244:247], v3, s[8:11], s46 offen offset:0
    buffer_load_dwordx4 v[248:251], v3, s[8:11], s46 offen offset:1024
    v_mfma_f32_32x32x8_bf16 v[12:27], v[128:129], v[200:201], 0
    v_exp_f32 v35, v35
    v_exp_f32 v36, v36
    v_exp_f32 v37, v37
    v_exp_f32 v38, v38
    v_exp_f32 v39, v39
    v_smfmac_f32_32x32x32_bf16 v[76:91], v[148:151], v[28:35], v2
    v_exp_f32 v40, v40
    v_exp_f32 v41, v41
    v_exp_f32 v42, v42
    v_exp_f32 v43, v43
    s_setprio 0
    v_mfma_f32_32x32x16_bf16 v[12:27], v[108:111], v[196:199], v[12:27]
    v_exp_f32 v44, v44
    v_exp_f32 v45, v45
    v_exp_f32 v46, v46
    v_exp_f32 v47, v47
    ds_read_b32 v10, v0 offset:25856
    ds_read2st64_b32 v[68:69], v253 offset0:128 offset1:142
    ds_read2st64_b32 v[60:61], v5 offset0:128 offset1:142
    ds_read2st64_b32 v[62:63], v5 offset0:156 offset1:170
    ds_read2st64_b32 v[64:65], v5 offset0:184 offset1:198
    ds_read2st64_b32 v[66:67], v5 offset0:212 offset1:226
    v_smfmac_f32_32x32x32_bf16 v[76:91], v[152:155], v[36:43], v2
    v_exp_f32 v48, v48
    v_exp_f32 v49, v49
    v_exp_f32 v50, v50
    v_mfma_f32_32x32x8_bf16 v[28:43], v[128:129], v[202:203], 0
    v_exp_f32 v51, v51
    v_exp_f32 v52, v52
    v_exp_f32 v53, v53
    v_exp_f32 v54, v54
    v_exp_f32 v55, v55
    v_smfmac_f32_32x32x32_bf16 v[76:91], v[156:159], v[44:51], v2
    v_exp_f32 v56, v56
    v_exp_f32 v57, v57
    v_exp_f32 v58, v58
    v_exp_f32 v59, v59
    s_setprio 2
    s_waitcnt lgkmcnt(0)
    v_cmp_eq_u32 vcc, 0, v10
    s_cbranch_vccnz P4_RT14
P4_BK14:
    v_cmp_eq_u32 vcc, 1, v10
    s_cbranch_vccnz P4_FB
    v_mfma_f32_32x32x16_bf16 v[28:43], v[112:115], v[196:199], v[28:43]
    v_exp_f32 v12, v12
    v_add_f32 v68, v68, v69
    v_add_f32 v60, v60, v61
    v_add_f32 v62, v62, v63
    v_exp_f32 v13, v13
    v_add_f32_dpp v68, v68, v68 quad_perm:[1,0,3,2] row_mask:0xf bank_mask:0xf
    v_add_f32 v64, v64, v65
    v_add_f32 v66, v66, v67
    v_exp_f32 v14, v14
    v_exp_f32 v15, v15
    s_cmp_lg_u32 s45, 0
    s_cbranch_scc1 P4_MK14
    buffer_store_dwordx4 v[72:75], v254, s[8:11], s43 offen offset:0 sc1
P4_MK14:
    v_smfmac_f32_32x32x32_bf16 v[76:91], v[160:163], v[52:59], v2
    v_add_f32_dpp v68, v68, v68 quad_perm:[2,3,0,1] row_mask:0xf bank_mask:0xf
    v_add_f32 v60, v60, v62
    v_add_f32 v64, v64, v66
    v_exp_f32 v16, v16
    v_add_f32 v60, v60, v64
    v_exp_f32 v17, v17
    v_exp_f32 v18, v18
    v_mfma_f32_32x32x8_bf16 v[44:59], v[130:131], v[200:201], 0
    v_rcp_f32 v62, v68
    v_exp_f32 v19, v19
    v_exp_f32 v20, v20
    v_mul_f32_dpp v60, v62, v60 row_newbcast:8 row_mask:0xf bank_mask:0xf
    v_mul_f32_dpp v68, v62, v68 row_newbcast:8 row_mask:0xf bank_mask:0xf
    v_cvt_pk_bf16_f32 v60, v60, v68
    v_exp_f32 v21, v21
    v_exp_f32 v22, v22
    v_exp_f32 v23, v23
    ds_write_b16 v7, v60 offset:16384
    s_mov_b64 exec, s[30:31]
    ds_write_b16_d16_hi v7, v60 offset:24574
    s_mov_b64 exec, 1
    ds_write_b32 v6, v2 offset:26112
    s_mov_b64 exec, -1
    v_smfmac_f32_32x32x32_bf16 v[76:91], v[164:167], v[12:19], v2
    v_exp_f32 v24, v24
    v_exp_f32 v25, v25
    v_exp_f32 v26, v26
    v_exp_f32 v27, v27
    s_setprio 1
    ds_read_b128 v[204:207], v252
    ds_read_b128 v[208:211], v252
    ds_read_b128 v[212:215], v252
    ds_read_b128 v[216:219], v252
    v_mfma_f32_32x32x16_bf16 v[44:59], v[116:119], v[196:199], v[44:59]
    v_exp_f32 v28, v28
    v_exp_f32 v29, v29
    v_exp_f32 v30, v30
    v_exp_f32 v31, v31
    v_smfmac_f32_32x32x32_bf16 v[76:91], v[168:171], v[20:27], v2
    v_exp_f32 v32, v32
    v_exp_f32 v33, v33
    v_exp_f32 v34, v34
    ds_read_b128 v[60:63], v252
    ds_read_b128 v[64:67], v252
    ds_read_b128 v[68:71], v252
    v_mfma_f32_32x32x8_bf16 v[12:27], v[130:131], v[202:203], 0
    v_exp_f32 v35, v35
    v_exp_f32 v36, v36
    v_exp_f32 v37, v37
    v_exp_f32 v38, v38
    v_exp_f32 v39, v39
    ds_read_b128 v[200:203], v9 offset:5120
    v_smfmac_f32_32x32x32_bf16 v[76:91], v[172:175], v[28:35], v2
    v_exp_f32 v40, v40
    v_exp_f32 v41, v41
    v_exp_f32 v42, v42
    v_exp_f32 v43, v43
    s_setprio 0
    ds_read_b32 v10, v0 offset:26112
    ds_read_b128 v[224:227], v9 offset:16384
    v_mfma_f32_32x32x16_bf16 v[12:27], v[120:123], v[196:199], v[12:27]
    v_exp_f32 v44, v44
    v_exp_f32 v45, v45
    v_exp_f32 v46, v46
    v_exp_f32 v47, v47
    ds_read_b128 v[196:199], v9 offset:4096
    s_cmp_lg_u32 s45, 0
    s_cbranch_scc1 P4_MK16
    buffer_store_dwordx4 v[72:75], v3, s[8:11], s7 offen offset:0 sc1
P4_MK16:
    v_smfmac_f32_32x32x32_bf16 v[76:91], v[176:179], v[36:43], v2
    v_exp_f32 v48, v48
    v_exp_f32 v49, v49
    v_exp_f32 v50, v50
    s_waitcnt lgkmcnt(1)
    v_cmp_eq_u32 vcc, 0, v10
    s_cbranch_vccnz P4_RT15
P4_BK15:
    s_waitcnt vmcnt(4)
    v_mfma_f32_32x32x8_bf16 v[28:43], v[124:125], v[200:201], 0
    v_exp_f32 v51, v51
    v_exp_f32 v52, v52
    v_exp_f32 v53, v53
    v_exp_f32 v54, v54
    v_smfmac_f32_16x16x64_bf16 v[204:207], v[224:227], v[228:235], v8
    v_exp_f32 v55, v55
    s_add_u32 s46, s24, 6144
    buffer_load_dwordx4 v[228:231], v3, s[8:11], s46 offen offset:0
    v_smfmac_f32_32x32x32_bf16 v[76:91], v[180:183], v[44:51], v2
    v_exp_f32 v56, v56
    v_exp_f32 v57, v57
    v_exp_f32 v58, v58
    v_exp_f32 v59, v59
    s_setprio 3
    s_waitcnt lgkmcnt(0)
    buffer_load_dwordx4 v[232:235], v3, s[8:11], s46 offen offset:1024
    v_mfma_f32_32x32x16_bf16 v[28:43], v[92:95], v[196:199], v[28:43]
    v_exp_f32 v12, v12
    v_exp_f32 v13, v13
    v_exp_f32 v14, v14
    v_exp_f32 v15, v15
    v_smfmac_f32_32x32x32_bf16 v[76:91], v[184:187], v[52:59], v2
    v_exp_f32 v16, v16
    v_exp_f32 v17, v17
    v_exp_f32 v18, v18
    v_mfma_f32_32x32x8_bf16 v[44:59], v[124:125], v[202:203], 0
    v_exp_f32 v19, v19
    v_exp_f32 v20, v20
    v_exp_f32 v21, v21
    v_exp_f32 v22, v22
    v_exp_f32 v23, v23
    v_smfmac_f32_32x32x32_bf16 v[76:91], v[188:191], v[12:19], v2
    v_exp_f32 v24, v24
    v_exp_f32 v25, v25
    v_exp_f32 v26, v26
    v_exp_f32 v27, v27
    s_setprio 2
    v_mfma_f32_32x32x16_bf16 v[44:59], v[96:99], v[196:199], v[44:59]
    v_exp_f32 v28, v28
    v_exp_f32 v29, v29
    v_exp_f32 v30, v30
    v_exp_f32 v31, v31
    s_cmp_lg_u32 s45, 0
    s_cbranch_scc1 P4_NP116
    s_add_u32 m0, s6, 0
    s_add_u32 s27, s25, 0
    buffer_load_dwordx4 v3, s[8:11], s27 offen lds
P4_NP116:
    v_smfmac_f32_32x32x32_bf16 v[76:91], v[192:195], v[20:27], v2
    v_exp_f32 v32, v32
    v_exp_f32 v33, v33
    v_exp_f32 v34, v34
    s_waitcnt vmcnt(4)
    v_mfma_f32_32x32x8_bf16 v[12:27], v[126:127], v[200:201], 0
    v_exp_f32 v35, v35
    v_exp_f32 v36, v36
    v_exp_f32 v37, v37
    v_exp_f32 v38, v38
    v_smfmac_f32_16x16x64_bf16 v[208:211], v[224:227], v[236:243], v8
    v_exp_f32 v39, v39
    s_add_u32 s46, s24, 73728
    buffer_load_dwordx4 v[236:239], v3, s[8:11], s46 offen offset:0
    v_smfmac_f32_32x32x32_bf16 v[60:75], v[132:135], v[28:35], v2
    v_exp_f32 v40, v40
    v_exp_f32 v41, v41
    v_exp_f32 v42, v42
    v_exp_f32 v43, v43
    s_setprio 1
    ds_write_b128 v4, v[76:79] offset:32768
    buffer_load_dwordx4 v[240:243], v3, s[8:11], s46 offen offset:1024
    v_mfma_f32_32x32x16_bf16 v[12:27], v[100:103], v[196:199], v[12:27]
    v_exp_f32 v44, v44
    v_exp_f32 v45, v45
    v_exp_f32 v46, v46
    v_exp_f32 v47, v47
    v_smfmac_f32_32x32x32_bf16 v[60:75], v[136:139], v[36:43], v2
    v_exp_f32 v48, v48
    v_exp_f32 v49, v49
    v_exp_f32 v50, v50
    ds_write_b128 v4, v[80:83] offset:32800
    v_mfma_f32_32x32x8_bf16 v[28:43], v[126:127], v[202:203], 0
    v_exp_f32 v51, v51
    v_exp_f32 v52, v52
    v_exp_f32 v53, v53
    v_exp_f32 v54, v54
    v_exp_f32 v55, v55
    ds_write_b128 v4, v[84:87] offset:32832
    s_mov_b64 exec, 1
    ds_write_b32 v6, v2 offset:25888
    s_mov_b64 exec, -1
    v_smfmac_f32_32x32x32_bf16 v[60:75], v[140:143], v[44:51], v2
    v_exp_f32 v56, v56
    v_exp_f32 v57, v57
    v_exp_f32 v58, v58
    v_exp_f32 v59, v59
    s_setprio 0
    v_mfma_f32_32x32x16_bf16 v[28:43], v[104:107], v[196:199], v[28:43]
    v_exp_f32 v12, v12
    v_exp_f32 v13, v13
    v_exp_f32 v14, v14
    v_exp_f32 v15, v15
    v_smfmac_f32_32x32x32_bf16 v[60:75], v[144:147], v[52:59], v2
    v_exp_f32 v16, v16
    v_exp_f32 v17, v17
    v_exp_f32 v18, v18
    s_waitcnt vmcnt(4)
    v_mfma_f32_32x32x8_bf16 v[44:59], v[128:129], v[200:201], 0
    v_exp_f32 v19, v19
    v_exp_f32 v20, v20
    v_exp_f32 v21, v21
    v_exp_f32 v22, v22
    v_smfmac_f32_16x16x64_bf16 v[212:215], v[224:227], v[244:251], v8
    v_exp_f32 v23, v23
    s_add_u32 s46, s24, 75776
    buffer_load_dwordx4 v[244:247], v3, s[8:11], s46 offen offset:0
    v_smfmac_f32_32x32x32_bf16 v[60:75], v[148:151], v[12:19], v2
    v_exp_f32 v24, v24
    v_exp_f32 v25, v25
    v_exp_f32 v26, v26
    v_exp_f32 v27, v27
    s_setprio 3
    buffer_load_dwordx4 v[248:251], v3, s[8:11], s46 offen offset:1024
    v_mfma_f32_32x32x16_bf16 v[44:59], v[108:111], v[196:199], v[44:59]
    v_exp_f32 v28, v28
    v_exp_f32 v29, v29
    v_exp_f32 v30, v30
    v_exp_f32 v31, v31
    ds_read_b32 v10, v0 offset:25888
    ds_read2st64_b32 v[84:85], v253 offset0:128 offset1:142
    ds_read2st64_b32 v[76:77], v5 offset0:128 offset1:142
    ds_read2st64_b32 v[78:79], v5 offset0:156 offset1:170
    ds_read2st64_b32 v[80:81], v5 offset0:184 offset1:198
    ds_read2st64_b32 v[82:83], v5 offset0:212 offset1:226
    s_cmp_lg_u32 s45, 0
    s_cbranch_scc1 P4_NP119
    s_add_u32 m0, s6, 8192
    s_add_u32 s27, s25, 7168
    buffer_load_dwordx4 v3, s[8:11], s27 offen lds
P4_NP119:
    v_smfmac_f32_32x32x32_bf16 v[60:75], v[152:155], v[20:27], v2
    v_exp_f32 v32, v32
    v_exp_f32 v33, v33
    v_exp_f32 v34, v34
    v_mfma_f32_32x32x8_bf16 v[12:27], v[128:129], v[202:203], 0
    v_exp_f32 v35, v35
    v_exp_f32 v36, v36
    v_exp_f32 v37, v37
    v_exp_f32 v38, v38
    v_exp_f32 v39, v39
    v_smfmac_f32_32x32x32_bf16 v[60:75], v[156:159], v[28:35], v2
    v_exp_f32 v40, v40
    v_exp_f32 v41, v41
    v_exp_f32 v42, v42
    v_exp_f32 v43, v43
    s_setprio 2
    s_waitcnt lgkmcnt(0)
    v_cmp_eq_u32 vcc, 0, v10
    s_cbranch_vccnz P4_RT16
P4_BK16:
    v_mfma_f32_32x32x16_bf16 v[12:27], v[112:115], v[196:199], v[12:27]
    v_exp_f32 v44, v44
    v_add_f32 v84, v84, v85
    v_add_f32 v76, v76, v77
    v_add_f32 v78, v78, v79
    v_exp_f32 v45, v45
    v_add_f32_dpp v84, v84, v84 quad_perm:[1,0,3,2] row_mask:0xf bank_mask:0xf
    v_add_f32 v80, v80, v81
    v_add_f32 v82, v82, v83
    v_exp_f32 v46, v46
    v_exp_f32 v47, v47
    v_smfmac_f32_32x32x32_bf16 v[60:75], v[160:163], v[36:43], v2
    v_add_f32_dpp v84, v84, v84 quad_perm:[2,3,0,1] row_mask:0xf bank_mask:0xf
    v_add_f32 v76, v76, v78
    v_add_f32 v80, v80, v82
    v_exp_f32 v48, v48
    v_add_f32 v76, v76, v80
    v_exp_f32 v49, v49
    v_exp_f32 v50, v50
    s_waitcnt vmcnt(4)
    v_mfma_f32_32x32x8_bf16 v[28:43], v[130:131], v[200:201], 0
    v_rcp_f32 v78, v84
    v_exp_f32 v51, v51
    v_exp_f32 v52, v52
    v_mul_f32_dpp v76, v78, v76 row_newbcast:8 row_mask:0xf bank_mask:0xf
    v_mul_f32_dpp v84, v78, v84 row_newbcast:8 row_mask:0xf bank_mask:0xf
    v_cvt_pk_bf16_f32 v76, v76, v84
    v_exp_f32 v53, v53
    v_exp_f32 v54, v54
    v_smfmac_f32_16x16x64_bf16 v[216:219], v[224:227], v[228:235], v8
    v_exp_f32 v55, v55
    ds_write_b16 v7, v76 offset:17408
    s_mov_b64 exec, s[30:31]
    ds_write_b16_d16_hi v7, v76 offset:24702
    s_mov_b64 exec, 1
    ds_write_b32 v6, v2 offset:26144
    s_mov_b64 exec, -1
    s_add_u32 s46, s24, 77824
    buffer_load_dwordx4 v[228:231], v3, s[8:11], s46 offen offset:0
    v_smfmac_f32_32x32x32_bf16 v[60:75], v[164:167], v[44:51], v2
    v_exp_f32 v56, v56
    v_exp_f32 v57, v57
    v_exp_f32 v58, v58
    v_exp_f32 v59, v59
    s_setprio 1
    buffer_load_dwordx4 v[232:235], v3, s[8:11], s46 offen offset:1024
    v_mfma_f32_32x32x16_bf16 v[28:43], v[116:119], v[196:199], v[28:43]
    v_exp_f32 v12, v12
    v_exp_f32 v13, v13
    v_exp_f32 v14, v14
    v_exp_f32 v15, v15
    v_smfmac_f32_32x32x32_bf16 v[60:75], v[168:171], v[52:59], v2
    v_exp_f32 v16, v16
    v_exp_f32 v17, v17
    v_exp_f32 v18, v18
    ds_read_b128 v[76:79], v252
    ds_read_b128 v[80:83], v252
    ds_read_b128 v[84:87], v252
    v_mfma_f32_32x32x8_bf16 v[44:59], v[130:131], v[202:203], 0
    v_exp_f32 v19, v19
    v_exp_f32 v20, v20
    v_exp_f32 v21, v21
    v_exp_f32 v22, v22
    v_exp_f32 v23, v23
    ds_read_b128 v[200:203], v9 offset:7168
    v_smfmac_f32_32x32x32_bf16 v[60:75], v[172:175], v[12:19], v2
    v_exp_f32 v24, v24
    v_exp_f32 v25, v25
    v_exp_f32 v26, v26
    v_exp_f32 v27, v27
    s_setprio 0
    ds_read_b32 v10, v0 offset:26144
    ds_read_b128 v[224:227], v9 offset:17408
    v_mfma_f32_32x32x16_bf16 v[44:59], v[120:123], v[196:199], v[44:59]
    v_exp_f32 v28, v28
    v_exp_f32 v29, v29
    v_exp_f32 v30, v30
    v_exp_f32 v31, v31
    ds_read_b128 v[196:199], v9 offset:6144
    s_cmp_lg_u32 s45, 0
    s_cbranch_scc1 P4_NP122
    s_add_u32 m0, s6, 16384
    s_add_u32 s27, s25, 14336
    buffer_load_dwordx4 v3, s[8:11], s27 offen lds
P4_NP122:
    v_smfmac_f32_32x32x32_bf16 v[60:75], v[176:179], v[20:27], v2
    v_exp_f32 v32, v32
    v_exp_f32 v33, v33
    v_exp_f32 v34, v34
    s_waitcnt lgkmcnt(1)
    v_cmp_eq_u32 vcc, 0, v10
    s_cbranch_vccnz P4_RT17
P4_BK17:
    s_waitcnt vmcnt(4)
    v_mfma_f32_32x32x8_bf16 v[12:27], v[124:125], v[200:201], 0
    v_exp_f32 v35, v35
    v_exp_f32 v36, v36
    v_exp_f32 v37, v37
    v_exp_f32 v38, v38
    v_smfmac_f32_16x16x64_bf16 v[204:207], v[224:227], v[236:243], v8
    v_exp_f32 v39, v39
    s_add_u32 s46, s24, 79872
    buffer_load_dwordx4 v[236:239], v3, s[8:11], s46 offen offset:0
    v_smfmac_f32_32x32x32_bf16 v[60:75], v[180:183], v[28:35], v2
    v_exp_f32 v40, v40
    v_exp_f32 v41, v41
    v_exp_f32 v42, v42
    v_exp_f32 v43, v43
    s_setprio 3
    s_waitcnt lgkmcnt(0)
    buffer_load_dwordx4 v[240:243], v3, s[8:11], s46 offen offset:1024
    v_mfma_f32_32x32x16_bf16 v[12:27], v[92:95], v[196:199], v[12:27]
    v_exp_f32 v44, v44
    v_exp_f32 v45, v45
    v_exp_f32 v46, v46
    v_exp_f32 v47, v47
    v_smfmac_f32_32x32x32_bf16 v[60:75], v[184:187], v[36:43], v2
    v_exp_f32 v48, v48
    v_exp_f32 v49, v49
    v_exp_f32 v50, v50
    v_mfma_f32_32x32x8_bf16 v[28:43], v[124:125], v[202:203], 0
    v_exp_f32 v51, v51
    v_exp_f32 v52, v52
    v_exp_f32 v53, v53
    v_exp_f32 v54, v54
    v_exp_f32 v55, v55
    v_smfmac_f32_32x32x32_bf16 v[60:75], v[188:191], v[44:51], v2
    v_exp_f32 v56, v56
    v_exp_f32 v57, v57
    v_exp_f32 v58, v58
    v_exp_f32 v59, v59
    s_setprio 2
    v_mfma_f32_32x32x16_bf16 v[28:43], v[96:99], v[196:199], v[28:43]
    v_exp_f32 v12, v12
    v_exp_f32 v13, v13
    v_exp_f32 v14, v14
    v_exp_f32 v15, v15
    v_smfmac_f32_32x32x32_bf16 v[60:75], v[192:195], v[52:59], v2
    v_exp_f32 v16, v16
    v_exp_f32 v17, v17
    v_exp_f32 v18, v18
    s_waitcnt vmcnt(4)
    v_mfma_f32_32x32x8_bf16 v[44:59], v[126:127], v[200:201], 0
    v_exp_f32 v19, v19
    v_exp_f32 v20, v20
    v_exp_f32 v21, v21
    v_exp_f32 v22, v22
    v_smfmac_f32_16x16x64_bf16 v[208:211], v[224:227], v[244:251], v8
    v_exp_f32 v23, v23
    s_add_u32 s46, s24, 147456
    buffer_load_dwordx4 v[244:247], v3, s[8:11], s46 offen offset:0
    v_smfmac_f32_32x32x32_bf16 v[76:91], v[132:135], v[12:19], v2
    v_exp_f32 v24, v24
    v_exp_f32 v25, v25
    v_exp_f32 v26, v26
    v_exp_f32 v27, v27
    s_setprio 1
    ds_write_b128 v4, v[60:63] offset:32768
    buffer_load_dwordx4 v[248:251], v3, s[8:11], s46 offen offset:1024
    v_mfma_f32_32x32x16_bf16 v[44:59], v[100:103], v[196:199], v[44:59]
    v_exp_f32 v28, v28
    v_exp_f32 v29, v29
    v_exp_f32 v30, v30
    v_exp_f32 v31, v31
    s_cmp_lg_u32 s45, 0
    s_cbranch_scc1 P4_NP125
    s_add_u32 m0, s6, 24576
    s_add_u32 s27, s25, 21504
    buffer_load_dwordx4 v3, s[8:11], s27 offen lds
P4_NP125:
    v_smfmac_f32_32x32x32_bf16 v[76:91], v[136:139], v[20:27], v2
    v_exp_f32 v32, v32
    v_exp_f32 v33, v33
    v_exp_f32 v34, v34
    ds_write_b128 v4, v[64:67] offset:32800
    v_mfma_f32_32x32x8_bf16 v[12:27], v[126:127], v[202:203], 0
    v_exp_f32 v35, v35
    v_exp_f32 v36, v36
    v_exp_f32 v37, v37
    v_exp_f32 v38, v38
    v_exp_f32 v39, v39
    ds_write_b128 v4, v[68:71] offset:32832
    s_mov_b64 exec, 1
    ds_write_b32 v6, v2 offset:25920
    s_mov_b64 exec, -1
    v_smfmac_f32_32x32x32_bf16 v[76:91], v[140:143], v[28:35], v2
    v_exp_f32 v40, v40
    v_exp_f32 v41, v41
    v_exp_f32 v42, v42
    v_exp_f32 v43, v43
    s_setprio 0
    v_mfma_f32_32x32x16_bf16 v[12:27], v[104:107], v[196:199], v[12:27]
    v_exp_f32 v44, v44
    v_exp_f32 v45, v45
    v_exp_f32 v46, v46
    v_exp_f32 v47, v47
    v_smfmac_f32_32x32x32_bf16 v[76:91], v[144:147], v[36:43], v2
    v_exp_f32 v48, v48
    v_exp_f32 v49, v49
    v_exp_f32 v50, v50
    s_waitcnt vmcnt(4)
    v_mfma_f32_32x32x8_bf16 v[28:43], v[128:129], v[200:201], 0
    v_exp_f32 v51, v51
    v_exp_f32 v52, v52
    v_exp_f32 v53, v53
    v_exp_f32 v54, v54
    v_smfmac_f32_16x16x64_bf16 v[212:215], v[224:227], v[228:235], v8
    v_exp_f32 v55, v55
    s_add_u32 s46, s24, 149504
    buffer_load_dwordx4 v[228:231], v3, s[8:11], s46 offen offset:0
    v_smfmac_f32_32x32x32_bf16 v[76:91], v[148:151], v[44:51], v2
    v_exp_f32 v56, v56
    v_exp_f32 v57, v57
    v_exp_f32 v58, v58
    v_exp_f32 v59, v59
    s_setprio 3
    buffer_load_dwordx4 v[232:235], v3, s[8:11], s46 offen offset:1024
    v_mfma_f32_32x32x16_bf16 v[28:43], v[108:111], v[196:199], v[28:43]
    v_exp_f32 v12, v12
    v_exp_f32 v13, v13
    v_exp_f32 v14, v14
    v_exp_f32 v15, v15
    ds_read_b32 v10, v0 offset:25920
    ds_read2st64_b32 v[68:69], v253 offset0:128 offset1:142
    ds_read2st64_b32 v[60:61], v5 offset0:128 offset1:142
    ds_read2st64_b32 v[62:63], v5 offset0:156 offset1:170
    ds_read2st64_b32 v[64:65], v5 offset0:184 offset1:198
    ds_read2st64_b32 v[66:67], v5 offset0:212 offset1:226
    v_smfmac_f32_32x32x32_bf16 v[76:91], v[152:155], v[52:59], v2
    v_exp_f32 v16, v16
    v_exp_f32 v17, v17
    v_exp_f32 v18, v18
    v_mfma_f32_32x32x8_bf16 v[44:59], v[128:129], v[202:203], 0
    v_exp_f32 v19, v19
    v_exp_f32 v20, v20
    v_exp_f32 v21, v21
    v_exp_f32 v22, v22
    v_exp_f32 v23, v23
    v_smfmac_f32_32x32x32_bf16 v[76:91], v[156:159], v[12:19], v2
    v_exp_f32 v24, v24
    v_exp_f32 v25, v25
    v_exp_f32 v26, v26
    v_exp_f32 v27, v27
    s_setprio 2
    s_waitcnt lgkmcnt(0)
    v_cmp_eq_u32 vcc, 0, v10
    s_cbranch_vccnz P4_RT18
P4_BK18:
    v_mfma_f32_32x32x16_bf16 v[44:59], v[112:115], v[196:199], v[44:59]
    v_exp_f32 v28, v28
    v_add_f32 v68, v68, v69
    v_add_f32 v60, v60, v61
    v_add_f32 v62, v62, v63
    v_exp_f32 v29, v29
    v_add_f32_dpp v68, v68, v68 quad_perm:[1,0,3,2] row_mask:0xf bank_mask:0xf
    v_add_f32 v64, v64, v65
    v_add_f32 v66, v66, v67
    v_exp_f32 v30, v30
    v_exp_f32 v31, v31
    s_cmp_lg_u32 s45, 0
    s_cbranch_scc1 P4_NP128
    s_add_u32 m0, s6, 32768
    s_add_u32 s27, s25, 28672
    buffer_load_dwordx4 v3, s[8:11], s27 offen lds
P4_NP128:
    v_smfmac_f32_32x32x32_bf16 v[76:91], v[160:163], v[20:27], v2
    v_add_f32_dpp v68, v68, v68 quad_perm:[2,3,0,1] row_mask:0xf bank_mask:0xf
    v_add_f32 v60, v60, v62
    v_add_f32 v64, v64, v66
    v_exp_f32 v32, v32
    v_add_f32 v60, v60, v64
    v_exp_f32 v33, v33
    v_exp_f32 v34, v34
    s_waitcnt vmcnt(4)
    v_mfma_f32_32x32x8_bf16 v[12:27], v[130:131], v[200:201], 0
    v_rcp_f32 v62, v68
    v_exp_f32 v35, v35
    v_exp_f32 v36, v36
    v_mul_f32_dpp v60, v62, v60 row_newbcast:8 row_mask:0xf bank_mask:0xf
    v_mul_f32_dpp v68, v62, v68 row_newbcast:8 row_mask:0xf bank_mask:0xf
    v_cvt_pk_bf16_f32 v60, v60, v68
    v_exp_f32 v37, v37
    v_exp_f32 v38, v38
    v_smfmac_f32_16x16x64_bf16 v[216:219], v[224:227], v[236:243], v8
    v_exp_f32 v39, v39
    ds_write_b16 v7, v60 offset:18432
    s_mov_b64 exec, s[30:31]
    ds_write_b16_d16_hi v7, v60 offset:24578
    s_mov_b64 exec, 1
    ds_write_b32 v6, v2 offset:26176
    s_mov_b64 exec, -1
    s_add_u32 s46, s24, 151552
    buffer_load_dwordx4 v[236:239], v3, s[8:11], s46 offen offset:0
    v_smfmac_f32_32x32x32_bf16 v[76:91], v[164:167], v[28:35], v2
    v_exp_f32 v40, v40
    v_exp_f32 v41, v41
    v_exp_f32 v42, v42
    v_exp_f32 v43, v43
    s_setprio 1
    buffer_load_dwordx4 v[240:243], v3, s[8:11], s46 offen offset:1024
    v_mfma_f32_32x32x16_bf16 v[12:27], v[116:119], v[196:199], v[12:27]
    v_exp_f32 v44, v44
    v_exp_f32 v45, v45
    v_exp_f32 v46, v46
    v_exp_f32 v47, v47
    v_smfmac_f32_32x32x32_bf16 v[76:91], v[168:171], v[36:43], v2
    v_exp_f32 v48, v48
    v_exp_f32 v49, v49
    v_exp_f32 v50, v50
    ds_read_b128 v[60:63], v252
    ds_read_b128 v[64:67], v252
    ds_read_b128 v[68:71], v252
    v_mfma_f32_32x32x8_bf16 v[28:43], v[130:131], v[202:203], 0
    v_exp_f32 v51, v51
    v_exp_f32 v52, v52
    v_exp_f32 v53, v53
    v_exp_f32 v54, v54
    v_exp_f32 v55, v55
    ds_read_b128 v[200:203], v9 offset:9216
    v_smfmac_f32_32x32x32_bf16 v[76:91], v[172:175], v[44:51], v2
    v_exp_f32 v56, v56
    v_exp_f32 v57, v57
    v_exp_f32 v58, v58
    v_exp_f32 v59, v59
    s_setprio 0
    ds_read_b32 v10, v0 offset:26176
    ds_read_b128 v[224:227], v9 offset:18432
    v_mfma_f32_32x32x16_bf16 v[28:43], v[120:123], v[196:199], v[28:43]
    v_exp_f32 v12, v12
    v_exp_f32 v13, v13
    v_exp_f32 v14, v14
    v_exp_f32 v15, v15
    ds_read_b128 v[196:199], v9 offset:8192
    v_smfmac_f32_32x32x32_bf16 v[76:91], v[176:179], v[52:59], v2
    v_exp_f32 v16, v16
    v_exp_f32 v17, v17
    v_exp_f32 v18, v18
    s_waitcnt lgkmcnt(1)
    v_cmp_eq_u32 vcc, 0, v10
    s_cbranch_vccnz P4_RT19
P4_BK19:
    s_waitcnt vmcnt(4)
    v_mfma_f32_32x32x8_bf16 v[44:59], v[124:125], v[200:201], 0
    v_exp_f32 v19, v19
    v_exp_f32 v20, v20
    v_exp_f32 v21, v21
    v_exp_f32 v22, v22
    v_smfmac_f32_16x16x64_bf16 v[204:207], v[224:227], v[244:251], v8
    v_exp_f32 v23, v23
    s_add_u32 s46, s24, 153600
    buffer_load_dwordx4 v[244:247], v3, s[8:11], s46 offen offset:0
    v_smfmac_f32_32x32x32_bf16 v[76:91], v[180:183], v[12:19], v2
    v_exp_f32 v24, v24
    v_exp_f32 v25, v25
    v_exp_f32 v26, v26
    v_exp_f32 v27, v27
    s_setprio 3
    s_waitcnt lgkmcnt(0)
    buffer_load_dwordx4 v[248:251], v3, s[8:11], s46 offen offset:1024
    v_mfma_f32_32x32x16_bf16 v[44:59], v[92:95], v[196:199], v[44:59]
    v_exp_f32 v28, v28
    v_exp_f32 v29, v29
    v_exp_f32 v30, v30
    v_exp_f32 v31, v31
    s_cmp_lg_u32 s45, 0
    s_cbranch_scc1 P4_NP131
    s_add_u32 m0, s6, 40960
    s_add_u32 s27, s25, 35840
    buffer_load_dwordx4 v3, s[8:11], s27 offen lds
P4_NP131:
    v_smfmac_f32_32x32x32_bf16 v[76:91], v[184:187], v[20:27], v2
    v_exp_f32 v32, v32
    v_exp_f32 v33, v33
    v_exp_f32 v34, v34
    v_mfma_f32_32x32x8_bf16 v[12:27], v[124:125], v[202:203], 0
    v_exp_f32 v35, v35
    v_exp_f32 v36, v36
    v_exp_f32 v37, v37
    v_exp_f32 v38, v38
    v_exp_f32 v39, v39
    v_smfmac_f32_32x32x32_bf16 v[76:91], v[188:191], v[28:35], v2
    v_exp_f32 v40, v40
    v_exp_f32 v41, v41
    v_exp_f32 v42, v42
    v_exp_f32 v43, v43
    s_setprio 2
    v_mfma_f32_32x32x16_bf16 v[12:27], v[96:99], v[196:199], v[12:27]
    v_exp_f32 v44, v44
    v_exp_f32 v45, v45
    v_exp_f32 v46, v46
    v_exp_f32 v47, v47
    v_smfmac_f32_32x32x32_bf16 v[76:91], v[192:195], v[36:43], v2
    v_exp_f32 v48, v48
    v_exp_f32 v49, v49
    v_exp_f32 v50, v50
    s_waitcnt vmcnt(4)
    v_mfma_f32_32x32x8_bf16 v[28:43], v[126:127], v[200:201], 0
    v_exp_f32 v51, v51
    v_exp_f32 v52, v52
    v_exp_f32 v53, v53
    v_exp_f32 v54, v54
    v_smfmac_f32_16x16x64_bf16 v[208:211], v[224:227], v[228:235], v8
    v_exp_f32 v55, v55
    s_add_u32 s46, s24, 221184
    buffer_load_dwordx4 v[228:231], v3, s[8:11], s46 offen offset:0
    v_smfmac_f32_32x32x32_bf16 v[60:75], v[132:135], v[44:51], v2
    v_exp_f32 v56, v56
    v_exp_f32 v57, v57
    v_exp_f32 v58, v58
    v_exp_f32 v59, v59
    s_setprio 1
    ds_write_b128 v4, v[76:79] offset:32768
    buffer_load_dwordx4 v[232:235], v3, s[8:11], s46 offen offset:1024
    v_mfma_f32_32x32x16_bf16 v[28:43], v[100:103], v[196:199], v[28:43]
    v_exp_f32 v12, v12
    v_exp_f32 v13, v13
    v_exp_f32 v14, v14
    v_exp_f32 v15, v15
    v_smfmac_f32_32x32x32_bf16 v[60:75], v[136:139], v[52:59], v2
    v_exp_f32 v16, v16
    v_exp_f32 v17, v17
    v_exp_f32 v18, v18
    ds_write_b128 v4, v[80:83] offset:32800
    v_mfma_f32_32x32x8_bf16 v[44:59], v[126:127], v[202:203], 0
    v_exp_f32 v19, v19
    v_exp_f32 v20, v20
    v_exp_f32 v21, v21
    v_exp_f32 v22, v22
    v_exp_f32 v23, v23
    ds_write_b128 v4, v[84:87] offset:32832
    s_mov_b64 exec, 1
    ds_write_b32 v6, v2 offset:25952
    s_mov_b64 exec, -1
    v_smfmac_f32_32x32x32_bf16 v[60:75], v[140:143], v[12:19], v2
    v_exp_f32 v24, v24
    v_exp_f32 v25, v25
    v_exp_f32 v26, v26
    v_exp_f32 v27, v27
    s_setprio 0
    v_mfma_f32_32x32x16_bf16 v[44:59], v[104:107], v[196:199], v[44:59]
    v_exp_f32 v28, v28
    v_exp_f32 v29, v29
    v_exp_f32 v30, v30
    v_exp_f32 v31, v31
    s_cmp_lg_u32 s45, 0
    s_cbranch_scc1 P4_NP134
    s_add_u32 m0, s6, 49152
    s_add_u32 s27, s25, 43008
    buffer_load_dwordx4 v3, s[8:11], s27 offen lds
P4_NP134:
    v_smfmac_f32_32x32x32_bf16 v[60:75], v[144:147], v[20:27], v2
    v_exp_f32 v32, v32
    v_exp_f32 v33, v33
    v_exp_f32 v34, v34
    s_waitcnt vmcnt(4)
    v_mfma_f32_32x32x8_bf16 v[12:27], v[128:129], v[200:201], 0
    v_exp_f32 v35, v35
    v_exp_f32 v36, v36
    v_exp_f32 v37, v37
    v_exp_f32 v38, v38
    v_smfmac_f32_16x16x64_bf16 v[212:215], v[224:227], v[236:243], v8
    v_exp_f32 v39, v39
    s_add_u32 s46, s24, 223232
    buffer_load_dwordx4 v[236:239], v3, s[8:11], s46 offen offset:0
    v_smfmac_f32_32x32x32_bf16 v[60:75], v[148:151], v[28:35], v2
    v_exp_f32 v40, v40
    v_exp_f32 v41, v41
    v_exp_f32 v42, v42
    v_exp_f32 v43, v43
    s_setprio 3
    buffer_load_dwordx4 v[240:243], v3, s[8:11], s46 offen offset:1024
    v_mfma_f32_32x32x16_bf16 v[12:27], v[108:111], v[196:199], v[12:27]
    v_exp_f32 v44, v44
    v_exp_f32 v45, v45
    v_exp_f32 v46, v46
    v_exp_f32 v47, v47
    ds_read_b32 v10, v0 offset:25952
    ds_read2st64_b32 v[84:85], v253 offset0:128 offset1:142
    ds_read2st64_b32 v[76:77], v5 offset0:128 offset1:142
    ds_read2st64_b32 v[78:79], v5 offset0:156 offset1:170
    ds_read2st64_b32 v[80:81], v5 offset0:184 offset1:198
    ds_read2st64_b32 v[82:83], v5 offset0:212 offset1:226
    v_smfmac_f32_32x32x32_bf16 v[60:75], v[152:155], v[36:43], v2
    v_exp_f32 v48, v48
    v_exp_f32 v49, v49
    v_exp_f32 v50, v50
    v_mfma_f32_32x32x8_bf16 v[28:43], v[128:129], v[202:203], 0
    v_exp_f32 v51, v51
    v_exp_f32 v52, v52
    v_exp_f32 v53, v53
    v_exp_f32 v54, v54
    v_exp_f32 v55, v55
    v_smfmac_f32_32x32x32_bf16 v[60:75], v[156:159], v[44:51], v2
    v_exp_f32 v56, v56
    v_exp_f32 v57, v57
    v_exp_f32 v58, v58
    v_exp_f32 v59, v59
    s_setprio 2
    s_waitcnt lgkmcnt(0)
    v_cmp_eq_u32 vcc, 0, v10
    s_cbranch_vccnz P4_RT20
P4_BK20:
    v_mfma_f32_32x32x16_bf16 v[28:43], v[112:115], v[196:199], v[28:43]
    v_exp_f32 v12, v12
    v_add_f32 v84, v84, v85
    v_add_f32 v76, v76, v77
    v_add_f32 v78, v78, v79
    v_exp_f32 v13, v13
    v_add_f32_dpp v84, v84, v84 quad_perm:[1,0,3,2] row_mask:0xf bank_mask:0xf
    v_add_f32 v80, v80, v81
    v_add_f32 v82, v82, v83
    v_exp_f32 v14, v14
    v_exp_f32 v15, v15
    v_smfmac_f32_32x32x32_bf16 v[60:75], v[160:163], v[52:59], v2
    v_add_f32_dpp v84, v84, v84 quad_perm:[2,3,0,1] row_mask:0xf bank_mask:0xf
    v_add_f32 v76, v76, v78
    v_add_f32 v80, v80, v82
    v_exp_f32 v16, v16
    v_add_f32 v76, v76, v80
    v_exp_f32 v17, v17
    v_exp_f32 v18, v18
    s_waitcnt vmcnt(4)
    v_mfma_f32_32x32x8_bf16 v[44:59], v[130:131], v[200:201], 0
    v_rcp_f32 v78, v84
    v_exp_f32 v19, v19
    v_exp_f32 v20, v20
    v_mul_f32_dpp v76, v78, v76 row_newbcast:8 row_mask:0xf bank_mask:0xf
    v_mul_f32_dpp v84, v78, v84 row_newbcast:8 row_mask:0xf bank_mask:0xf
    v_cvt_pk_bf16_f32 v76, v76, v84
    v_exp_f32 v21, v21
    v_exp_f32 v22, v22
    v_smfmac_f32_16x16x64_bf16 v[216:219], v[224:227], v[244:251], v8
    v_exp_f32 v23, v23
    ds_write_b16 v7, v76 offset:19456
    s_mov_b64 exec, s[30:31]
    ds_write_b16_d16_hi v7, v76 offset:24706
    s_mov_b64 exec, 1
    ds_write_b32 v6, v2 offset:26208
    s_mov_b64 exec, -1
    s_add_u32 s46, s24, 225280
    buffer_load_dwordx4 v[244:247], v3, s[8:11], s46 offen offset:0
    v_smfmac_f32_32x32x32_bf16 v[60:75], v[164:167], v[12:19], v2
    v_exp_f32 v24, v24
    v_exp_f32 v25, v25
    v_exp_f32 v26, v26
    v_exp_f32 v27, v27
    s_setprio 1
    buffer_load_dwordx4 v[248:251], v3, s[8:11], s46 offen offset:1024
    v_mfma_f32_32x32x16_bf16 v[44:59], v[116:119], v[196:199], v[44:59]
    v_exp_f32 v28, v28
    v_exp_f32 v29, v29
    v_exp_f32 v30, v30
    v_exp_f32 v31, v31
    s_cmp_lg_u32 s45, 0
    s_cbranch_scc1 P4_NP137
    s_add_u32 m0, s6, 57344
    s_add_u32 s27, s25, 50176
    buffer_load_dwordx4 v3, s[8:11], s27 offen lds
P4_NP137:
    v_smfmac_f32_32x32x32_bf16 v[60:75], v[168:171], v[20:27], v2
    v_exp_f32 v32, v32
    v_exp_f32 v33, v33
    v_exp_f32 v34, v34
    ds_read_b128 v[76:79], v252
    ds_read_b128 v[80:83], v252
    ds_read_b128 v[84:87], v252
    v_mfma_f32_32x32x8_bf16 v[12:27], v[130:131], v[202:203], 0
    v_exp_f32 v35, v35
    v_exp_f32 v36, v36
    v_exp_f32 v37, v37
    v_exp_f32 v38, v38
    v_exp_f32 v39, v39
    ds_read_b128 v[200:203], v9 offset:11264
    v_smfmac_f32_32x32x32_bf16 v[60:75], v[172:175], v[28:35], v2
    v_exp_f32 v40, v40
    v_exp_f32 v41, v41
    v_exp_f32 v42, v42
    v_exp_f32 v43, v43
    s_setprio 0
    ds_read_b32 v10, v0 offset:26208
    ds_read_b128 v[224:227], v9 offset:19456
    v_mfma_f32_32x32x16_bf16 v[12:27], v[120:123], v[196:199], v[12:27]
    v_exp_f32 v44, v44
    v_exp_f32 v45, v45
    v_exp_f32 v46, v46
    v_exp_f32 v47, v47
    ds_read_b128 v[196:199], v9 offset:10240
    v_smfmac_f32_32x32x32_bf16 v[60:75], v[176:179], v[36:43], v2
    v_exp_f32 v48, v48
    v_exp_f32 v49, v49
    v_exp_f32 v50, v50
    s_waitcnt lgkmcnt(1)
    v_cmp_eq_u32 vcc, 0, v10
    s_cbranch_vccnz P4_RT21
P4_BK21:
    s_waitcnt vmcnt(4)
    v_mfma_f32_32x32x8_bf16 v[28:43], v[124:125], v[200:201], 0
    v_exp_f32 v51, v51
    v_exp_f32 v52, v52
    v_exp_f32 v53, v53
    v_exp_f32 v54, v54
    v_smfmac_f32_16x16x64_bf16 v[204:207], v[224:227], v[228:235], v8
    v_exp_f32 v55, v55
    s_add_u32 s46, s24, 227328
    buffer_load_dwordx4 v[228:231], v3, s[8:11], s46 offen offset:0
    v_smfmac_f32_32x32x32_bf16 v[60:75], v[180:183], v[44:51], v2
    v_exp_f32 v56, v56
    v_exp_f32 v57, v57
    v_exp_f32 v58, v58
    v_exp_f32 v59, v59
    s_setprio 3
    s_waitcnt lgkmcnt(0)
    buffer_load_dwordx4 v[232:235], v3, s[8:11], s46 offen offset:1024
    v_mfma_f32_32x32x16_bf16 v[28:43], v[92:95], v[196:199], v[28:43]
    v_exp_f32 v12, v12
    v_exp_f32 v13, v13
    v_exp_f32 v14, v14
    v_exp_f32 v15, v15
    v_smfmac_f32_32x32x32_bf16 v[60:75], v[184:187], v[52:59], v2
    v_exp_f32 v16, v16
    v_exp_f32 v17, v17
    v_exp_f32 v18, v18
    v_mfma_f32_32x32x8_bf16 v[44:59], v[124:125], v[202:203], 0
    v_exp_f32 v19, v19
    v_exp_f32 v20, v20
    v_exp_f32 v21, v21
    v_exp_f32 v22, v22
    v_exp_f32 v23, v23
    v_smfmac_f32_32x32x32_bf16 v[60:75], v[188:191], v[12:19], v2
    v_exp_f32 v24, v24
    v_exp_f32 v25, v25
    v_exp_f32 v26, v26
    v_exp_f32 v27, v27
    s_setprio 2
    v_mfma_f32_32x32x16_bf16 v[44:59], v[96:99], v[196:199], v[44:59]
    v_exp_f32 v28, v28
    v_exp_f32 v29, v29
    v_exp_f32 v30, v30
    v_exp_f32 v31, v31
    s_cmp_lg_u32 s45, 0
    s_cbranch_scc1 P4_NP140
    s_add_u32 m0, s6, 65536
    s_add_u32 s27, s25, 57344
    buffer_load_dwordx4 v3, s[8:11], s27 offen lds
P4_NP140:
    v_smfmac_f32_32x32x32_bf16 v[60:75], v[192:195], v[20:27], v2
    v_exp_f32 v32, v32
    v_exp_f32 v33, v33
    v_exp_f32 v34, v34
    s_waitcnt vmcnt(4)
    v_mfma_f32_32x32x8_bf16 v[12:27], v[126:127], v[200:201], 0
    v_exp_f32 v35, v35
    v_exp_f32 v36, v36
    v_exp_f32 v37, v37
    v_exp_f32 v38, v38
    v_smfmac_f32_16x16x64_bf16 v[208:211], v[224:227], v[236:243], v8
    v_exp_f32 v39, v39
    s_add_u32 s46, s24, 294912
    buffer_load_dwordx4 v[236:239], v3, s[8:11], s46 offen offset:0
    v_smfmac_f32_32x32x32_bf16 v[76:91], v[132:135], v[28:35], v2
    v_exp_f32 v40, v40
    v_exp_f32 v41, v41
    v_exp_f32 v42, v42
    v_exp_f32 v43, v43
    s_setprio 1
    ds_write_b128 v4, v[60:63] offset:32768
    buffer_load_dwordx4 v[240:243], v3, s[8:11], s46 offen offset:1024
    v_mfma_f32_32x32x16_bf16 v[12:27], v[100:103], v[196:199], v[12:27]
    v_exp_f32 v44, v44
    v_exp_f32 v45, v45
    v_exp_f32 v46, v46
    v_exp_f32 v47, v47
    v_smfmac_f32_32x32x32_bf16 v[76:91], v[136:139], v[36:43], v2
    v_exp_f32 v48, v48
    v_exp_f32 v49, v49
    v_exp_f32 v50, v50
    ds_write_b128 v4, v[64:67] offset:32800
    v_mfma_f32_32x32x8_bf16 v[28:43], v[126:127], v[202:203], 0
    v_exp_f32 v51, v51
    v_exp_f32 v52, v52
    v_exp_f32 v53, v53
    v_exp_f32 v54, v54
    v_exp_f32 v55, v55
    ds_write_b128 v4, v[68:71] offset:32832
    s_mov_b64 exec, 1
    ds_write_b32 v6, v2 offset:25984
    s_mov_b64 exec, -1
    v_smfmac_f32_32x32x32_bf16 v[76:91], v[140:143], v[44:51], v2
    v_exp_f32 v56, v56
    v_exp_f32 v57, v57
    v_exp_f32 v58, v58
    v_exp_f32 v59, v59
    s_setprio 0
    v_mfma_f32_32x32x16_bf16 v[28:43], v[104:107], v[196:199], v[28:43]
    v_exp_f32 v12, v12
    v_exp_f32 v13, v13
    v_exp_f32 v14, v14
    v_exp_f32 v15, v15
    v_smfmac_f32_32x32x32_bf16 v[76:91], v[144:147], v[52:59], v2
    v_exp_f32 v16, v16
    v_exp_f32 v17, v17
    v_exp_f32 v18, v18
    s_waitcnt vmcnt(4)
    v_mfma_f32_32x32x8_bf16 v[44:59], v[128:129], v[200:201], 0
    v_exp_f32 v19, v19
    v_exp_f32 v20, v20
    v_exp_f32 v21, v21
    v_exp_f32 v22, v22
    v_smfmac_f32_16x16x64_bf16 v[212:215], v[224:227], v[244:251], v8
    v_exp_f32 v23, v23
    s_add_u32 s46, s24, 296960
    buffer_load_dwordx4 v[244:247], v3, s[8:11], s46 offen offset:0
    v_smfmac_f32_32x32x32_bf16 v[76:91], v[148:151], v[12:19], v2
    v_exp_f32 v24, v24
    v_exp_f32 v25, v25
    v_exp_f32 v26, v26
    v_exp_f32 v27, v27
    s_setprio 3
    buffer_load_dwordx4 v[248:251], v3, s[8:11], s46 offen offset:1024
    v_mfma_f32_32x32x16_bf16 v[44:59], v[108:111], v[196:199], v[44:59]
    v_exp_f32 v28, v28
    v_exp_f32 v29, v29
    v_exp_f32 v30, v30
    v_exp_f32 v31, v31
    ds_read_b32 v10, v0 offset:25984
    ds_read2st64_b32 v[68:69], v253 offset0:128 offset1:142
    ds_read2st64_b32 v[60:61], v5 offset0:128 offset1:142
    ds_read2st64_b32 v[62:63], v5 offset0:156 offset1:170
    ds_read2st64_b32 v[64:65], v5 offset0:184 offset1:198
    ds_read2st64_b32 v[66:67], v5 offset0:212 offset1:226
    s_cmp_lg_u32 s45, 0
    s_cbranch_scc1 P4_NP143
    s_add_u32 m0, s6, 73728
    s_add_u32 s27, s25, 64512
    buffer_load_dwordx4 v3, s[8:11], s27 offen lds
P4_NP143:
    v_smfmac_f32_32x32x32_bf16 v[76:91], v[152:155], v[20:27], v2
    v_exp_f32 v32, v32
    v_exp_f32 v33, v33
    v_exp_f32 v34, v34
    v_mfma_f32_32x32x8_bf16 v[12:27], v[128:129], v[202:203], 0
    v_exp_f32 v35, v35
    v_exp_f32 v36, v36
    v_exp_f32 v37, v37
    v_exp_f32 v38, v38
    v_exp_f32 v39, v39
    v_smfmac_f32_32x32x32_bf16 v[76:91], v[156:159], v[28:35], v2
    v_exp_f32 v40, v40
    v_exp_f32 v41, v41
    v_exp_f32 v42, v42
    v_exp_f32 v43, v43
    s_setprio 2
    s_waitcnt lgkmcnt(0)
    v_cmp_eq_u32 vcc, 0, v10
    s_cbranch_vccnz P4_RT22
P4_BK22:
    v_mfma_f32_32x32x16_bf16 v[12:27], v[112:115], v[196:199], v[12:27]
    v_exp_f32 v44, v44
    v_add_f32 v68, v68, v69
    v_add_f32 v60, v60, v61
    v_add_f32 v62, v62, v63
    v_exp_f32 v45, v45
    v_add_f32_dpp v68, v68, v68 quad_perm:[1,0,3,2] row_mask:0xf bank_mask:0xf
    v_add_f32 v64, v64, v65
    v_add_f32 v66, v66, v67
    v_exp_f32 v46, v46
    v_exp_f32 v47, v47
    v_smfmac_f32_32x32x32_bf16 v[76:91], v[160:163], v[36:43], v2
    v_add_f32_dpp v68, v68, v68 quad_perm:[2,3,0,1] row_mask:0xf bank_mask:0xf
    v_add_f32 v60, v60, v62
    v_add_f32 v64, v64, v66
    v_exp_f32 v48, v48
    v_add_f32 v60, v60, v64
    v_exp_f32 v49, v49
    v_exp_f32 v50, v50
    s_waitcnt vmcnt(4)
    v_mfma_f32_32x32x8_bf16 v[28:43], v[130:131], v[200:201], 0
    v_rcp_f32 v62, v68
    v_exp_f32 v51, v51
    v_exp_f32 v52, v52
    v_mul_f32_dpp v60, v62, v60 row_newbcast:8 row_mask:0xf bank_mask:0xf
    v_mul_f32_dpp v68, v62, v68 row_newbcast:8 row_mask:0xf bank_mask:0xf
    v_cvt_pk_bf16_f32 v60, v60, v68
    v_exp_f32 v53, v53
    v_exp_f32 v54, v54
    v_smfmac_f32_16x16x64_bf16 v[216:219], v[224:227], v[228:235], v8
    v_exp_f32 v55, v55
    ds_write_b16 v7, v60 offset:20480
    s_mov_b64 exec, s[30:31]
    ds_write_b16_d16_hi v7, v60 offset:25086
    s_mov_b64 exec, 1
    ds_write_b32 v6, v2 offset:26240
    s_mov_b64 exec, -1
    s_add_u32 s46, s24, 299008
    buffer_load_dwordx4 v[228:231], v3, s[8:11], s46 offen offset:0
    v_smfmac_f32_32x32x32_bf16 v[76:91], v[164:167], v[44:51], v2
    v_exp_f32 v56, v56
    v_exp_f32 v57, v57
    v_exp_f32 v58, v58
    v_exp_f32 v59, v59
    s_setprio 1
    buffer_load_dwordx4 v[232:235], v3, s[8:11], s46 offen offset:1024
    v_mfma_f32_32x32x16_bf16 v[28:43], v[116:119], v[196:199], v[28:43]
    v_exp_f32 v12, v12
    v_exp_f32 v13, v13
    v_exp_f32 v14, v14
    v_exp_f32 v15, v15
    v_smfmac_f32_32x32x32_bf16 v[76:91], v[168:171], v[52:59], v2
    v_exp_f32 v16, v16
    v_exp_f32 v17, v17
    v_exp_f32 v18, v18
    ds_read_b128 v[60:63], v252
    ds_read_b128 v[64:67], v252
    ds_read_b128 v[68:71], v252
    v_mfma_f32_32x32x8_bf16 v[44:59], v[130:131], v[202:203], 0
    v_exp_f32 v19, v19
    v_exp_f32 v20, v20
    v_exp_f32 v21, v21
    v_exp_f32 v22, v22
    v_exp_f32 v23, v23
    ds_read_b128 v[200:203], v9 offset:13312
    v_smfmac_f32_32x32x32_bf16 v[76:91], v[172:175], v[12:19], v2
    v_exp_f32 v24, v24
    v_exp_f32 v25, v25
    v_exp_f32 v26, v26
    v_exp_f32 v27, v27
    s_setprio 0
    ds_read_b32 v10, v0 offset:26240
    ds_read_b128 v[224:227], v9 offset:20480
    v_mfma_f32_32x32x16_bf16 v[44:59], v[120:123], v[196:199], v[44:59]
    v_exp_f32 v28, v28
    v_exp_f32 v29, v29
    v_exp_f32 v30, v30
    v_exp_f32 v31, v31
    ds_read_b128 v[196:199], v9 offset:12288
    s_cmp_lg_u32 s45, 0
    s_cbranch_scc1 P4_NP146
    s_add_u32 m0, s6, 81920
    s_add_u32 s27, s25, 71680
    buffer_load_dwordx4 v3, s[8:11], s27 offen lds
P4_NP146:
    v_smfmac_f32_32x32x32_bf16 v[76:91], v[176:179], v[20:27], v2
    v_exp_f32 v32, v32
    v_exp_f32 v33, v33
    v_exp_f32 v34, v34
    s_waitcnt lgkmcnt(1)
    v_cmp_eq_u32 vcc, 0, v10
    s_cbranch_vccnz P4_RT23
P4_BK23:
    s_waitcnt vmcnt(4)
    v_mfma_f32_32x32x8_bf16 v[12:27], v[124:125], v[200:201], 0
    v_exp_f32 v35, v35
    v_exp_f32 v36, v36
    v_exp_f32 v37, v37
    v_exp_f32 v38, v38
    v_smfmac_f32_16x16x64_bf16 v[204:207], v[224:227], v[236:243], v8
    v_exp_f32 v39, v39
    s_add_u32 s46, s24, 301056
    buffer_load_dwordx4 v[236:239], v3, s[8:11], s46 offen offset:0
    v_smfmac_f32_32x32x32_bf16 v[76:91], v[180:183], v[28:35], v2
    v_exp_f32 v40, v40
    v_exp_f32 v41, v41
    v_exp_f32 v42, v42
    v_exp_f32 v43, v43
    s_setprio 3
    s_waitcnt lgkmcnt(0)
    buffer_load_dwordx4 v[240:243], v3, s[8:11], s46 offen offset:1024
    v_mfma_f32_32x32x16_bf16 v[12:27], v[92:95], v[196:199], v[12:27]
    v_exp_f32 v44, v44
    v_exp_f32 v45, v45
    v_exp_f32 v46, v46
    v_exp_f32 v47, v47
    v_smfmac_f32_32x32x32_bf16 v[76:91], v[184:187], v[36:43], v2
    v_exp_f32 v48, v48
    v_exp_f32 v49, v49
    v_exp_f32 v50, v50
    v_mfma_f32_32x32x8_bf16 v[28:43], v[124:125], v[202:203], 0
    v_exp_f32 v51, v51
    v_exp_f32 v52, v52
    v_exp_f32 v53, v53
    v_exp_f32 v54, v54
    v_exp_f32 v55, v55
    v_smfmac_f32_32x32x32_bf16 v[76:91], v[188:191], v[44:51], v2
    v_exp_f32 v56, v56
    v_exp_f32 v57, v57
    v_exp_f32 v58, v58
    v_exp_f32 v59, v59
    s_setprio 2
    v_mfma_f32_32x32x16_bf16 v[28:43], v[96:99], v[196:199], v[28:43]
    v_exp_f32 v12, v12
    v_exp_f32 v13, v13
    v_exp_f32 v14, v14
    v_exp_f32 v15, v15
    v_smfmac_f32_32x32x32_bf16 v[76:91], v[192:195], v[52:59], v2
    v_exp_f32 v16, v16
    v_exp_f32 v17, v17
    v_exp_f32 v18, v18
    s_waitcnt vmcnt(4)
    v_mfma_f32_32x32x8_bf16 v[44:59], v[126:127], v[200:201], 0
    v_exp_f32 v19, v19
    v_exp_f32 v20, v20
    v_exp_f32 v21, v21
    v_exp_f32 v22, v22
    v_smfmac_f32_16x16x64_bf16 v[208:211], v[224:227], v[244:251], v8
    v_exp_f32 v23, v23
    s_add_u32 s46, s24, 368640
    buffer_load_dwordx4 v[244:247], v3, s[8:11], s46 offen offset:0
    v_smfmac_f32_32x32x32_bf16 v[60:75], v[132:135], v[12:19], v2
    v_exp_f32 v24, v24
    v_exp_f32 v25, v25
    v_exp_f32 v26, v26
    v_exp_f32 v27, v27
    s_setprio 1
    ds_write_b128 v4, v[76:79] offset:32768
    buffer_load_dwordx4 v[248:251], v3, s[8:11], s46 offen offset:1024
    v_mfma_f32_32x32x16_bf16 v[44:59], v[100:103], v[196:199], v[44:59]
    v_exp_f32 v28, v28
    v_exp_f32 v29, v29
    v_exp_f32 v30, v30
    v_exp_f32 v31, v31
    s_cmp_lg_u32 s45, 0
    s_cbranch_scc1 P4_NP149
    s_add_u32 m0, s6, 90112
    s_add_u32 s27, s25, 78848
    buffer_load_dwordx4 v3, s[8:11], s27 offen lds
P4_NP149:
    v_smfmac_f32_32x32x32_bf16 v[60:75], v[136:139], v[20:27], v2
    v_exp_f32 v32, v32
    v_exp_f32 v33, v33
    v_exp_f32 v34, v34
    ds_write_b128 v4, v[80:83] offset:32800
    v_mfma_f32_32x32x8_bf16 v[12:27], v[126:127], v[202:203], 0
    v_exp_f32 v35, v35
    v_exp_f32 v36, v36
    v_exp_f32 v37, v37
    v_exp_f32 v38, v38
    v_exp_f32 v39, v39
    ds_write_b128 v4, v[84:87] offset:32832
    s_mov_b64 exec, 1
    ds_write_b32 v6, v2 offset:26016
    s_mov_b64 exec, -1
    v_smfmac_f32_32x32x32_bf16 v[60:75], v[140:143], v[28:35], v2
    v_exp_f32 v40, v40
    v_exp_f32 v41, v41
    v_exp_f32 v42, v42
    v_exp_f32 v43, v43
    s_setprio 0
    v_mfma_f32_32x32x16_bf16 v[12:27], v[104:107], v[196:199], v[12:27]
    v_exp_f32 v44, v44
    v_exp_f32 v45, v45
    v_exp_f32 v46, v46
    v_exp_f32 v47, v47
    v_smfmac_f32_32x32x32_bf16 v[60:75], v[144:147], v[36:43], v2
    v_exp_f32 v48, v48
    v_exp_f32 v49, v49
    v_exp_f32 v50, v50
    s_waitcnt vmcnt(4)
    v_mfma_f32_32x32x8_bf16 v[28:43], v[128:129], v[200:201], 0
    v_exp_f32 v51, v51
    v_exp_f32 v52, v52
    v_exp_f32 v53, v53
    v_exp_f32 v54, v54
    v_smfmac_f32_16x16x64_bf16 v[212:215], v[224:227], v[228:235], v8
    v_exp_f32 v55, v55
    s_add_u32 s46, s24, 370688
    buffer_load_dwordx4 v[228:231], v3, s[8:11], s46 offen offset:0
    v_smfmac_f32_32x32x32_bf16 v[60:75], v[148:151], v[44:51], v2
    v_exp_f32 v56, v56
    v_exp_f32 v57, v57
    v_exp_f32 v58, v58
    v_exp_f32 v59, v59
    s_setprio 3
    buffer_load_dwordx4 v[232:235], v3, s[8:11], s46 offen offset:1024
    v_mfma_f32_32x32x16_bf16 v[28:43], v[108:111], v[196:199], v[28:43]
    v_exp_f32 v12, v12
    v_exp_f32 v13, v13
    v_exp_f32 v14, v14
    v_exp_f32 v15, v15
    ds_read_b32 v10, v0 offset:26016
    ds_read2st64_b32 v[84:85], v253 offset0:128 offset1:142
    ds_read2st64_b32 v[76:77], v5 offset0:128 offset1:142
    ds_read2st64_b32 v[78:79], v5 offset0:156 offset1:170
    ds_read2st64_b32 v[80:81], v5 offset0:184 offset1:198
    ds_read2st64_b32 v[82:83], v5 offset0:212 offset1:226
    v_smfmac_f32_32x32x32_bf16 v[60:75], v[152:155], v[52:59], v2
    v_exp_f32 v16, v16
    v_exp_f32 v17, v17
    v_exp_f32 v18, v18
    v_mfma_f32_32x32x8_bf16 v[44:59], v[128:129], v[202:203], 0
    v_exp_f32 v19, v19
    v_exp_f32 v20, v20
    v_exp_f32 v21, v21
    v_exp_f32 v22, v22
    v_exp_f32 v23, v23
    v_smfmac_f32_32x32x32_bf16 v[60:75], v[156:159], v[12:19], v2
    v_exp_f32 v24, v24
    v_exp_f32 v25, v25
    v_exp_f32 v26, v26
    v_exp_f32 v27, v27
    s_setprio 2
    s_waitcnt lgkmcnt(0)
    v_cmp_eq_u32 vcc, 0, v10
    s_cbranch_vccnz P4_RT24
P4_BK24:
    v_mfma_f32_32x32x16_bf16 v[44:59], v[112:115], v[196:199], v[44:59]
    v_exp_f32 v28, v28
    v_add_f32 v84, v84, v85
    v_add_f32 v76, v76, v77
    v_add_f32 v78, v78, v79
    v_exp_f32 v29, v29
    v_add_f32_dpp v84, v84, v84 quad_perm:[1,0,3,2] row_mask:0xf bank_mask:0xf
    v_add_f32 v80, v80, v81
    v_add_f32 v82, v82, v83
    v_exp_f32 v30, v30
    v_exp_f32 v31, v31
    v_smfmac_f32_32x32x32_bf16 v[60:75], v[160:163], v[20:27], v2
    v_add_f32_dpp v84, v84, v84 quad_perm:[2,3,0,1] row_mask:0xf bank_mask:0xf
    v_add_f32 v76, v76, v78
    v_add_f32 v80, v80, v82
    v_exp_f32 v32, v32
    v_add_f32 v76, v76, v80
    v_exp_f32 v33, v33
    v_exp_f32 v34, v34
    s_waitcnt vmcnt(4)
    v_mfma_f32_32x32x8_bf16 v[12:27], v[130:131], v[200:201], 0
    v_rcp_f32 v78, v84
    v_exp_f32 v35, v35
    v_exp_f32 v36, v36
    v_mul_f32_dpp v76, v78, v76 row_newbcast:8 row_mask:0xf bank_mask:0xf
    v_mul_f32_dpp v84, v78, v84 row_newbcast:8 row_mask:0xf bank_mask:0xf
    v_cvt_pk_bf16_f32 v76, v76, v84
    v_exp_f32 v37, v37
    v_exp_f32 v38, v38
    v_smfmac_f32_16x16x64_bf16 v[216:219], v[224:227], v[236:243], v8
    v_exp_f32 v39, v39
    ds_write_b16 v7, v76 offset:21504
    s_mov_b64 exec, s[30:31]
    ds_write_b16_d16_hi v7, v76 offset:25214
    s_mov_b64 exec, 1
    ds_write_b32 v6, v2 offset:26272
    s_mov_b64 exec, -1
    s_add_u32 s46, s24, 372736
    buffer_load_dwordx4 v[236:239], v3, s[8:11], s46 offen offset:0
    v_smfmac_f32_32x32x32_bf16 v[60:75], v[164:167], v[28:35], v2
    v_exp_f32 v40, v40
    v_exp_f32 v41, v41
    v_exp_f32 v42, v42
    v_exp_f32 v43, v43
    s_setprio 1
    buffer_load_dwordx4 v[240:243], v3, s[8:11], s46 offen offset:1024
    v_mfma_f32_32x32x16_bf16 v[12:27], v[116:119], v[196:199], v[12:27]
    v_exp_f32 v44, v44
    v_exp_f32 v45, v45
    v_exp_f32 v46, v46
    v_exp_f32 v47, v47
    v_smfmac_f32_32x32x32_bf16 v[60:75], v[168:171], v[36:43], v2
    v_exp_f32 v48, v48
    v_exp_f32 v49, v49
    v_exp_f32 v50, v50
    ds_read_b128 v[76:79], v252
    ds_read_b128 v[80:83], v252
    ds_read_b128 v[84:87], v252
    v_mfma_f32_32x32x8_bf16 v[28:43], v[130:131], v[202:203], 0
    v_exp_f32 v51, v51
    v_exp_f32 v52, v52
    v_exp_f32 v53, v53
    v_exp_f32 v54, v54
    v_exp_f32 v55, v55
    ds_read_b128 v[200:203], v9 offset:15360
    v_smfmac_f32_32x32x32_bf16 v[60:75], v[172:175], v[44:51], v2
    v_exp_f32 v56, v56
    v_exp_f32 v57, v57
    v_exp_f32 v58, v58
    v_exp_f32 v59, v59
    s_setprio 0
    ds_read_b32 v10, v0 offset:26272
    ds_read_b128 v[224:227], v9 offset:21504
    v_mfma_f32_32x32x16_bf16 v[28:43], v[120:123], v[196:199], v[28:43]
    v_exp_f32 v12, v12
    v_exp_f32 v13, v13
    v_exp_f32 v14, v14
    v_exp_f32 v15, v15
    ds_read_b128 v[196:199], v9 offset:14336
    v_smfmac_f32_32x32x32_bf16 v[60:75], v[176:179], v[52:59], v2
    v_exp_f32 v16, v16
    v_exp_f32 v17, v17
    v_exp_f32 v18, v18
    s_waitcnt lgkmcnt(1)
    v_cmp_eq_u32 vcc, 0, v10
    s_cbranch_vccnz P4_RT25
P4_BK25:
    s_waitcnt vmcnt(4)
    v_mfma_f32_32x32x8_bf16 v[44:59], v[124:125], v[200:201], 0
    v_exp_f32 v19, v19
    v_exp_f32 v20, v20
    v_exp_f32 v21, v21
    v_exp_f32 v22, v22
    v_smfmac_f32_16x16x64_bf16 v[204:207], v[224:227], v[244:251], v8
    v_exp_f32 v23, v23
    s_add_u32 s46, s24, 374784
    buffer_load_dwordx4 v[244:247], v3, s[8:11], s46 offen offset:0
    buffer_load_dwordx4 v[248:251], v3, s[8:11], s46 offen offset:1024
    v_smfmac_f32_32x32x32_bf16 v[60:75], v[180:183], v[12:19], v2
    v_exp_f32 v24, v24
    v_exp_f32 v25, v25
    v_exp_f32 v26, v26
    v_exp_f32 v27, v27
    s_setprio 3
    s_waitcnt lgkmcnt(0)
    v_mfma_f32_32x32x16_bf16 v[44:59], v[92:95], v[196:199], v[44:59]
    v_exp_f32 v28, v28
    v_exp_f32 v29, v29
    v_exp_f32 v30, v30
    v_exp_f32 v31, v31
    v_smfmac_f32_32x32x32_bf16 v[60:75], v[184:187], v[20:27], v2
    v_exp_f32 v32, v32
    v_exp_f32 v33, v33
    v_exp_f32 v34, v34
    s_waitcnt vmcnt(4)
    v_mfma_f32_32x32x8_bf16 v[12:27], v[124:125], v[202:203], 0
    v_exp_f32 v35, v35
    v_exp_f32 v36, v36
    v_exp_f32 v37, v37
    v_exp_f32 v38, v38
    v_smfmac_f32_16x16x64_bf16 v[208:211], v[224:227], v[228:235], v8
    v_exp_f32 v39, v39
    s_add_u32 s46, s24, 442368
    buffer_load_dwordx4 v[228:231], v3, s[8:11], s46 offen offset:0
    buffer_load_dwordx4 v[232:235], v3, s[8:11], s46 offen offset:1024
    v_smfmac_f32_32x32x32_bf16 v[60:75], v[188:191], v[28:35], v2
    v_exp_f32 v40, v40
    v_exp_f32 v41, v41
    v_exp_f32 v42, v42
    v_exp_f32 v43, v43
    s_setprio 2
    v_mfma_f32_32x32x16_bf16 v[12:27], v[96:99], v[196:199], v[12:27]
    v_exp_f32 v44, v44
    v_exp_f32 v45, v45
    v_exp_f32 v46, v46
    v_exp_f32 v47, v47
    s_add_u32 s46, s24, 444416
    buffer_load_dwordx4 v[92:95], v3, s[8:11], s46 offen offset:0
    buffer_load_dwordx4 v[96:99], v3, s[8:11], s46 offen offset:1024
    v_smfmac_f32_32x32x32_bf16 v[60:75], v[192:195], v[36:43], v2
    v_exp_f32 v48, v48
    v_exp_f32 v49, v49
    v_exp_f32 v50, v50
    s_waitcnt vmcnt(6)
    v_mfma_f32_32x32x8_bf16 v[28:43], v[126:127], v[200:201], 0
    v_exp_f32 v51, v51
    v_exp_f32 v52, v52
    v_exp_f32 v53, v53
    v_exp_f32 v54, v54
    v_smfmac_f32_16x16x64_bf16 v[212:215], v[224:227], v[236:243], v8
    v_exp_f32 v55, v55
    s_add_u32 s46, s24, 446464
    buffer_load_dwordx4 v[236:239], v3, s[8:11], s46 offen offset:0
    buffer_load_dwordx4 v[240:243], v3, s[8:11], s46 offen offset:1024
    v_smfmac_f32_32x32x32_bf16 v[76:91], v[132:135], v[44:51], v2
    v_exp_f32 v56, v56
    v_exp_f32 v57, v57
    v_exp_f32 v58, v58
    v_exp_f32 v59, v59
    s_setprio 1
    ds_write_b128 v4, v[60:63] offset:32768
    v_mfma_f32_32x32x16_bf16 v[28:43], v[100:103], v[196:199], v[28:43]
    v_exp_f32 v12, v12
    v_exp_f32 v13, v13
    v_exp_f32 v14, v14
    v_exp_f32 v15, v15
    v_smfmac_f32_32x32x32_bf16 v[76:91], v[136:139], v[52:59], v2
    v_exp_f32 v16, v16
    v_exp_f32 v17, v17
    v_exp_f32 v18, v18
    ds_write_b128 v4, v[64:67] offset:32800
    s_waitcnt vmcnt(6)
    v_mfma_f32_32x32x8_bf16 v[44:59], v[126:127], v[202:203], 0
    v_exp_f32 v19, v19
    v_exp_f32 v20, v20
    v_exp_f32 v21, v21
    v_exp_f32 v22, v22
    v_smfmac_f32_16x16x64_bf16 v[216:219], v[224:227], v[244:251], v8
    v_exp_f32 v23, v23
    ds_write_b128 v4, v[68:71] offset:32832
    s_mov_b64 exec, 1
    ds_write_b32 v6, v2 offset:26048
    s_mov_b64 exec, -1
    s_add_u32 s46, s24, 448512
    buffer_load_dwordx4 v[244:247], v3, s[8:11], s46 offen offset:0
    buffer_load_dwordx4 v[248:251], v3, s[8:11], s46 offen offset:1024
    v_smfmac_f32_32x32x32_bf16 v[76:91], v[140:143], v[12:19], v2
    v_exp_f32 v24, v24
    v_exp_f32 v25, v25
    v_exp_f32 v26, v26
    v_exp_f32 v27, v27
    s_setprio 0
    v_mfma_f32_32x32x16_bf16 v[44:59], v[104:107], v[196:199], v[44:59]
    v_exp_f32 v28, v28
    v_exp_f32 v29, v29
    v_exp_f32 v30, v30
    v_exp_f32 v31, v31
    s_add_u32 s46, s24, 516096
    buffer_load_dwordx4 v[100:103], v3, s[8:11], s46 offen offset:0
    buffer_load_dwordx4 v[104:107], v3, s[8:11], s46 offen offset:1024
    v_smfmac_f32_32x32x32_bf16 v[76:91], v[144:147], v[20:27], v2
    v_exp_f32 v32, v32
    v_exp_f32 v33, v33
    v_exp_f32 v34, v34
    v_mfma_f32_32x32x8_bf16 v[12:27], v[128:129], v[200:201], 0
    v_exp_f32 v35, v35
    v_exp_f32 v36, v36
    v_exp_f32 v37, v37
    v_exp_f32 v38, v38
    v_exp_f32 v39, v39
    v_smfmac_f32_32x32x32_bf16 v[76:91], v[148:151], v[28:35], v2
    v_exp_f32 v40, v40
    v_exp_f32 v41, v41
    v_exp_f32 v42, v42
    v_exp_f32 v43, v43
    s_setprio 3
    v_mfma_f32_32x32x16_bf16 v[12:27], v[108:111], v[196:199], v[12:27]
    v_exp_f32 v44, v44
    v_exp_f32 v45, v45
    v_exp_f32 v46, v46
    v_exp_f32 v47, v47
    ds_read_b32 v10, v0 offset:26048
    ds_read2st64_b32 v[68:69], v253 offset0:128 offset1:142
    ds_read2st64_b32 v[60:61], v5 offset0:128 offset1:142
    ds_read2st64_b32 v[62:63], v5 offset0:156 offset1:170
    ds_read2st64_b32 v[64:65], v5 offset0:184 offset1:198
    ds_read2st64_b32 v[66:67], v5 offset0:212 offset1:226
    s_add_u32 s46, s24, 518144
    buffer_load_dwordx4 v[140:143], v3, s[8:11], s46 offen offset:0
    buffer_load_dwordx4 v[144:147], v3, s[8:11], s46 offen offset:1024
    v_smfmac_f32_32x32x32_bf16 v[76:91], v[152:155], v[36:43], v2
    v_exp_f32 v48, v48
    v_exp_f32 v49, v49
    v_exp_f32 v50, v50
    v_mfma_f32_32x32x8_bf16 v[28:43], v[128:129], v[202:203], 0
    v_exp_f32 v51, v51
    v_exp_f32 v52, v52
    v_exp_f32 v53, v53
    v_exp_f32 v54, v54
    v_exp_f32 v55, v55
    v_smfmac_f32_32x32x32_bf16 v[76:91], v[156:159], v[44:51], v2
    v_exp_f32 v56, v56
    v_exp_f32 v57, v57
    v_exp_f32 v58, v58
    v_exp_f32 v59, v59
    s_setprio 2
    s_waitcnt lgkmcnt(0)
    v_cmp_eq_u32 vcc, 0, v10
    s_cbranch_vccnz P4_RT26
P4_BK26:
    v_mfma_f32_32x32x16_bf16 v[28:43], v[112:115], v[196:199], v[28:43]
    v_exp_f32 v12, v12
    v_add_f32 v68, v68, v69
    v_add_f32 v60, v60, v61
    v_add_f32 v62, v62, v63
    v_exp_f32 v13, v13
    v_add_f32_dpp v68, v68, v68 quad_perm:[1,0,3,2] row_mask:0xf bank_mask:0xf
    v_add_f32 v64, v64, v65
    v_add_f32 v66, v66, v67
    v_exp_f32 v14, v14
    v_exp_f32 v15, v15
    s_add_u32 s46, s24, 520192
    buffer_load_dwordx4 v[108:111], v3, s[8:11], s46 offen offset:0
    buffer_load_dwordx4 v[112:115], v3, s[8:11], s46 offen offset:1024
    v_smfmac_f32_32x32x32_bf16 v[76:91], v[160:163], v[52:59], v2
    v_add_f32_dpp v68, v68, v68 quad_perm:[2,3,0,1] row_mask:0xf bank_mask:0xf
    v_add_f32 v60, v60, v62
    v_add_f32 v64, v64, v66
    v_exp_f32 v16, v16
    v_add_f32 v60, v60, v64
    v_exp_f32 v17, v17
    v_exp_f32 v18, v18
    v_mfma_f32_32x32x8_bf16 v[44:59], v[130:131], v[200:201], 0
    v_rcp_f32 v62, v68
    v_exp_f32 v19, v19
    v_exp_f32 v20, v20
    v_mul_f32_dpp v60, v62, v60 row_newbcast:8 row_mask:0xf bank_mask:0xf
    v_mul_f32_dpp v68, v62, v68 row_newbcast:8 row_mask:0xf bank_mask:0xf
    v_cvt_pk_bf16_f32 v60, v60, v68
    v_exp_f32 v21, v21
    v_exp_f32 v22, v22
    v_exp_f32 v23, v23
    ds_write_b16 v7, v60 offset:22528
    s_mov_b64 exec, s[30:31]
    ds_write_b16_d16_hi v7, v60 offset:25090
    s_mov_b64 exec, 1
    ds_write_b32 v6, v2 offset:26304
    s_mov_b64 exec, -1
    s_add_u32 s46, s24, 522240
    buffer_load_dwordx4 v[148:151], v3, s[8:11], s46 offen offset:0
    buffer_load_dwordx4 v[152:155], v3, s[8:11], s46 offen offset:1024
    v_smfmac_f32_32x32x32_bf16 v[76:91], v[164:167], v[12:19], v2
    v_exp_f32 v24, v24
    v_exp_f32 v25, v25
    v_exp_f32 v26, v26
    v_exp_f32 v27, v27
    s_setprio 1
    v_mfma_f32_32x32x16_bf16 v[44:59], v[116:119], v[196:199], v[44:59]
    v_exp_f32 v28, v28
    v_exp_f32 v29, v29
    v_exp_f32 v30, v30
    v_exp_f32 v31, v31
    v_smfmac_f32_32x32x32_bf16 v[76:91], v[168:171], v[20:27], v2
    v_exp_f32 v32, v32
    v_exp_f32 v33, v33
    v_exp_f32 v34, v34
    v_mfma_f32_32x32x8_bf16 v[12:27], v[130:131], v[202:203], 0
    v_exp_f32 v35, v35
    v_exp_f32 v36, v36
    v_exp_f32 v37, v37
    v_exp_f32 v38, v38
    v_exp_f32 v39, v39
    v_smfmac_f32_32x32x32_bf16 v[76:91], v[172:175], v[28:35], v2
    v_exp_f32 v40, v40
    v_exp_f32 v41, v41
    v_and_b32 v254, 7, v1
    v_lshlrev_b32 v254, 4, v254
    v_bfe_u32 v255, v1, 3, 1
    v_lshl_add_u32 v254, v255, 9, v254
    v_lshrrev_b32 v255, 5, v1
    v_lshl_add_u32 v254, v255, 8, v254
    v_bfe_u32 v255, v1, 4, 1
    v_lshl_add_u32 v11, v255, 3, v254
    v_lshl_add_u32 v254, v255, 10, v254
    s_lshl_b32 s29, s44, 9
    s_add_u32 s28, s5, s29
    s_mul_i32 s29, s45, 2359296
    s_add_u32 s29, s29, s28
    s_add_u32 s29, s29, 9437184
    buffer_load_dwordx2 v[132:133], v11, s[8:11], s29 offen offset:0 sc1
    buffer_load_dwordx2 v[134:135], v11, s[8:11], s29 offen offset:1024 sc1
    v_exp_f32 v42, v42
    v_exp_f32 v43, v43
    s_setprio 0
    ds_read_b32 v10, v0 offset:26304
    ds_read_b128 v[224:227], v9 offset:22528
    v_mfma_f32_32x32x16_bf16 v[12:27], v[120:123], v[196:199], v[12:27]
    v_exp_f32 v44, v44
    v_exp_f32 v45, v45
    v_exp_f32 v46, v46
    v_exp_f32 v47, v47
    v_smfmac_f32_32x32x32_bf16 v[76:91], v[176:179], v[36:43], v2
    v_exp_f32 v48, v48
    v_exp_f32 v49, v49
    v_exp_f32 v50, v50
    s_waitcnt lgkmcnt(0)
    v_cmp_eq_u32 vcc, 0, v10
    s_cbranch_vccnz P4_RT27
P4_BK27:
    s_waitcnt vmcnt(16)
    v_exp_f32 v51, v51
    v_exp_f32 v52, v52
    v_exp_f32 v53, v53
    v_exp_f32 v54, v54
    v_smfmac_f32_16x16x64_bf16 v[204:207], v[224:227], v[228:235], v8
    v_exp_f32 v55, v55
    s_waitcnt vmcnt(14)
    v_smfmac_f32_32x32x32_bf16 v[76:91], v[180:183], v[44:51], v2
    v_exp_f32 v56, v56
    v_exp_f32 v57, v57
    v_exp_f32 v58, v58
    v_smfmac_f32_16x16x64_bf16 v[208:211], v[224:227], v[92:99], v8
    v_exp_f32 v59, v59
    s_setprio 3
    v_exp_f32 v12, v12
    v_exp_f32 v13, v13
    v_exp_f32 v14, v14
    v_exp_f32 v15, v15
    v_smfmac_f32_32x32x32_bf16 v[76:91], v[184:187], v[52:59], v2
    v_exp_f32 v16, v16
    v_exp_f32 v17, v17
    v_exp_f32 v18, v18
    s_waitcnt vmcnt(12)
    v_exp_f32 v19, v19
    v_exp_f32 v20, v20
    v_exp_f32 v21, v21
    v_exp_f32 v22, v22
    v_smfmac_f32_16x16x64_bf16 v[212:215], v[224:227], v[236:243], v8
    v_exp_f32 v23, v23
    s_waitcnt vmcnt(10)
    v_smfmac_f32_32x32x32_bf16 v[76:91], v[188:191], v[12:19], v2
    v_exp_f32 v24, v24
    v_exp_f32 v25, v25
    v_exp_f32 v26, v26
    v_smfmac_f32_16x16x64_bf16 v[216:219], v[224:227], v[244:251], v8
    v_exp_f32 v27, v27
    s_setprio 2
    s_nop 0
    v_smfmac_f32_32x32x32_bf16 v[76:91], v[192:195], v[20:27], v2
    s_waitcnt vmcnt(10)
    s_nop 10
    ds_write_b128 v4, v[76:79] offset:32768
    ds_write_b128 v4, v[80:83] offset:32800
    ds_write_b128 v4, v[84:87] offset:32832
    s_add_u32 s46, s19, 0
    buffer_load_dwordx4 v[52:55], v3, s[8:11], s46 offen offset:0
    s_add_u32 s46, s19, 36864
    buffer_load_dwordx4 v[56:59], v3, s[8:11], s46 offen offset:0
    s_add_u32 s46, s19, 1024
    buffer_load_dwordx4 v[44:47], v3, s[8:11], s46 offen offset:0
    s_add_u32 s46, s19, 37888
    buffer_load_dwordx4 v[48:51], v3, s[8:11], s46 offen offset:0
    v_and_b32 v68, 7, v1
    v_bfe_u32 v69, v1, 4, 1
    v_lshlrev_b32 v69, 2, v69
    v_sub_u32 v68, v68, v69
    v_and_b32 v69, 1, v68
    v_lshlrev_b32 v69, 4, v69
    v_mov_b32 v70, 0x3f80
    v_lshlrev_b32 v69, v69, v70
    v_lshrrev_b32 v68, 1, v68
    v_cmp_eq_u32 s[36:37], 0, v68
    v_cmp_eq_u32 s[38:39], 1, v68
    s_waitcnt lgkmcnt(0)
    s_barrier
    ds_read2st64_b32 v[84:85], v253 offset0:128 offset1:142
    ds_read2st64_b32 v[76:77], v5 offset0:128 offset1:142
    ds_read2st64_b32 v[78:79], v5 offset0:156 offset1:170
    ds_read2st64_b32 v[80:81], v5 offset0:184 offset1:198
    ds_read2st64_b32 v[82:83], v5 offset0:212 offset1:226
    s_add_u32 s46, s19, 2048
    buffer_load_dwordx4 v[36:39], v3, s[8:11], s46 offen offset:0
    s_add_u32 s46, s19, 38912
    buffer_load_dwordx4 v[40:43], v3, s[8:11], s46 offen offset:0
    s_add_u32 s46, s19, 3072
    buffer_load_dwordx4 v[28:31], v3, s[8:11], s46 offen offset:0
    s_add_u32 s46, s19, 39936
    buffer_load_dwordx4 v[32:35], v3, s[8:11], s46 offen offset:0
    v_cndmask_b32 v70, 0, v69, s[36:37]
    v_cndmask_b32 v71, 0, v69, s[38:39]
    s_waitcnt lgkmcnt(0)
    v_add_f32 v84, v84, v85
    v_add_f32 v76, v76, v77
    v_add_f32 v78, v78, v79
    v_add_f32_dpp v84, v84, v84 quad_perm:[1,0,3,2] row_mask:0xf bank_mask:0xf
    v_add_f32 v80, v80, v81
    v_add_f32 v82, v82, v83
    v_add_f32_dpp v84, v84, v84 quad_perm:[2,3,0,1] row_mask:0xf bank_mask:0xf
    v_add_f32 v76, v76, v78
    v_add_f32 v80, v80, v82
    v_add_f32 v76, v76, v80
    v_rcp_f32 v78, v84
    s_nop 1
    v_mul_f32_dpp v76, v78, v76 row_newbcast:8 row_mask:0xf bank_mask:0xf
    v_mul_f32_dpp v84, v78, v84 row_newbcast:8 row_mask:0xf bank_mask:0xf
    v_cvt_pk_bf16_f32 v76, v76, v84
    ds_write_b16 v7, v76 offset:23552
    s_mov_b64 exec, s[30:31]
    ds_write_b16_d16_hi v7, v76 offset:25218
    s_mov_b64 exec, -1
    s_mov_b32 s29, 0xffff0000
    v_cndmask_b32 v64, 0, v70, s[34:35]
    v_cndmask_b32 v65, 0, v71, s[34:35]
    v_cndmask_b32 v66, v70, 0, s[34:35]
    v_cndmask_b32 v67, v71, 0, s[34:35]
    s_waitcnt lgkmcnt(0)
    s_barrier
    ds_read_b128 v[224:227], v9 offset:23552
    ds_read_b128 v[60:63], v9 offset:24576
    s_waitcnt vmcnt(8)
    v_lshlrev_b32 v12, 16, v132
    v_and_b32 v13, s29, v132
    v_lshlrev_b32 v14, 16, v133
    v_and_b32 v15, s29, v133
    v_lshlrev_b32 v16, 16, v134
    v_and_b32 v17, s29, v134
    v_lshlrev_b32 v18, 16, v135
    v_and_b32 v19, s29, v135
    s_waitcnt lgkmcnt(0)
    s_waitcnt vmcnt(10)
    v_smfmac_f32_16x16x64_bf16 v[204:207], v[224:227], v[100:107], v8
    v_smfmac_f32_16x16x64_bf16 v[208:211], v[224:227], v[140:147], v8
    v_smfmac_f32_16x16x64_bf16 v[212:215], v[224:227], v[108:115], v8
    v_smfmac_f32_16x16x64_bf16 v[216:219], v[224:227], v[148:155], v8
    s_waitcnt vmcnt(6)
    v_smfmac_f32_16x16x64_bf16 v[204:207], v[60:63], v[52:59], v8
    s_waitcnt vmcnt(4)
    v_smfmac_f32_16x16x64_bf16 v[208:211], v[60:63], v[44:51], v8
    s_waitcnt vmcnt(2)
    v_smfmac_f32_16x16x64_bf16 v[212:215], v[60:63], v[36:43], v8
    s_waitcnt vmcnt(0)
    v_smfmac_f32_16x16x64_bf16 v[216:219], v[60:63], v[28:35], v8
    s_nop 1
    v_cvt_pk_bf16_f32 v204, v204, v205
    v_cvt_pk_bf16_f32 v205, v206, v207
    v_cvt_pk_bf16_f32 v206, v208, v209
    v_cvt_pk_bf16_f32 v207, v210, v211
    s_nop 1
    v_mfma_f32_16x16x32_bf16 v[12:15], v[204:207], v[64:67], v[12:15]
    v_cvt_pk_bf16_f32 v212, v212, v213
    v_cvt_pk_bf16_f32 v213, v214, v215
    v_cvt_pk_bf16_f32 v214, v216, v217
    v_cvt_pk_bf16_f32 v215, v218, v219
    s_nop 1
    v_mfma_f32_16x16x32_bf16 v[16:19], v[212:215], v[64:67], v[16:19]
    s_nop 0
    v_cvt_pk_bf16_f32 v132, v12, v13
    v_cvt_pk_bf16_f32 v133, v14, v15
    s_nop 4
    v_cvt_pk_bf16_f32 v134, v16, v17
    v_cvt_pk_bf16_f32 v135, v18, v19
    s_nop 0
    v_permlane16_swap_b32 v132, v134
    v_permlane16_swap_b32 v133, v135
    s_cmp_eq_u32 s45, 0
    s_cbranch_scc1 P4_MID1
    v_and_b32 v14, 7, v1
    v_mul_u32_u24 v14, 1152, v14
    v_lshrrev_b32 v15, 4, v1
    v_lshl_add_u32 v16, v15, 3, v14
    v_bfe_u32 v15, v1, 3, 2
    v_lshl_add_u32 v14, v15, 5, v14
    v_lshrrev_b32 v15, 5, v1
    v_lshl_add_u32 v14, v15, 4, v14
    s_mul_i32 s28, s4, 9216
    s_lshl_b32 s29, s44, 5
    s_add_u32 s28, s28, s29
    buffer_store_dwordx4 v[132:135], v14, s[12:15], s28 offen
    s_endpgm
P4_MID1:
    s_mov_b32 s26, 0x3f803f80
    s_add_u32 s27, s28, 4718592
    v_dot2_f32_bf16 v12, v132, s26, 0
    v_dot2_f32_bf16 v13, v132, v132, 0
    v_dot2_f32_bf16 v12, v133, s26, v12
    v_dot2_f32_bf16 v13, v133, v133, v13
    v_dot2_f32_bf16 v12, v134, s26, v12
    v_dot2_f32_bf16 v13, v134, v134, v13
    v_dot2_f32_bf16 v12, v135, s26, v12
    v_dot2_f32_bf16 v13, v135, v135, v13
    v_and_b32 v16, 7, v1
    v_lshlrev_b32 v16, 6, v16
    v_add_u32 v16, 98304, v16
    v_permlane32_swap_b32 v12, v13
    s_lshl_b32 s26, s3, 3
    v_add_f32 v12, v12, v13
    v_lshrrev_b32 v17, 5, v1
    v_lshl_add_u32 v17, v17, 2, v16
    v_add_f32_dpp v12, v12, v12 row_ror:8 row_mask:0xf bank_mask:0xf
    v_add_u32 v17, s26, v17
    v_mov_b32 v13, v12
    s_nop 1
    v_permlane16_swap_b32 v12, v13
    v_add_f32 v12, v12, v13
    s_mov_b32 exec_lo, 0xff
    s_mov_b32 exec_hi, 0xff
    ds_write_b32 v17, v12 offset:61952
    s_mov_b64 exec, -1
    buffer_store_dwordx4 v[132:135], v254, s[8:11], s27 offen sc1
    s_waitcnt lgkmcnt(0)
    s_barrier
    ds_read_b128 v[20:23], v16 offset:61952
    ds_read_b128 v[24:27], v16 offset:61968
    ds_read_b128 v[28:31], v16 offset:61984
    ds_read_b128 v[32:35], v16 offset:62000
    v_lshlrev_b32 v44, 16, v132
    v_and_b32 v45, s29, v132
    v_lshlrev_b32 v46, 16, v133
    v_and_b32 v47, s29, v133
    v_lshlrev_b32 v48, 16, v134
    v_and_b32 v49, s29, v134
    v_lshlrev_b32 v50, 16, v135
    v_and_b32 v51, s29, v135
    s_waitcnt lgkmcnt(0)
    v_add_f32 v20, v20, v22
    v_add_f32 v21, v21, v23
    v_add_f32 v24, v24, v26
    v_add_f32 v25, v25, v27
    v_add_f32 v28, v28, v30
    v_add_f32 v29, v29, v31
    v_add_f32 v32, v32, v34
    v_add_f32 v33, v33, v35
    v_add_f32 v20, v20, v24
    v_add_f32 v21, v21, v25
    v_add_f32 v28, v28, v32
    v_add_f32 v29, v29, v33
    v_add_f32 v20, v20, v28
    v_add_f32 v21, v21, v29
    v_mul_f32 v20, 3135475257, v20
    v_mul_f32 v21, 987991609, v21
    v_fma_f32 v21, -v20, v20, v21
    v_max_f32 v21, 0, v21
    v_add_f32 v21, 925353388, v21
    v_rsq_f32 v21, v21
    s_add_u32 s27, s28, 2359296
    v_mul_f32 v20, v20, v21
    v_fma_f32 v44, v44, v21, v20
    v_fma_f32 v45, v45, v21, v20
    v_cvt_pk_bf16_f32 v36, v44, v45
    v_fma_f32 v46, v46, v21, v20
    v_fma_f32 v47, v47, v21, v20
    v_cvt_pk_bf16_f32 v37, v46, v47
    v_fma_f32 v48, v48, v21, v20
    v_fma_f32 v49, v49, v21, v20
    v_cvt_pk_bf16_f32 v38, v48, v49
    v_fma_f32 v50, v50, v21, v20
    v_fma_f32 v51, v51, v21, v20
    v_cvt_pk_bf16_f32 v39, v50, v51
    v_min_u32 v36, -2, v36
    s_waitcnt vmcnt(0)
    buffer_store_dwordx4 v[36:39], v254, s[8:11], s27 offen sc1
    s_setprio 0
    s_mov_b32 s45, 1
    s_branch MID
P4_END:
    s_endpgm
P4_RT0:
    s_sleep 1
    ds_read_b32 v10, v0 offset:25856
    ds_read2st64_b32 v[68:69], v253 offset0:128 offset1:142
    ds_read2st64_b32 v[60:61], v5 offset0:128 offset1:142
    ds_read2st64_b32 v[62:63], v5 offset0:156 offset1:170
    ds_read2st64_b32 v[64:65], v5 offset0:184 offset1:198
    ds_read2st64_b32 v[66:67], v5 offset0:212 offset1:226
    s_waitcnt lgkmcnt(0)
    v_cmp_eq_u32 vcc, 0, v10
    s_cbranch_vccnz P4_RT0
    s_branch P4_BK0
P4_RT1:
    s_sleep 1
    ds_read_b32 v10, v0 offset:26112
    ds_read_b128 v[224:227], v9 offset:16384
    s_waitcnt lgkmcnt(0)
    v_cmp_eq_u32 vcc, 0, v10
    s_cbranch_vccnz P4_RT1
    s_branch P4_BK1
P4_RT2:
    s_sleep 1
    ds_read_b32 v10, v0 offset:25888
    ds_read2st64_b32 v[84:85], v253 offset0:128 offset1:142
    ds_read2st64_b32 v[76:77], v5 offset0:128 offset1:142
    ds_read2st64_b32 v[78:79], v5 offset0:156 offset1:170
    ds_read2st64_b32 v[80:81], v5 offset0:184 offset1:198
    ds_read2st64_b32 v[82:83], v5 offset0:212 offset1:226
    s_waitcnt lgkmcnt(0)
    v_cmp_eq_u32 vcc, 0, v10
    s_cbranch_vccnz P4_RT2
    s_branch P4_BK2
P4_RT3:
    s_sleep 1
    ds_read_b32 v10, v0 offset:26144
    ds_read_b128 v[224:227], v9 offset:17408
    s_waitcnt lgkmcnt(0)
    v_cmp_eq_u32 vcc, 0, v10
    s_cbranch_vccnz P4_RT3
    s_branch P4_BK3
P4_RT4:
    s_sleep 1
    ds_read_b32 v10, v0 offset:25920
    ds_read2st64_b32 v[68:69], v253 offset0:128 offset1:142
    ds_read2st64_b32 v[60:61], v5 offset0:128 offset1:142
    ds_read2st64_b32 v[62:63], v5 offset0:156 offset1:170
    ds_read2st64_b32 v[64:65], v5 offset0:184 offset1:198
    ds_read2st64_b32 v[66:67], v5 offset0:212 offset1:226
    s_waitcnt lgkmcnt(0)
    v_cmp_eq_u32 vcc, 0, v10
    s_cbranch_vccnz P4_RT4
    s_branch P4_BK4
P4_RT5:
    s_sleep 1
    ds_read_b32 v10, v0 offset:26176
    ds_read_b128 v[224:227], v9 offset:18432
    s_waitcnt lgkmcnt(0)
    v_cmp_eq_u32 vcc, 0, v10
    s_cbranch_vccnz P4_RT5
    s_branch P4_BK5
P4_RT6:
    s_sleep 1
    ds_read_b32 v10, v0 offset:25952
    ds_read2st64_b32 v[84:85], v253 offset0:128 offset1:142
    ds_read2st64_b32 v[76:77], v5 offset0:128 offset1:142
    ds_read2st64_b32 v[78:79], v5 offset0:156 offset1:170
    ds_read2st64_b32 v[80:81], v5 offset0:184 offset1:198
    ds_read2st64_b32 v[82:83], v5 offset0:212 offset1:226
    s_waitcnt lgkmcnt(0)
    v_cmp_eq_u32 vcc, 0, v10
    s_cbranch_vccnz P4_RT6
    s_branch P4_BK6
P4_RT7:
    s_sleep 1
    ds_read_b32 v10, v0 offset:26208
    ds_read_b128 v[224:227], v9 offset:19456
    s_waitcnt lgkmcnt(0)
    v_cmp_eq_u32 vcc, 0, v10
    s_cbranch_vccnz P4_RT7
    s_branch P4_BK7
P4_RT8:
    s_sleep 1
    ds_read_b32 v10, v0 offset:25984
    ds_read2st64_b32 v[68:69], v253 offset0:128 offset1:142
    ds_read2st64_b32 v[60:61], v5 offset0:128 offset1:142
    ds_read2st64_b32 v[62:63], v5 offset0:156 offset1:170
    ds_read2st64_b32 v[64:65], v5 offset0:184 offset1:198
    ds_read2st64_b32 v[66:67], v5 offset0:212 offset1:226
    s_waitcnt lgkmcnt(0)
    v_cmp_eq_u32 vcc, 0, v10
    s_cbranch_vccnz P4_RT8
    s_branch P4_BK8
P4_RT9:
    s_sleep 1
    ds_read_b32 v10, v0 offset:26240
    ds_read_b128 v[224:227], v9 offset:20480
    s_waitcnt lgkmcnt(0)
    v_cmp_eq_u32 vcc, 0, v10
    s_cbranch_vccnz P4_RT9
    s_branch P4_BK9
P4_RT10:
    s_sleep 1
    ds_read_b32 v10, v0 offset:26016
    ds_read2st64_b32 v[84:85], v253 offset0:128 offset1:142
    ds_read2st64_b32 v[76:77], v5 offset0:128 offset1:142
    ds_read2st64_b32 v[78:79], v5 offset0:156 offset1:170
    ds_read2st64_b32 v[80:81], v5 offset0:184 offset1:198
    ds_read2st64_b32 v[82:83], v5 offset0:212 offset1:226
    s_waitcnt lgkmcnt(0)
    v_cmp_eq_u32 vcc, 0, v10
    s_cbranch_vccnz P4_RT10
    s_branch P4_BK10
P4_RT11:
    s_sleep 1
    ds_read_b32 v10, v0 offset:26272
    ds_read_b128 v[224:227], v9 offset:21504
    s_waitcnt lgkmcnt(0)
    v_cmp_eq_u32 vcc, 0, v10
    s_cbranch_vccnz P4_RT11
    s_branch P4_BK11
P4_RT12:
    s_sleep 1
    ds_read_b32 v10, v0 offset:26048
    ds_read2st64_b32 v[68:69], v253 offset0:128 offset1:142
    ds_read2st64_b32 v[60:61], v5 offset0:128 offset1:142
    ds_read2st64_b32 v[62:63], v5 offset0:156 offset1:170
    ds_read2st64_b32 v[64:65], v5 offset0:184 offset1:198
    ds_read2st64_b32 v[66:67], v5 offset0:212 offset1:226
    s_waitcnt lgkmcnt(0)
    v_cmp_eq_u32 vcc, 0, v10
    s_cbranch_vccnz P4_RT12
    s_branch P4_BK12
P4_RT13:
    s_sleep 1
    ds_read_b32 v10, v0 offset:26304
    ds_read_b128 v[224:227], v9 offset:22528
    s_waitcnt lgkmcnt(0)
    v_cmp_eq_u32 vcc, 0, v10
    s_cbranch_vccnz P4_RT13
    s_branch P4_BK13
P4_RT14:
    s_sleep 1
    ds_read_b32 v10, v0 offset:25856
    ds_read2st64_b32 v[68:69], v253 offset0:128 offset1:142
    ds_read2st64_b32 v[60:61], v5 offset0:128 offset1:142
    ds_read2st64_b32 v[62:63], v5 offset0:156 offset1:170
    ds_read2st64_b32 v[64:65], v5 offset0:184 offset1:198
    ds_read2st64_b32 v[66:67], v5 offset0:212 offset1:226
    s_waitcnt lgkmcnt(0)
    v_cmp_eq_u32 vcc, 0, v10
    s_cbranch_vccnz P4_RT14
    s_branch P4_BK14
P4_RT15:
    s_sleep 1
    ds_read_b32 v10, v0 offset:26112
    ds_read_b128 v[224:227], v9 offset:16384
    s_waitcnt lgkmcnt(0)
    v_cmp_eq_u32 vcc, 0, v10
    s_cbranch_vccnz P4_RT15
    s_branch P4_BK15
P4_RT16:
    s_sleep 1
    ds_read_b32 v10, v0 offset:25888
    ds_read2st64_b32 v[84:85], v253 offset0:128 offset1:142
    ds_read2st64_b32 v[76:77], v5 offset0:128 offset1:142
    ds_read2st64_b32 v[78:79], v5 offset0:156 offset1:170
    ds_read2st64_b32 v[80:81], v5 offset0:184 offset1:198
    ds_read2st64_b32 v[82:83], v5 offset0:212 offset1:226
    s_waitcnt lgkmcnt(0)
    v_cmp_eq_u32 vcc, 0, v10
    s_cbranch_vccnz P4_RT16
    s_branch P4_BK16
P4_RT17:
    s_sleep 1
    ds_read_b32 v10, v0 offset:26144
    ds_read_b128 v[224:227], v9 offset:17408
    s_waitcnt lgkmcnt(0)
    v_cmp_eq_u32 vcc, 0, v10
    s_cbranch_vccnz P4_RT17
    s_branch P4_BK17
P4_RT18:
    s_sleep 1
    ds_read_b32 v10, v0 offset:25920
    ds_read2st64_b32 v[68:69], v253 offset0:128 offset1:142
    ds_read2st64_b32 v[60:61], v5 offset0:128 offset1:142
    ds_read2st64_b32 v[62:63], v5 offset0:156 offset1:170
    ds_read2st64_b32 v[64:65], v5 offset0:184 offset1:198
    ds_read2st64_b32 v[66:67], v5 offset0:212 offset1:226
    s_waitcnt lgkmcnt(0)
    v_cmp_eq_u32 vcc, 0, v10
    s_cbranch_vccnz P4_RT18
    s_branch P4_BK18
P4_RT19:
    s_sleep 1
    ds_read_b32 v10, v0 offset:26176
    ds_read_b128 v[224:227], v9 offset:18432
    s_waitcnt lgkmcnt(0)
    v_cmp_eq_u32 vcc, 0, v10
    s_cbranch_vccnz P4_RT19
    s_branch P4_BK19
P4_RT20:
    s_sleep 1
    ds_read_b32 v10, v0 offset:25952
    ds_read2st64_b32 v[84:85], v253 offset0:128 offset1:142
    ds_read2st64_b32 v[76:77], v5 offset0:128 offset1:142
    ds_read2st64_b32 v[78:79], v5 offset0:156 offset1:170
    ds_read2st64_b32 v[80:81], v5 offset0:184 offset1:198
    ds_read2st64_b32 v[82:83], v5 offset0:212 offset1:226
    s_waitcnt lgkmcnt(0)
    v_cmp_eq_u32 vcc, 0, v10
    s_cbranch_vccnz P4_RT20
    s_branch P4_BK20
P4_RT21:
    s_sleep 1
    ds_read_b32 v10, v0 offset:26208
    ds_read_b128 v[224:227], v9 offset:19456
    s_waitcnt lgkmcnt(0)
    v_cmp_eq_u32 vcc, 0, v10
    s_cbranch_vccnz P4_RT21
    s_branch P4_BK21
P4_RT22:
    s_sleep 1
    ds_read_b32 v10, v0 offset:25984
    ds_read2st64_b32 v[68:69], v253 offset0:128 offset1:142
    ds_read2st64_b32 v[60:61], v5 offset0:128 offset1:142
    ds_read2st64_b32 v[62:63], v5 offset0:156 offset1:170
    ds_read2st64_b32 v[64:65], v5 offset0:184 offset1:198
    ds_read2st64_b32 v[66:67], v5 offset0:212 offset1:226
    s_waitcnt lgkmcnt(0)
    v_cmp_eq_u32 vcc, 0, v10
    s_cbranch_vccnz P4_RT22
    s_branch P4_BK22
P4_RT23:
    s_sleep 1
    ds_read_b32 v10, v0 offset:26240
    ds_read_b128 v[224:227], v9 offset:20480
    s_waitcnt lgkmcnt(0)
    v_cmp_eq_u32 vcc, 0, v10
    s_cbranch_vccnz P4_RT23
    s_branch P4_BK23
P4_RT24:
    s_sleep 1
    ds_read_b32 v10, v0 offset:26016
    ds_read2st64_b32 v[84:85], v253 offset0:128 offset1:142
    ds_read2st64_b32 v[76:77], v5 offset0:128 offset1:142
    ds_read2st64_b32 v[78:79], v5 offset0:156 offset1:170
    ds_read2st64_b32 v[80:81], v5 offset0:184 offset1:198
    ds_read2st64_b32 v[82:83], v5 offset0:212 offset1:226
    s_waitcnt lgkmcnt(0)
    v_cmp_eq_u32 vcc, 0, v10
    s_cbranch_vccnz P4_RT24
    s_branch P4_BK24
P4_RT25:
    s_sleep 1
    ds_read_b32 v10, v0 offset:26272
    ds_read_b128 v[224:227], v9 offset:21504
    s_waitcnt lgkmcnt(0)
    v_cmp_eq_u32 vcc, 0, v10
    s_cbranch_vccnz P4_RT25
    s_branch P4_BK25
P4_RT26:
    s_sleep 1
    ds_read_b32 v10, v0 offset:26048
    ds_read2st64_b32 v[68:69], v253 offset0:128 offset1:142
    ds_read2st64_b32 v[60:61], v5 offset0:128 offset1:142
    ds_read2st64_b32 v[62:63], v5 offset0:156 offset1:170
    ds_read2st64_b32 v[64:65], v5 offset0:184 offset1:198
    ds_read2st64_b32 v[66:67], v5 offset0:212 offset1:226
    s_waitcnt lgkmcnt(0)
    v_cmp_eq_u32 vcc, 0, v10
    s_cbranch_vccnz P4_RT26
    s_branch P4_BK26
P4_RT27:
    s_sleep 1
    ds_read_b32 v10, v0 offset:26304
    ds_read_b128 v[224:227], v9 offset:22528
    s_waitcnt lgkmcnt(0)
    v_cmp_eq_u32 vcc, 0, v10
    s_cbranch_vccnz P4_RT27
    s_branch P4_BK27
P4_RK:
    s_add_u32 s46, s46, 1
    s_cmp_gt_u32 s46, 131072
    s_cbranch_scc1 P4_RKB
    s_sleep 2
    buffer_load_dwordx4 v[124:127], v254, s[8:11], s23 offen sc1
    buffer_load_dwordx4 v[92:95], v3, s[8:11], s21 offen offset:0 sc1
    buffer_load_dwordx4 v[96:99], v3, s[8:11], s21 offen offset:1024 sc1
    s_waitcnt vmcnt(0)
    s_waitcnt lgkmcnt(0)
    v_max3_u32 v10, v92, v93, v94
    v_max3_u32 v10, v95, v96, v10
    v_max3_u32 v10, v97, v98, v10
    v_max3_u32 v10, v99, v124, v10
    v_max3_u32 v10, v125, v126, v10
    v_max_u32 v10, v127, v10
    v_cmp_eq_u32 vcc, -1, v10
    s_cbranch_vccnz P4_RK
    s_branch P4_RKB
P4_RK00:
    s_add_u32 s46, s46, 1
    s_cmp_gt_u32 s46, 131072
    s_cbranch_scc1 P4_RK00B
    s_sleep 2
    buffer_load_dwordx4 v[100:103], v3, s[8:11], s21 offen offset:2048 sc1
    s_waitcnt vmcnt(0)
    s_waitcnt lgkmcnt(0)
    v_max3_u32 v10, v100, v101, v102
    v_max_u32 v10, v103, v10
    v_cmp_eq_u32 vcc, -1, v10
    s_cbranch_vccnz P4_RK00
    s_branch P4_RK00B
P4_RV00:
    s_add_u32 s46, s46, 1
    s_cmp_gt_u32 s46, 131072
    s_cbranch_scc1 P4_RV00B
    s_sleep 2
    s_add_u32 m0, s6, 0
    s_add_u32 s27, s40, 0
    buffer_load_dwordx4 v3, s[8:11], s27 offen sc1 lds
    s_add_u32 m0, s6, 8192
    s_add_u32 s27, s40, 1024
    buffer_load_dwordx4 v3, s[8:11], s27 offen sc1 lds
    s_waitcnt vmcnt(0)
    ds_read_b128 v[132:135], v204 offset:0
    ds_read_b128 v[136:139], v205 offset:0
    s_waitcnt lgkmcnt(0)
    v_max_u32 v10, v132, v136
    v_cmp_eq_u32 vcc, -1, v10
    s_cbranch_vccnz P4_RV00
    s_branch P4_RV00B
P4_RK01:
    s_add_u32 s46, s46, 1
    s_cmp_gt_u32 s46, 131072
    s_cbranch_scc1 P4_RK01B
    s_sleep 2
    buffer_load_dwordx4 v[104:107], v3, s[8:11], s21 offen offset:3072 sc1
    s_waitcnt vmcnt(0)
    s_waitcnt lgkmcnt(0)
    v_max3_u32 v10, v104, v105, v106
    v_max_u32 v10, v107, v10
    v_cmp_eq_u32 vcc, -1, v10
    s_cbranch_vccnz P4_RK01
    s_branch P4_RK01B
P4_RV01:
    s_add_u32 s46, s46, 1
    s_cmp_gt_u32 s46, 131072
    s_cbranch_scc1 P4_RV01B
    s_sleep 2
    s_add_u32 m0, s6, 8192
    s_add_u32 s27, s40, 1024
    buffer_load_dwordx4 v3, s[8:11], s27 offen sc1 lds
    s_add_u32 m0, s6, 16384
    s_add_u32 s27, s40, 2048
    buffer_load_dwordx4 v3, s[8:11], s27 offen sc1 lds
    s_waitcnt vmcnt(0)
    ds_read_b128 v[140:143], v206 offset:0
    ds_read_b128 v[144:147], v207 offset:0
    s_waitcnt lgkmcnt(0)
    v_max_u32 v10, v140, v144
    v_cmp_eq_u32 vcc, -1, v10
    s_cbranch_vccnz P4_RV01
    s_branch P4_RV01B
P4_RK02:
    s_add_u32 s46, s46, 1
    s_cmp_gt_u32 s46, 131072
    s_cbranch_scc1 P4_RK02B
    s_sleep 2
    buffer_load_dwordx4 v[108:111], v3, s[8:11], s22 offen offset:0 sc1
    s_waitcnt vmcnt(0)
    s_waitcnt lgkmcnt(0)
    v_max3_u32 v10, v108, v109, v110
    v_max_u32 v10, v111, v10
    v_cmp_eq_u32 vcc, -1, v10
    s_cbranch_vccnz P4_RK02
    s_branch P4_RK02B
P4_RV02:
    s_add_u32 s46, s46, 1
    s_cmp_gt_u32 s46, 131072
    s_cbranch_scc1 P4_RV02B
    s_sleep 2
    s_add_u32 m0, s6, 16384
    s_add_u32 s27, s40, 2048
    buffer_load_dwordx4 v3, s[8:11], s27 offen sc1 lds
    s_add_u32 m0, s6, 24576
    s_add_u32 s27, s40, 3072
    buffer_load_dwordx4 v3, s[8:11], s27 offen sc1 lds
    s_waitcnt vmcnt(0)
    ds_read_b128 v[148:151], v208 offset:0
    ds_read_b128 v[152:155], v209 offset:0
    s_waitcnt lgkmcnt(0)
    v_max_u32 v10, v148, v152
    v_cmp_eq_u32 vcc, -1, v10
    s_cbranch_vccnz P4_RV02
    s_branch P4_RV02B
P4_RK03:
    s_add_u32 s46, s46, 1
    s_cmp_gt_u32 s46, 131072
    s_cbranch_scc1 P4_RK03B
    s_sleep 2
    buffer_load_dwordx4 v[112:115], v3, s[8:11], s22 offen offset:1024 sc1
    s_waitcnt vmcnt(0)
    s_waitcnt lgkmcnt(0)
    v_max3_u32 v10, v112, v113, v114
    v_max_u32 v10, v115, v10
    v_cmp_eq_u32 vcc, -1, v10
    s_cbranch_vccnz P4_RK03
    s_branch P4_RK03B
P4_RV03:
    s_add_u32 s46, s46, 1
    s_cmp_gt_u32 s46, 131072
    s_cbranch_scc1 P4_RV03B
    s_sleep 2
    s_add_u32 m0, s6, 24576
    s_add_u32 s27, s40, 3072
    buffer_load_dwordx4 v3, s[8:11], s27 offen sc1 lds
    s_add_u32 m0, s6, 32768
    s_add_u32 s27, s40, 4096
    buffer_load_dwordx4 v3, s[8:11], s27 offen sc1 lds
    s_waitcnt vmcnt(0)
    ds_read_b128 v[156:159], v210 offset:0
    ds_read_b128 v[160:163], v211 offset:0
    s_waitcnt lgkmcnt(0)
    v_max_u32 v10, v156, v160
    v_cmp_eq_u32 vcc, -1, v10
    s_cbranch_vccnz P4_RV03
    s_branch P4_RV03B
P4_RK04:
    s_add_u32 s46, s46, 1
    s_cmp_gt_u32 s46, 131072
    s_cbranch_scc1 P4_RK04B
    s_sleep 2
    buffer_load_dwordx4 v[116:119], v3, s[8:11], s22 offen offset:2048 sc1
    s_waitcnt vmcnt(0)
    s_waitcnt lgkmcnt(0)
    v_max3_u32 v10, v116, v117, v118
    v_max_u32 v10, v119, v10
    v_cmp_eq_u32 vcc, -1, v10
    s_cbranch_vccnz P4_RK04
    s_branch P4_RK04B
P4_RV04:
    s_add_u32 s46, s46, 1
    s_cmp_gt_u32 s46, 131072
    s_cbranch_scc1 P4_RV04B
    s_sleep 2
    s_add_u32 m0, s6, 40960
    s_add_u32 s27, s40, 5120
    buffer_load_dwordx4 v3, s[8:11], s27 offen sc1 lds
    s_add_u32 m0, s6, 49152
    s_add_u32 s27, s40, 6144
    buffer_load_dwordx4 v3, s[8:11], s27 offen sc1 lds
    s_waitcnt vmcnt(0)
    ds_read_b128 v[164:167], v204 offset:40960
    ds_read_b128 v[168:171], v205 offset:40960
    s_waitcnt lgkmcnt(0)
    v_max_u32 v10, v164, v168
    v_cmp_eq_u32 vcc, -1, v10
    s_cbranch_vccnz P4_RV04
    s_branch P4_RV04B
P4_RK05:
    s_add_u32 s46, s46, 1
    s_cmp_gt_u32 s46, 131072
    s_cbranch_scc1 P4_RK05B
    s_sleep 2
    buffer_load_dwordx4 v[120:123], v3, s[8:11], s22 offen offset:3072 sc1
    s_waitcnt vmcnt(0)
    s_waitcnt lgkmcnt(0)
    v_max3_u32 v10, v120, v121, v122
    v_max_u32 v10, v123, v10
    v_cmp_eq_u32 vcc, -1, v10
    s_cbranch_vccnz P4_RK05
    s_branch P4_RK05B
P4_RV05:
    s_add_u32 s46, s46, 1
    s_cmp_gt_u32 s46, 131072
    s_cbranch_scc1 P4_RV05B
    s_sleep 2
    s_add_u32 m0, s6, 49152
    s_add_u32 s27, s40, 6144
    buffer_load_dwordx4 v3, s[8:11], s27 offen sc1 lds
    s_add_u32 m0, s6, 57344
    s_add_u32 s27, s40, 7168
    buffer_load_dwordx4 v3, s[8:11], s27 offen sc1 lds
    s_waitcnt vmcnt(0)
    ds_read_b128 v[172:175], v206 offset:40960
    ds_read_b128 v[176:179], v207 offset:40960
    s_waitcnt lgkmcnt(0)
    v_max_u32 v10, v172, v176
    v_cmp_eq_u32 vcc, -1, v10
    s_cbranch_vccnz P4_RV05
    s_branch P4_RV05B
P4_RV06:
    s_add_u32 s46, s46, 1
    s_cmp_gt_u32 s46, 131072
    s_cbranch_scc1 P4_RV06B
    s_sleep 2
    s_add_u32 m0, s6, 57344
    s_add_u32 s27, s40, 7168
    buffer_load_dwordx4 v3, s[8:11], s27 offen sc1 lds
    s_add_u32 m0, s6, 65536
    s_add_u32 s27, s40, 8192
    buffer_load_dwordx4 v3, s[8:11], s27 offen sc1 lds
    s_waitcnt vmcnt(0)
    ds_read_b128 v[180:183], v208 offset:40960
    ds_read_b128 v[184:187], v209 offset:40960
    s_waitcnt lgkmcnt(0)
    v_max_u32 v10, v180, v184
    v_cmp_eq_u32 vcc, -1, v10
    s_cbranch_vccnz P4_RV06
    s_branch P4_RV06B
P4_RV07:
    s_add_u32 s46, s46, 1
    s_cmp_gt_u32 s46, 131072
    s_cbranch_scc1 P4_RV07B
    s_sleep 2
    s_add_u32 m0, s6, 65536
    s_add_u32 s27, s40, 8192
    buffer_load_dwordx4 v3, s[8:11], s27 offen sc1 lds
    s_add_u32 m0, s6, 73728
    s_add_u32 s27, s40, 9216
    buffer_load_dwordx4 v3, s[8:11], s27 offen sc1 lds
    s_waitcnt vmcnt(0)
    ds_read_b128 v[188:191], v210 offset:40960
    ds_read_b128 v[192:195], v211 offset:40960
    s_waitcnt lgkmcnt(0)
    v_max_u32 v10, v188, v192
    v_cmp_eq_u32 vcc, -1, v10
    s_cbranch_vccnz P4_RV07
    s_branch P4_RV07B
P4_RK10:
    s_add_u32 s46, s46, 1
    s_cmp_gt_u32 s46, 131072
    s_cbranch_scc1 P4_RK10B
    s_sleep 2
    buffer_load_dwordx4 v[100:103], v3, s[8:11], s21 offen offset:2048 sc1
    s_waitcnt vmcnt(0)
    s_waitcnt lgkmcnt(0)
    v_max3_u32 v10, v100, v101, v102
    v_max_u32 v10, v103, v10
    v_cmp_eq_u32 vcc, -1, v10
    s_cbranch_vccnz P4_RK10
    s_branch P4_RK10B
P4_RV10:
    s_add_u32 s46, s46, 1
    s_cmp_gt_u32 s46, 131072
    s_cbranch_scc1 P4_RV10B
    s_sleep 2
    s_add_u32 m0, s6, 0
    s_add_u32 s27, s40, 0
    buffer_load_dwordx4 v3, s[8:11], s27 offen sc1 lds
    s_add_u32 m0, s6, 8192
    s_add_u32 s27, s40, 1024
    buffer_load_dwordx4 v3, s[8:11], s27 offen sc1 lds
    s_waitcnt vmcnt(0)
    ds_read_b128 v[132:135], v204 offset:0
    ds_read_b128 v[136:139], v205 offset:0
    s_waitcnt lgkmcnt(0)
    v_max_u32 v10, v132, v136
    v_cmp_eq_u32 vcc, -1, v10
    s_cbranch_vccnz P4_RV10
    s_branch P4_RV10B
P4_RK11:
    s_add_u32 s46, s46, 1
    s_cmp_gt_u32 s46, 131072
    s_cbranch_scc1 P4_RK11B
    s_sleep 2
    buffer_load_dwordx4 v[104:107], v3, s[8:11], s21 offen offset:3072 sc1
    s_waitcnt vmcnt(0)
    s_waitcnt lgkmcnt(0)
    v_max3_u32 v10, v104, v105, v106
    v_max_u32 v10, v107, v10
    v_cmp_eq_u32 vcc, -1, v10
    s_cbranch_vccnz P4_RK11
    s_branch P4_RK11B
P4_RV11:
    s_add_u32 s46, s46, 1
    s_cmp_gt_u32 s46, 131072
    s_cbranch_scc1 P4_RV11B
    s_sleep 2
    s_add_u32 m0, s6, 8192
    s_add_u32 s27, s40, 1024
    buffer_load_dwordx4 v3, s[8:11], s27 offen sc1 lds
    s_add_u32 m0, s6, 16384
    s_add_u32 s27, s40, 2048
    buffer_load_dwordx4 v3, s[8:11], s27 offen sc1 lds
    s_waitcnt vmcnt(0)
    ds_read_b128 v[140:143], v206 offset:0
    ds_read_b128 v[144:147], v207 offset:0
    s_waitcnt lgkmcnt(0)
    v_max_u32 v10, v140, v144
    v_cmp_eq_u32 vcc, -1, v10
    s_cbranch_vccnz P4_RV11
    s_branch P4_RV11B
P4_RK12:
    s_add_u32 s46, s46, 1
    s_cmp_gt_u32 s46, 131072
    s_cbranch_scc1 P4_RK12B
    s_sleep 2
    buffer_load_dwordx4 v[108:111], v3, s[8:11], s22 offen offset:0 sc1
    s_waitcnt vmcnt(0)
    s_waitcnt lgkmcnt(0)
    v_max3_u32 v10, v108, v109, v110
    v_max_u32 v10, v111, v10
    v_cmp_eq_u32 vcc, -1, v10
    s_cbranch_vccnz P4_RK12
    s_branch P4_RK12B
P4_RV12:
    s_add_u32 s46, s46, 1
    s_cmp_gt_u32 s46, 131072
    s_cbranch_scc1 P4_RV12B
    s_sleep 2
    s_add_u32 m0, s6, 16384
    s_add_u32 s27, s40, 2048
    buffer_load_dwordx4 v3, s[8:11], s27 offen sc1 lds
    s_add_u32 m0, s6, 24576
    s_add_u32 s27, s40, 3072
    buffer_load_dwordx4 v3, s[8:11], s27 offen sc1 lds
    s_waitcnt vmcnt(0)
    ds_read_b128 v[148:151], v208 offset:0
    ds_read_b128 v[152:155], v209 offset:0
    s_waitcnt lgkmcnt(0)
    v_max_u32 v10, v148, v152
    v_cmp_eq_u32 vcc, -1, v10
    s_cbranch_vccnz P4_RV12
    s_branch P4_RV12B
P4_RK13:
    s_add_u32 s46, s46, 1
    s_cmp_gt_u32 s46, 131072
    s_cbranch_scc1 P4_RK13B
    s_sleep 2
    buffer_load_dwordx4 v[112:115], v3, s[8:11], s22 offen offset:1024 sc1
    s_waitcnt vmcnt(0)
    s_waitcnt lgkmcnt(0)
    v_max3_u32 v10, v112, v113, v114
    v_max_u32 v10, v115, v10
    v_cmp_eq_u32 vcc, -1, v10
    s_cbranch_vccnz P4_RK13
    s_branch P4_RK13B
P4_RV13:
    s_add_u32 s46, s46, 1
    s_cmp_gt_u32 s46, 131072
    s_cbranch_scc1 P4_RV13B
    s_sleep 2
    s_add_u32 m0, s6, 24576
    s_add_u32 s27, s40, 3072
    buffer_load_dwordx4 v3, s[8:11], s27 offen sc1 lds
    s_add_u32 m0, s6, 32768
    s_add_u32 s27, s40, 4096
    buffer_load_dwordx4 v3, s[8:11], s27 offen sc1 lds
    s_waitcnt vmcnt(0)
    ds_read_b128 v[156:159], v210 offset:0
    ds_read_b128 v[160:163], v211 offset:0
    s_waitcnt lgkmcnt(0)
    v_max_u32 v10, v156, v160
    v_cmp_eq_u32 vcc, -1, v10
    s_cbranch_vccnz P4_RV13
    s_branch P4_RV13B
P4_RK14:
    s_add_u32 s46, s46, 1
    s_cmp_gt_u32 s46, 131072
    s_cbranch_scc1 P4_RK14B
    s_sleep 2
    buffer_load_dwordx4 v[116:119], v3, s[8:11], s22 offen offset:2048 sc1
    s_waitcnt vmcnt(0)
    s_waitcnt lgkmcnt(0)
    v_max3_u32 v10, v116, v117, v118
    v_max_u32 v10, v119, v10
    v_cmp_eq_u32 vcc, -1, v10
    s_cbranch_vccnz P4_RK14
    s_branch P4_RK14B
P4_RV14:
    s_add_u32 s46, s46, 1
    s_cmp_gt_u32 s46, 131072
    s_cbranch_scc1 P4_RV14B
    s_sleep 2
    s_add_u32 m0, s6, 40960
    s_add_u32 s27, s40, 5120
    buffer_load_dwordx4 v3, s[8:11], s27 offen sc1 lds
    s_add_u32 m0, s6, 49152
    s_add_u32 s27, s40, 6144
    buffer_load_dwordx4 v3, s[8:11], s27 offen sc1 lds
    s_waitcnt vmcnt(0)
    ds_read_b128 v[164:167], v204 offset:40960
    ds_read_b128 v[168:171], v205 offset:40960
    s_waitcnt lgkmcnt(0)
    v_max_u32 v10, v164, v168
    v_cmp_eq_u32 vcc, -1, v10
    s_cbranch_vccnz P4_RV14
    s_branch P4_RV14B
P4_RK15:
    s_add_u32 s46, s46, 1
    s_cmp_gt_u32 s46, 131072
    s_cbranch_scc1 P4_RK15B
    s_sleep 2
    buffer_load_dwordx4 v[120:123], v3, s[8:11], s22 offen offset:3072 sc1
    s_waitcnt vmcnt(0)
    s_waitcnt lgkmcnt(0)
    v_max3_u32 v10, v120, v121, v122
    v_max_u32 v10, v123, v10
    v_cmp_eq_u32 vcc, -1, v10
    s_cbranch_vccnz P4_RK15
    s_branch P4_RK15B
P4_RV15:
    s_add_u32 s46, s46, 1
    s_cmp_gt_u32 s46, 131072
    s_cbranch_scc1 P4_RV15B
    s_sleep 2
    s_add_u32 m0, s6, 49152
    s_add_u32 s27, s40, 6144
    buffer_load_dwordx4 v3, s[8:11], s27 offen sc1 lds
    s_add_u32 m0, s6, 57344
    s_add_u32 s27, s40, 7168
    buffer_load_dwordx4 v3, s[8:11], s27 offen sc1 lds
    s_waitcnt vmcnt(0)
    ds_read_b128 v[172:175], v206 offset:40960
    ds_read_b128 v[176:179], v207 offset:40960
    s_waitcnt lgkmcnt(0)
    v_max_u32 v10, v172, v176
    v_cmp_eq_u32 vcc, -1, v10
    s_cbranch_vccnz P4_RV15
    s_branch P4_RV15B
P4_RV16:
    s_add_u32 s46, s46, 1
    s_cmp_gt_u32 s46, 131072
    s_cbranch_scc1 P4_RV16B
    s_sleep 2
    s_add_u32 m0, s6, 57344
    s_add_u32 s27, s40, 7168
    buffer_load_dwordx4 v3, s[8:11], s27 offen sc1 lds
    s_add_u32 m0, s6, 65536
    s_add_u32 s27, s40, 8192
    buffer_load_dwordx4 v3, s[8:11], s27 offen sc1 lds
    s_waitcnt vmcnt(0)
    ds_read_b128 v[180:183], v208 offset:40960
    ds_read_b128 v[184:187], v209 offset:40960
    s_waitcnt lgkmcnt(0)
    v_max_u32 v10, v180, v184
    v_cmp_eq_u32 vcc, -1, v10
    s_cbranch_vccnz P4_RV16
    s_branch P4_RV16B
P4_RV17:
    s_add_u32 s46, s46, 1
    s_cmp_gt_u32 s46, 131072
    s_cbranch_scc1 P4_RV17B
    s_sleep 2
    s_add_u32 m0, s6, 65536
    s_add_u32 s27, s40, 8192
    buffer_load_dwordx4 v3, s[8:11], s27 offen sc1 lds
    s_add_u32 m0, s6, 73728
    s_add_u32 s27, s40, 9216
    buffer_load_dwordx4 v3, s[8:11], s27 offen sc1 lds
    s_waitcnt vmcnt(0)
    ds_read_b128 v[188:191], v210 offset:40960
    ds_read_b128 v[192:195], v211 offset:40960
    s_waitcnt lgkmcnt(0)
    v_max_u32 v10, v188, v192
    v_cmp_eq_u32 vcc, -1, v10
    s_cbranch_vccnz P4_RV17
    s_branch P4_RV17B
P4_FB:
    s_waitcnt vmcnt(0) lgkmcnt(0)
    s_barrier
    s_nop 15
    v_mov_b32 v12, 0
    ds_write_b32 v6, v12 offset:25856
    v_mov_b32 v11, 2
    s_mov_b32 s38, 2
    v_and_b32 v12, 31, v1
    v_lshlrev_b32 v12, 2, v12
    s_lshl_b32 s26, s3, 11
    v_add_u32 v31, s26, v9
    ds_read_b32 v20, v31 offset:1024
    s_mov_b32 exec_lo, 0
    v_mov_b32 v124, 0x3f803f80
    v_mov_b32 v125, 0x3f803f80
    v_mov_b32 v126, 0x3f803f80
    v_mov_b32 v127, 0x3f803f80
    v_mov_b32 v128, 0x3f803f80
    v_mov_b32 v129, 0x3f803f80
    v_mov_b32 v130, 0x3f803f80
    v_mov_b32 v131, 0x3f803f80
    s_mov_b32 exec_lo, -1
    s_mov_b32 s46, 0
    buffer_load_dwordx4 v[92:95], v3, s[8:11], s21 offen offset:0 sc1
    buffer_load_dwordx4 v[96:99], v3, s[8:11], s21 offen offset:1024 sc1
    s_add_u32 m0, s6, 0
    s_add_u32 s27, s40, 0
    buffer_load_dwordx4 v3, s[8:11], s27 offen sc1 lds
    s_add_u32 m0, s6, 8192
    s_add_u32 s27, s40, 1024
    buffer_load_dwordx4 v3, s[8:11], s27 offen sc1 lds
    buffer_load_dwordx4 v[100:103], v3, s[8:11], s21 offen offset:2048 sc1
    s_add_u32 m0, s6, 16384
    s_add_u32 s27, s40, 2048
    buffer_load_dwordx4 v3, s[8:11], s27 offen sc1 lds
    buffer_load_dwordx4 v[104:107], v3, s[8:11], s21 offen offset:3072 sc1
    s_waitcnt lgkmcnt(0)
    v_mov_b32 v21, 0
    v_cvt_pk_bf16_f32 v22, -v21, -v21
    v_lshlrev_b32 v22, 16, v22
    v_sub_f32 v23, -v21, v22
    v_cvt_pk_bf16_f32 v22, v22, v23
    v_cndmask_b32 v24, v22, v20, s[32:33]
    v_mov_b32 v25, 0
    v_mov_b32 v26, 0
    v_mov_b32 v27, v24
    ds_write_b128 v31, v[24:27] offset:1024
    v_add_u32 v29, 98304, v12
    s_lshl_b32 s26, s3, 7
    v_add_u32 v30, s26, v29
    v_mov_b32 v28, 0xff800000
    ds_write_b32 v30, v28 offset:62464
    s_waitcnt vmcnt(0) lgkmcnt(0)
    s_barrier
    v_mov_b32 v28, v9
    s_mov_b32 s26, 0
P4_FBL:
    ds_read_b128 v[196:199], v28 offset:0
    ds_read_b128 v[200:203], v28 offset:1024
    v_mov_b32 v21, 0xff800000
    s_waitcnt lgkmcnt(0)
    v_mfma_f32_32x32x16_bf16 v[44:59], v[92:95], v[196:199], 0
    s_nop 9
    v_mfma_f32_32x32x8_bf16 v[44:59], v[124:125], v[200:201], v[44:59]
    s_nop 11
    v_max3_f32 v21, v44, v45, v21
    v_max3_f32 v21, v46, v47, v21
    v_max3_f32 v21, v48, v49, v21
    v_max3_f32 v21, v50, v51, v21
    v_max3_f32 v21, v52, v53, v21
    v_max3_f32 v21, v54, v55, v21
    v_max3_f32 v21, v56, v57, v21
    v_max3_f32 v21, v58, v59, v21
    v_mfma_f32_32x32x16_bf16 v[44:59], v[96:99], v[196:199], 0
    s_nop 9
    v_mfma_f32_32x32x8_bf16 v[44:59], v[124:125], v[202:203], v[44:59]
    s_nop 11
    v_max3_f32 v21, v44, v45, v21
    v_max3_f32 v21, v46, v47, v21
    v_max3_f32 v21, v48, v49, v21
    v_max3_f32 v21, v50, v51, v21
    v_max3_f32 v21, v52, v53, v21
    v_max3_f32 v21, v54, v55, v21
    v_max3_f32 v21, v56, v57, v21
    v_max3_f32 v21, v58, v59, v21
    v_mfma_f32_32x32x16_bf16 v[44:59], v[100:103], v[196:199], 0
    s_nop 9
    v_mfma_f32_32x32x8_bf16 v[44:59], v[126:127], v[200:201], v[44:59]
    s_nop 11
    v_max3_f32 v21, v44, v45, v21
    v_max3_f32 v21, v46, v47, v21
    v_max3_f32 v21, v48, v49, v21
    v_max3_f32 v21, v50, v51, v21
    v_max3_f32 v21, v52, v53, v21
    v_max3_f32 v21, v54, v55, v21
    v_max3_f32 v21, v56, v57, v21
    v_max3_f32 v21, v58, v59, v21
    v_mfma_f32_32x32x16_bf16 v[44:59], v[104:107], v[196:199], 0
    s_nop 9
    v_mfma_f32_32x32x8_bf16 v[44:59], v[126:127], v[202:203], v[44:59]
    s_nop 11
    v_max3_f32 v21, v44, v45, v21
    v_max3_f32 v21, v46, v47, v21
    v_max3_f32 v21, v48, v49, v21
    v_max3_f32 v21, v50, v51, v21
    v_max3_f32 v21, v52, v53, v21
    v_max3_f32 v21, v54, v55, v21
    v_max3_f32 v21, v56, v57, v21
    v_max3_f32 v21, v58, v59, v21
    v_mfma_f32_32x32x16_bf16 v[44:59], v[108:111], v[196:199], 0
    s_nop 9
    v_mfma_f32_32x32x8_bf16 v[44:59], v[128:129], v[200:201], v[44:59]
    s_nop 11
    v_max3_f32 v21, v44, v45, v21
    v_max3_f32 v21, v46, v47, v21
    v_max3_f32 v21, v48, v49, v21
    v_max3_f32 v21, v50, v51, v21
    v_max3_f32 v21, v52, v53, v21
    v_max3_f32 v21, v54, v55, v21
    v_max3_f32 v21, v56, v57, v21
    v_max3_f32 v21, v58, v59, v21
    v_mfma_f32_32x32x16_bf16 v[44:59], v[112:115], v[196:199], 0
    s_nop 9
    v_mfma_f32_32x32x8_bf16 v[44:59], v[128:129], v[202:203], v[44:59]
    s_nop 11
    v_max3_f32 v21, v44, v45, v21
    v_max3_f32 v21, v46, v47, v21
    v_max3_f32 v21, v48, v49, v21
    v_max3_f32 v21, v50, v51, v21
    v_max3_f32 v21, v52, v53, v21
    v_max3_f32 v21, v54, v55, v21
    v_max3_f32 v21, v56, v57, v21
    v_max3_f32 v21, v58, v59, v21
    v_mfma_f32_32x32x16_bf16 v[44:59], v[116:119], v[196:199], 0
    s_nop 9
    v_mfma_f32_32x32x8_bf16 v[44:59], v[130:131], v[200:201], v[44:59]
    s_nop 11
    v_max3_f32 v21, v44, v45, v21
    v_max3_f32 v21, v46, v47, v21
    v_max3_f32 v21, v48, v49, v21
    v_max3_f32 v21, v50, v51, v21
    v_max3_f32 v21, v52, v53, v21
    v_max3_f32 v21, v54, v55, v21
    v_max3_f32 v21, v56, v57, v21
    v_max3_f32 v21, v58, v59, v21
    v_mfma_f32_32x32x16_bf16 v[44:59], v[120:123], v[196:199], 0
    s_nop 9
    v_mfma_f32_32x32x8_bf16 v[44:59], v[130:131], v[202:203], v[44:59]
    s_nop 11
    v_max3_f32 v21, v44, v45, v21
    v_max3_f32 v21, v46, v47, v21
    v_max3_f32 v21, v48, v49, v21
    v_max3_f32 v21, v50, v51, v21
    v_max3_f32 v21, v52, v53, v21
    v_max3_f32 v21, v54, v55, v21
    v_max3_f32 v21, v56, v57, v21
    v_max3_f32 v21, v58, v59, v21
    ds_max_f32 v29, v21 offset:62464
    v_add_u32 v28, 2048, v28
    v_add_u32 v29, 128, v29
    s_add_u32 s26, s26, 1
    s_cmp_lt_u32 s26, 8
    s_cbranch_scc1 P4_FBL
    s_waitcnt lgkmcnt(0)
    s_barrier
    ds_read_b32 v21, v30 offset:62464
    s_waitcnt lgkmcnt(0)
    v_cvt_pk_bf16_f32 v22, -v21, -v21
    v_lshlrev_b32 v22, 16, v22
    v_sub_f32 v23, -v21, v22
    v_cvt_pk_bf16_f32 v22, v22, v23
    v_cndmask_b32 v24, v22, v20, s[32:33]
    v_mov_b32 v25, 0
    v_mov_b32 v26, 0
    v_mov_b32 v27, v24
    ds_write_b128 v31, v[24:27] offset:1024
    s_waitcnt lgkmcnt(0)
    s_barrier
    ds_read_b128 v[196:199], v9 offset:0
    ds_read_b128 v[200:203], v9 offset:1024
    s_waitcnt lgkmcnt(0)
    s_branch P4_GO
CODE_END:
.section .rodata,"a"
.p2align 6
.amdhsa_kernel k0_kernel
  .amdhsa_next_free_vgpr 80
  .amdhsa_next_free_sgpr 64
  .amdhsa_accum_offset 80
  .amdhsa_group_segment_fixed_size 0
  .amdhsa_kernarg_size 88
  .amdhsa_user_sgpr_count 2
  .amdhsa_user_sgpr_kernarg_segment_ptr 1
  .amdhsa_system_sgpr_workgroup_id_x 1
.end_amdhsa_kernel
.p2align 6
.amdhsa_kernel main_kernel
  .amdhsa_next_free_vgpr 256
  .amdhsa_next_free_sgpr 48
  .amdhsa_accum_offset 256
  .amdhsa_group_segment_fixed_size 0
  .amdhsa_kernarg_size 88
  .amdhsa_user_sgpr_count 2
  .amdhsa_user_sgpr_kernarg_segment_ptr 1
  .amdhsa_system_sgpr_workgroup_id_x 1
.end_amdhsa_kernel
```
